```python
import torch

def _softmax(x, axis=-1):
    return torch.softmax(x, dim=axis)
def _gelu(x):
    return torch.nn.functional.gelu(x, approximate="tanh")
def _silu(x):
    return torch.nn.functional.silu(x)
def _sigmoid(x):
    return torch.sigmoid(x)
def _layernorm(x, axis=-1, eps=1e-5):
    m = x.mean(dim=axis, keepdim=True)
    v = x.var(dim=axis, keepdim=True, unbiased=False)
    return (x - m) / torch.sqrt(v + eps)
def _scatter_add(tgt, idx, src, axis=0):
    return tgt.clone().index_add_(axis, idx, src)
def _segment_sum(src, seg, n):
    out = torch.zeros((n,) + src.shape[1:], dtype=src.dtype)
    return out.index_add_(0, seg, src)
def _pad(x, pw):
    flat = tuple(v for pair in reversed(pw) for v in pair)
    return torch.nn.functional.pad(x, flat)

kernel_name = 'standalone__gqa_block_cached__near_ridge'

def setup_inputs():

    _w = (lambda a: (lambda t: t.to(torch.bfloat16) if t.is_floating_point() else t)(torch.as_tensor(a)))
    B, Sq, D = 8, 144, 640
    Hq, Hkv, Sk, Dh = 32, 32, 1024, 128
    assert Hq % Hkv == 0, (Hq, Hkv)
    return {
        "x": _w((lambda *s: torch.randn(*s, dtype=torch.bfloat16) * 0.8)(B, Sq, D)),
        "k_cache": _w((lambda *s: torch.randn(*s, dtype=torch.bfloat16) * 0.8)(B, Hkv, Sk, Dh)),
        "v_cache": _w((lambda *s: torch.randn(*s, dtype=torch.bfloat16) * 0.05)(B, Hkv, Sk, Dh)),
        "wq": _w((lambda *s: torch.randn(*s, dtype=torch.bfloat16) * 0.8)(D, Hq * Dh) * (D ** -0.5)),
        "wo": _w((lambda *s: torch.randn(*s, dtype=torch.bfloat16) * 0.05)(Hq * Dh, D) * ((Hq * Dh) ** -0.5)),
    }

def reference(x, k_cache, v_cache, wq, wo):
    B, Sq, D = x.shape
    Hq, Dh = 32, 128
    Hkv = k_cache.shape[1]
    rep = Hq // Hkv
    q = (lambda x, *d: x.permute(*d))((x @ wq).reshape(B, Sq, Hq, Dh), 0, 2, 1, 3)
    k = (lambda x, n, axis: torch.repeat_interleave(x, n, dim=axis))(k_cache, rep, axis=1)
    v = (lambda x, n, axis: torch.repeat_interleave(x, n, dim=axis))(v_cache, rep, axis=1)
    scores = torch.einsum("bhqd,bhkd->bhqk", q, k) * (Dh ** -0.5)
    p = _softmax(scores, axis=-1)
    o = torch.einsum("bhqk,bhkd->bhqd", p, v)
    return (lambda x, *d: x.permute(*d))(o, 0, 2, 1, 3).reshape(B, Sq, Hq * Dh) @ wo
```

```asm
; @launch grid=(256,1,1) block=(256,1,1) lds=163840
.amdgcn_target "amdgcn-amd-amdhsa--gfx950"
.text
.globl standalone__gqa_block_cached__near_ridge_kernel
.p2align 8
.type standalone__gqa_block_cached__near_ridge_kernel,@function
standalone__gqa_block_cached__near_ridge_kernel:
  s_cmp_ge_u32 s2, 256
  s_cbranch_scc1 L_end_standalone__gqa_block_cached__near_ridge_kernel
  s_load_dwordx8 s[4:11], s[0:1], 0
  s_load_dwordx8 s[12:19], s[0:1], 32
  v_lshrrev_b32 v1, 6, v0
  s_and_b32 s43, s2, 7
  s_bfe_u32 s3, s2, 0x20003
  s_lshr_b32 s41, s2, 5
  v_readfirstlane_b32 s40, v1
  s_lshl_b32 s42, s43, 2
  s_add_u32 s42, s42, s3
  s_lshl_b32 s94, s41, 5
  s_add_u32 s94, s94, s42
  s_lshl_b32 s93, s3, 3
  s_add_u32 s93, s93, s43
  s_cmp_lt_u32 s40, 3
  s_cbranch_scc1 L_Cw_standalone__gqa_block_cached__near_ridge_kernel
  s_mul_i32 s43, s41, 5
  s_lshr_b32 s43, s43, 2
  s_mul_i32 s44, s3, 5
  s_lshr_b32 s44, s44, 1
  s_add_u32 s43, s43, s44
  s_sub_u32 s44, s43, 10
  s_cmp_ge_u32 s43, 10
  s_cselect_b32 s80, s44, s43
  s_add_u32 s81, s80, 1
  s_cmp_eq_u32 s81, 10
  s_cselect_b32 s81, 0, s81
  s_mul_i32 s48, s41, 184320
  s_lshl_b32 s49, s93, 8
  v_and_b32 v92, 63, v0
  v_and_b32 v85, 15, v92
  v_lshrrev_b32 v86, 4, v92
  v_lshrrev_b32 v91, 3, v92
  v_mul_u32_u24 v91, 1280, v91
  v_xor_b32 v84, v86, v92
  v_and_b32 v84, 7, v84
  v_lshl_add_u32 v93, v84, 4, v91
  v_xor_b32 v84, 4, v84
  v_lshl_add_u32 v94, v84, 4, v91
  v_add_u32 v94, 9216, v94
  v_add_u32 v95, 18432, v93
  v_add_u32 v96, 18432, v94
  v_lshlrev_b32 v84, 2, v86
  v_xor_b32 v84, v84, v85
  v_lshlrev_b32 v91, 13, v86
  v_lshl_add_u32 v97, v84, 4, v91
  v_add_u32 v98, 31744, v97
  v_xor_b32 v90, 2, v84
  v_lshl_add_u32 v90, v90, 4, v91
  v_add_u32 v99, 63488, v90
  v_add_u32 v100, 95232, v90
  s_waitcnt lgkmcnt(0)
  s_add_u32 s20, s4, s48
  s_addc_u32 s21, s5, 0
  s_mov_b32 s22, 184320
  s_mov_b32 s23, 0x20000
  s_add_u32 s32, s10, s49
  s_addc_u32 s33, s11, 0
  s_sub_u32 s34, 5242880, s49
  s_mov_b32 s35, 0x20000
  s_mov_b32 m0, 94208
  s_lshl_b32 s50, s80, 7
  buffer_load_dwordx4 v93, s[20:23], s50 offen offset:0 lds
  buffer_load_dwordx4 v94, s[20:23], s50 offen offset:1024 lds
  buffer_load_dwordx4 v95, s[20:23], s50 offen offset:2048 lds
  buffer_load_dwordx4 v96, s[20:23], s50 offen offset:3072 lds
  s_mov_b32 m0, 98304
  s_add_u32 s50, s50, 40960
  buffer_load_dwordx4 v93, s[20:23], s50 offen offset:0 lds
  buffer_load_dwordx4 v94, s[20:23], s50 offen offset:1024 lds
  buffer_load_dwordx4 v95, s[20:23], s50 offen offset:2048 lds
  buffer_load_dwordx4 v96, s[20:23], s50 offen offset:3072 lds
  s_mov_b32 m0, 102400
  s_add_u32 s50, s50, 40960
  buffer_load_dwordx4 v93, s[20:23], s50 offen offset:0 lds
  buffer_load_dwordx4 v94, s[20:23], s50 offen offset:1024 lds
  buffer_load_dwordx4 v95, s[20:23], s50 offen offset:2048 lds
  buffer_load_dwordx4 v96, s[20:23], s50 offen offset:3072 lds
  s_mov_b32 m0, 106496
  s_add_u32 s50, s50, 40960
  buffer_load_dwordx4 v93, s[20:23], s50 offen offset:0 lds
  buffer_load_dwordx4 v94, s[20:23], s50 offen offset:1024 lds
  buffer_load_dwordx4 v95, s[20:23], s50 offen offset:2048 lds
  buffer_load_dwordx4 v96, s[20:23], s50 offen offset:3072 lds
  s_mov_b32 m0, 110592
  s_add_u32 s50, s50, 40960
  buffer_load_dwordx4 v93, s[20:23], s50 offen offset:0 lds
  buffer_load_dwordx4 v94, s[20:23], s50 offen offset:1024 lds
  s_mov_b32 m0, 112640
  s_lshl_b32 s50, s80, 19
  buffer_load_dwordx4 v97, s[32:35], s50 offen offset:0 lds
  buffer_load_dwordx4 v98, s[32:35], s50 offen offset:1024 lds
  buffer_load_dwordx4 v99, s[32:35], s50 offen offset:2048 lds
  buffer_load_dwordx4 v100, s[32:35], s50 offen offset:3072 lds
  s_mov_b32 m0, 116736
  s_add_u32 s50, s50, 131072
  buffer_load_dwordx4 v97, s[32:35], s50 offen offset:0 lds
  buffer_load_dwordx4 v98, s[32:35], s50 offen offset:1024 lds
  buffer_load_dwordx4 v99, s[32:35], s50 offen offset:2048 lds
  buffer_load_dwordx4 v100, s[32:35], s50 offen offset:3072 lds
  s_mov_b32 m0, 120832
  s_add_u32 s50, s50, 131072
  buffer_load_dwordx4 v97, s[32:35], s50 offen offset:0 lds
  buffer_load_dwordx4 v98, s[32:35], s50 offen offset:1024 lds
  buffer_load_dwordx4 v99, s[32:35], s50 offen offset:2048 lds
  buffer_load_dwordx4 v100, s[32:35], s50 offen offset:3072 lds
  s_mov_b32 m0, 124928
  s_add_u32 s50, s50, 131072
  buffer_load_dwordx4 v97, s[32:35], s50 offen offset:0 lds
  buffer_load_dwordx4 v98, s[32:35], s50 offen offset:1024 lds
  buffer_load_dwordx4 v99, s[32:35], s50 offen offset:2048 lds
  buffer_load_dwordx4 v100, s[32:35], s50 offen offset:3072 lds
  s_mov_b32 m0, 129024
  s_lshl_b32 s50, s81, 7
  buffer_load_dwordx4 v93, s[20:23], s50 offen offset:0 lds
  buffer_load_dwordx4 v94, s[20:23], s50 offen offset:1024 lds
  buffer_load_dwordx4 v95, s[20:23], s50 offen offset:2048 lds
  buffer_load_dwordx4 v96, s[20:23], s50 offen offset:3072 lds
  s_mov_b32 m0, 133120
  s_add_u32 s50, s50, 40960
  buffer_load_dwordx4 v93, s[20:23], s50 offen offset:0 lds
  buffer_load_dwordx4 v94, s[20:23], s50 offen offset:1024 lds
  buffer_load_dwordx4 v95, s[20:23], s50 offen offset:2048 lds
  buffer_load_dwordx4 v96, s[20:23], s50 offen offset:3072 lds
  s_mov_b32 m0, 137216
  s_add_u32 s50, s50, 40960
  buffer_load_dwordx4 v93, s[20:23], s50 offen offset:0 lds
  buffer_load_dwordx4 v94, s[20:23], s50 offen offset:1024 lds
  buffer_load_dwordx4 v95, s[20:23], s50 offen offset:2048 lds
  buffer_load_dwordx4 v96, s[20:23], s50 offen offset:3072 lds
  s_mov_b32 m0, 141312
  s_add_u32 s50, s50, 40960
  buffer_load_dwordx4 v93, s[20:23], s50 offen offset:0 lds
  buffer_load_dwordx4 v94, s[20:23], s50 offen offset:1024 lds
  buffer_load_dwordx4 v95, s[20:23], s50 offen offset:2048 lds
  buffer_load_dwordx4 v96, s[20:23], s50 offen offset:3072 lds
  s_mov_b32 m0, 145408
  s_add_u32 s50, s50, 40960
  buffer_load_dwordx4 v93, s[20:23], s50 offen offset:0 lds
  buffer_load_dwordx4 v94, s[20:23], s50 offen offset:1024 lds
  s_mov_b32 m0, 147456
  s_lshl_b32 s50, s81, 19
  buffer_load_dwordx4 v97, s[32:35], s50 offen offset:0 lds
  buffer_load_dwordx4 v98, s[32:35], s50 offen offset:1024 lds
  buffer_load_dwordx4 v99, s[32:35], s50 offen offset:2048 lds
  buffer_load_dwordx4 v100, s[32:35], s50 offen offset:3072 lds
  s_mov_b32 m0, 151552
  s_add_u32 s50, s50, 131072
  buffer_load_dwordx4 v97, s[32:35], s50 offen offset:0 lds
  buffer_load_dwordx4 v98, s[32:35], s50 offen offset:1024 lds
  buffer_load_dwordx4 v99, s[32:35], s50 offen offset:2048 lds
  buffer_load_dwordx4 v100, s[32:35], s50 offen offset:3072 lds
  s_add_u32 s82, s81, 1
  s_cmp_eq_u32 s82, 10
  s_cselect_b32 s82, 0, s82
  s_add_u32 s83, s82, 1
  s_cmp_eq_u32 s83, 10
  s_cselect_b32 s83, 0, s83
  s_add_u32 s84, s83, 1
  s_cmp_eq_u32 s84, 10
  s_cselect_b32 s84, 0, s84
  s_add_u32 s85, s84, 1
  s_cmp_eq_u32 s85, 10
  s_cselect_b32 s85, 0, s85
  s_add_u32 s86, s85, 1
  s_cmp_eq_u32 s86, 10
  s_cselect_b32 s86, 0, s86
  s_add_u32 s87, s86, 1
  s_cmp_eq_u32 s87, 10
  s_cselect_b32 s87, 0, s87
  s_add_u32 s88, s87, 1
  s_cmp_eq_u32 s88, 10
  s_cselect_b32 s88, 0, s88
  s_add_u32 s89, s88, 1
  s_cmp_eq_u32 s89, 10
  s_cselect_b32 s89, 0, s89
  s_lshl_b32 s47, s41, 5
  s_add_u32 s47, s47, s93
  s_lshl_b32 s47, s47, 18
  s_add_u32 s24, s6, s47
  s_addc_u32 s25, s7, 0
  s_mov_b32 s26, 0x40000
  s_mov_b32 s27, 0x20000
  s_add_u32 s28, s8, s47
  s_addc_u32 s29, s9, 0
  s_mov_b32 s30, 0x40000
  s_mov_b32 s31, 0x20000
  s_lshr_b32 s43, s42, 2
  s_lshl_b32 s95, s43, 12
  s_mul_i32 s44, s3, 320
  s_mul_i32 s48, s41, 184320
  s_add_u32 s48, s48, s44
  s_add_u32 s36, s14, s48
  s_addc_u32 s37, s15, 0
  s_mov_b32 s38, 183360
  s_mov_b32 s39, 0x20000
  s_mul_i32 s48, s43, 163840
  s_add_u32 s48, s48, s44
  s_add_u32 s4, s12, s48
  s_addc_u32 s5, s13, 0
  s_mov_b32 s6, 4095040
  s_mov_b32 s7, 0x20000
  s_sub_u32 s48, s94, s3
  s_mul_i32 s48, s48, 36864
  s_add_u32 s8, s18, s48
  s_addc_u32 s9, s19, 0
  s_mov_b32 s10, 147456
  s_mov_b32 s11, 0x20000
  s_lshl_b32 s48, s41, 2
  s_add_u32 s48, s48, s3
  s_mul_i32 s48, s48, 368640
  s_add_u32 s48, s48, 16777216
  s_add_u32 s12, s18, s48
  s_addc_u32 s13, s19, 0
  s_mov_b32 s14, 368640
  s_mov_b32 s15, 0x20000
  s_lshl_b32 s48, s41, 15
  s_add_u32 s48, s48, 50331648
  s_add_u32 s16, s18, s48
  s_addc_u32 s17, s19, 0
  s_mov_b32 s18, 32768
  s_mov_b32 s19, 0x20000
  s_mov_b32 s92, 0
  v_lshlrev_b32 v91, 8, v86
  v_add_u32 v84, 0, v86
  v_xor_b32 v84, v84, v85
  v_lshl_add_u32 v101, v84, 4, v91
  v_add_u32 v84, 4, v86
  v_xor_b32 v84, v84, v85
  v_lshl_add_u32 v102, v84, 4, v91
  v_add_u32 v84, 8, v86
  v_xor_b32 v84, v84, v85
  v_lshl_add_u32 v103, v84, 4, v91
  v_add_u32 v84, 12, v86
  v_xor_b32 v84, v84, v85
  v_lshl_add_u32 v104, v84, 4, v91
  v_lshlrev_b32 v84, 2, v86
  v_xor_b32 v84, v84, v85
  v_xor_b32 v90, 0, v84
  v_lshl_add_u32 v105, v90, 4, v91
  v_xor_b32 v90, 2, v84
  v_lshl_add_u32 v106, v90, 4, v91
  v_lshlrev_b32 v116, 4, v92
  v_add_u32 v117, 65536, v116
  v_add_u32 v118, 131072, v116
  s_lshr_b32 s49, s42, 2
  s_lshl_b32 s46, s40, 3
  s_add_u32 s46, s46, s49
  s_sub_u32 s47, 7, s40
  s_lshl_b32 s47, s47, 3
  s_add_u32 s47, s47, s49
  v_lshlrev_b32 v91, 4, v92
  v_and_b32 v84, 15, v92
  v_mul_u32_u24 v84, 1280, v84
  v_bfe_u32 v90, v92, 4, 1
  v_lshl_add_u32 v84, v90, 5, v84
  v_lshrrev_b32 v90, 5, v92
  v_lshl_add_u32 v90, v90, 4, v84
  s_cmp_ge_u32 s46, 45
  s_cselect_b32 s46, s46, s46
  s_cselect_b32 s48, 0x1000000, 0
  s_lshl_b32 s43, s46, 10
  s_add_u32 s43, s43, s48
  v_add_u32 v119, s43, v91
  s_mul_i32 s43, s46, 52
  s_lshr_b32 s43, s43, 8
  s_mul_i32 s44, s43, 5
  s_sub_u32 s44, s46, s44
  s_lshl_b32 s44, s44, 6
  s_mul_i32 s45, s43, 20480
  s_add_u32 s44, s44, s45
  s_add_u32 s44, s44, s48
  v_add_u32 v121, s44, v90
  s_mul_i32 s43, s43, 86
  s_lshr_b32 s43, s43, 8
  s_lshl_b32 s43, s43, 7
  v_mov_b32 v123, s43
  s_cmp_ge_u32 s47, 45
  s_cselect_b32 s47, s46, s47
  s_cselect_b32 s48, 0x1000000, 0
  s_lshl_b32 s43, s47, 10
  s_add_u32 s43, s43, s48
  v_add_u32 v120, s43, v91
  s_mul_i32 s43, s47, 52
  s_lshr_b32 s43, s43, 8
  s_mul_i32 s44, s43, 5
  s_sub_u32 s44, s47, s44
  s_lshl_b32 s44, s44, 6
  s_mul_i32 s45, s43, 20480
  s_add_u32 s44, s44, s45
  s_add_u32 s44, s44, s48
  v_add_u32 v122, s44, v90
  s_mul_i32 s43, s43, 86
  s_lshr_b32 s43, s43, 8
  s_lshl_b32 s43, s43, 7
  v_mov_b32 v124, s43
  v_and_b32 v84, 8, v92
  v_cmp_eq_u32 vcc, 0, v84
  s_nop 1
  v_cndmask_b32 v123, v124, v123, vcc
  s_lshl_b32 s43, s3, 10
  s_add_u32 s43, s43, 512
  v_and_b32 v84, 7, v92
  v_lshl_add_u32 v123, v84, 12, v123
  v_add_u32 v123, s43, v123
  s_mov_b64 exec, 0xffff
  buffer_load_dword v124, v123, s[16:19], 0 offen sc1
  s_mov_b64 exec, -1
  s_lshr_b32 s91, s41, 1
  s_mul_i32 s91, s91, 1310720
  s_and_b32 s90, s41, 1
  s_mul_i32 s90, s90, 81920
  s_add_u32 s91, s91, s90
  v_add_u32 v84, 0, v92
  v_mul_u32_u24 v91, 3277, v84
  v_lshrrev_b32 v91, 16, v91
  v_mul_u32_u24 v90, 20, v91
  v_sub_u32 v90, v84, v90
  v_bfe_u32 v84, v91, 2, 1
  v_lshlrev_b32 v84, 1, v84
  v_xor_b32 v90, v90, v84
  v_mul_u32_u24 v91, 1280, v91
  v_lshl_add_u32 v107, v90, 4, v91
  v_add_u32 v84, 64, v92
  v_mul_u32_u24 v91, 3277, v84
  v_lshrrev_b32 v91, 16, v91
  v_mul_u32_u24 v90, 20, v91
  v_sub_u32 v90, v84, v90
  v_bfe_u32 v84, v91, 2, 1
  v_lshlrev_b32 v84, 1, v84
  v_xor_b32 v90, v90, v84
  v_mul_u32_u24 v91, 1280, v91
  v_lshl_add_u32 v108, v90, 4, v91
  v_add_u32 v84, 128, v92
  v_mul_u32_u24 v91, 3277, v84
  v_lshrrev_b32 v91, 16, v91
  v_mul_u32_u24 v90, 20, v91
  v_sub_u32 v90, v84, v90
  v_bfe_u32 v84, v91, 2, 1
  v_lshlrev_b32 v84, 1, v84
  v_xor_b32 v90, v90, v84
  v_mul_u32_u24 v91, 1280, v91
  v_lshl_add_u32 v109, v90, 4, v91
  v_add_u32 v84, 192, v92
  v_mul_u32_u24 v91, 3277, v84
  v_lshrrev_b32 v91, 16, v91
  v_mul_u32_u24 v90, 20, v91
  v_sub_u32 v90, v84, v90
  v_bfe_u32 v84, v91, 2, 1
  v_lshlrev_b32 v84, 1, v84
  v_xor_b32 v90, v90, v84
  v_mul_u32_u24 v91, 1280, v91
  v_lshl_add_u32 v110, v90, 4, v91
  v_add_u32 v84, 256, v92
  v_mul_u32_u24 v91, 3277, v84
  v_lshrrev_b32 v91, 16, v91
  v_mul_u32_u24 v90, 20, v91
  v_sub_u32 v90, v84, v90
  v_bfe_u32 v84, v91, 2, 1
  v_lshlrev_b32 v84, 1, v84
  v_xor_b32 v90, v90, v84
  v_mul_u32_u24 v91, 1280, v91
  v_lshl_add_u32 v111, v90, 4, v91
  s_waitcnt vmcnt(57)
  s_mov_b32 m0, 155648
  s_add_u32 s50, s50, 131072
  buffer_load_dwordx4 v97, s[32:35], s50 offen offset:0 lds
  buffer_load_dwordx4 v98, s[32:35], s50 offen offset:1024 lds
  buffer_load_dwordx4 v99, s[32:35], s50 offen offset:2048 lds
  buffer_load_dwordx4 v100, s[32:35], s50 offen offset:3072 lds
  s_waitcnt vmcnt(57)
  s_mov_b32 m0, 159744
  s_add_u32 s50, s50, 131072
  buffer_load_dwordx4 v97, s[32:35], s50 offen offset:0 lds
  buffer_load_dwordx4 v98, s[32:35], s50 offen offset:1024 lds
  buffer_load_dwordx4 v99, s[32:35], s50 offen offset:2048 lds
  buffer_load_dwordx4 v100, s[32:35], s50 offen offset:3072 lds
  s_add_u32 s43, s41, s3
  s_bitcmp1_b32 s43, 0
  s_cbranch_scc1 L_HB_standalone__gqa_block_cached__near_ridge_kernel
  s_waitcnt vmcnt(57)
  s_mov_b32 s50, 32768
  buffer_load_dwordx4 a[0:3], v105, s[28:31], s50 offen offset:0 nt
  buffer_load_dwordx4 a[4:7], v106, s[28:31], s50 offen offset:1024 nt
  buffer_load_dwordx4 a[8:11], v105, s[28:31], s50 offen offset:2048 nt
  buffer_load_dwordx4 a[12:15], v106, s[28:31], s50 offen offset:3072 nt
  s_waitcnt vmcnt(57)
  s_mov_b32 s50, 36864
  buffer_load_dwordx4 a[16:19], v105, s[28:31], s50 offen offset:0 nt
  buffer_load_dwordx4 a[20:23], v106, s[28:31], s50 offen offset:1024 nt
  buffer_load_dwordx4 a[24:27], v105, s[28:31], s50 offen offset:2048 nt
  buffer_load_dwordx4 a[28:31], v106, s[28:31], s50 offen offset:3072 nt
  s_waitcnt vmcnt(55)
  s_mov_b32 s50, 40960
  buffer_load_dwordx4 a[32:35], v105, s[28:31], s50 offen offset:0 nt
  buffer_load_dwordx4 a[36:39], v106, s[28:31], s50 offen offset:1024 nt
  buffer_load_dwordx4 a[40:43], v105, s[28:31], s50 offen offset:2048 nt
  buffer_load_dwordx4 a[44:47], v106, s[28:31], s50 offen offset:3072 nt
  s_waitcnt vmcnt(55)
  s_mov_b32 s50, 45056
  buffer_load_dwordx4 a[48:51], v105, s[28:31], s50 offen offset:0 nt
  buffer_load_dwordx4 a[52:55], v106, s[28:31], s50 offen offset:1024 nt
  buffer_load_dwordx4 a[56:59], v105, s[28:31], s50 offen offset:2048 nt
  buffer_load_dwordx4 a[60:63], v106, s[28:31], s50 offen offset:3072 nt
  s_waitcnt vmcnt(55)
  s_mov_b32 m0, 24576
  s_lshl_b32 s50, s82, 7
  buffer_load_dwordx4 v93, s[20:23], s50 offen offset:0 lds
  buffer_load_dwordx4 v94, s[20:23], s50 offen offset:1024 lds
  buffer_load_dwordx4 v95, s[20:23], s50 offen offset:2048 lds
  buffer_load_dwordx4 v96, s[20:23], s50 offen offset:3072 lds
  s_waitcnt vmcnt(55)
  s_mov_b32 m0, 28672
  s_add_u32 s50, s50, 40960
  buffer_load_dwordx4 v93, s[20:23], s50 offen offset:0 lds
  buffer_load_dwordx4 v94, s[20:23], s50 offen offset:1024 lds
  buffer_load_dwordx4 v95, s[20:23], s50 offen offset:2048 lds
  buffer_load_dwordx4 v96, s[20:23], s50 offen offset:3072 lds
  s_barrier
  s_waitcnt vmcnt(55)
  s_mov_b32 m0, 32768
  s_add_u32 s50, s50, 40960
  buffer_load_dwordx4 v93, s[20:23], s50 offen offset:0 lds
  buffer_load_dwordx4 v94, s[20:23], s50 offen offset:1024 lds
  buffer_load_dwordx4 v95, s[20:23], s50 offen offset:2048 lds
  buffer_load_dwordx4 v96, s[20:23], s50 offen offset:3072 lds
  s_waitcnt vmcnt(55)
  s_mov_b32 m0, 36864
  s_add_u32 s50, s50, 40960
  buffer_load_dwordx4 v93, s[20:23], s50 offen offset:0 lds
  buffer_load_dwordx4 v94, s[20:23], s50 offen offset:1024 lds
  buffer_load_dwordx4 v95, s[20:23], s50 offen offset:2048 lds
  buffer_load_dwordx4 v96, s[20:23], s50 offen offset:3072 lds
  s_mov_b32 m0, 40960
  s_add_u32 s50, s50, 40960
  buffer_load_dwordx4 v93, s[20:23], s50 offen offset:0 lds
  buffer_load_dwordx4 v94, s[20:23], s50 offen offset:1024 lds
  s_waitcnt vmcnt(57)
  s_mov_b32 m0, 43008
  s_lshl_b32 s50, s82, 19
  buffer_load_dwordx4 v97, s[32:35], s50 offen offset:0 lds
  buffer_load_dwordx4 v98, s[32:35], s50 offen offset:1024 lds
  buffer_load_dwordx4 v99, s[32:35], s50 offen offset:2048 lds
  buffer_load_dwordx4 v100, s[32:35], s50 offen offset:3072 lds
  s_waitcnt vmcnt(57)
  s_mov_b32 m0, 47104
  s_add_u32 s50, s50, 131072
  buffer_load_dwordx4 v97, s[32:35], s50 offen offset:0 lds
  buffer_load_dwordx4 v98, s[32:35], s50 offen offset:1024 lds
  buffer_load_dwordx4 v99, s[32:35], s50 offen offset:2048 lds
  buffer_load_dwordx4 v100, s[32:35], s50 offen offset:3072 lds
  s_waitcnt vmcnt(55)
  s_mov_b32 m0, 51200
  s_add_u32 s50, s50, 131072
  buffer_load_dwordx4 v97, s[32:35], s50 offen offset:0 lds
  buffer_load_dwordx4 v98, s[32:35], s50 offen offset:1024 lds
  buffer_load_dwordx4 v99, s[32:35], s50 offen offset:2048 lds
  buffer_load_dwordx4 v100, s[32:35], s50 offen offset:3072 lds
  s_waitcnt vmcnt(55)
  s_mov_b32 m0, 55296
  s_add_u32 s50, s50, 131072
  buffer_load_dwordx4 v97, s[32:35], s50 offen offset:0 lds
  buffer_load_dwordx4 v98, s[32:35], s50 offen offset:1024 lds
  buffer_load_dwordx4 v99, s[32:35], s50 offen offset:2048 lds
  buffer_load_dwordx4 v100, s[32:35], s50 offen offset:3072 lds
  s_waitcnt vmcnt(54)
  s_mov_b32 m0, 59392
  s_lshl_b32 s50, s83, 7
  buffer_load_dwordx4 v93, s[20:23], s50 offen offset:0 lds
  buffer_load_dwordx4 v94, s[20:23], s50 offen offset:1024 lds
  buffer_load_dwordx4 v95, s[20:23], s50 offen offset:2048 lds
  buffer_load_dwordx4 v96, s[20:23], s50 offen offset:3072 lds
  s_waitcnt vmcnt(54)
  s_mov_b32 m0, 63488
  s_add_u32 s50, s50, 40960
  buffer_load_dwordx4 v93, s[20:23], s50 offen offset:0 lds
  buffer_load_dwordx4 v94, s[20:23], s50 offen offset:1024 lds
  buffer_load_dwordx4 v95, s[20:23], s50 offen offset:2048 lds
  buffer_load_dwordx4 v96, s[20:23], s50 offen offset:3072 lds
  s_barrier
  s_waitcnt vmcnt(54)
  s_mov_b32 m0, 67584
  s_add_u32 s50, s50, 40960
  buffer_load_dwordx4 v93, s[20:23], s50 offen offset:0 lds
  buffer_load_dwordx4 v94, s[20:23], s50 offen offset:1024 lds
  buffer_load_dwordx4 v95, s[20:23], s50 offen offset:2048 lds
  buffer_load_dwordx4 v96, s[20:23], s50 offen offset:3072 lds
  s_waitcnt vmcnt(54)
  s_mov_b32 m0, 71680
  s_add_u32 s50, s50, 40960
  buffer_load_dwordx4 v93, s[20:23], s50 offen offset:0 lds
  buffer_load_dwordx4 v94, s[20:23], s50 offen offset:1024 lds
  buffer_load_dwordx4 v95, s[20:23], s50 offen offset:2048 lds
  buffer_load_dwordx4 v96, s[20:23], s50 offen offset:3072 lds
  s_mov_b32 m0, 75776
  s_add_u32 s50, s50, 40960
  buffer_load_dwordx4 v93, s[20:23], s50 offen offset:0 lds
  buffer_load_dwordx4 v94, s[20:23], s50 offen offset:1024 lds
  s_waitcnt vmcnt(56)
  s_mov_b32 m0, 77824
  s_lshl_b32 s50, s83, 19
  buffer_load_dwordx4 v97, s[32:35], s50 offen offset:0 lds
  buffer_load_dwordx4 v98, s[32:35], s50 offen offset:1024 lds
  buffer_load_dwordx4 v99, s[32:35], s50 offen offset:2048 lds
  buffer_load_dwordx4 v100, s[32:35], s50 offen offset:3072 lds
  s_waitcnt vmcnt(56)
  s_mov_b32 m0, 81920
  s_add_u32 s50, s50, 131072
  buffer_load_dwordx4 v97, s[32:35], s50 offen offset:0 lds
  buffer_load_dwordx4 v98, s[32:35], s50 offen offset:1024 lds
  buffer_load_dwordx4 v99, s[32:35], s50 offen offset:2048 lds
  buffer_load_dwordx4 v100, s[32:35], s50 offen offset:3072 lds
  s_waitcnt vmcnt(56)
  s_mov_b32 m0, 86016
  s_add_u32 s50, s50, 131072
  buffer_load_dwordx4 v97, s[32:35], s50 offen offset:0 lds
  buffer_load_dwordx4 v98, s[32:35], s50 offen offset:1024 lds
  buffer_load_dwordx4 v99, s[32:35], s50 offen offset:2048 lds
  buffer_load_dwordx4 v100, s[32:35], s50 offen offset:3072 lds
  s_waitcnt vmcnt(56)
  s_mov_b32 m0, 90112
  s_add_u32 s50, s50, 131072
  buffer_load_dwordx4 v97, s[32:35], s50 offen offset:0 lds
  buffer_load_dwordx4 v98, s[32:35], s50 offen offset:1024 lds
  buffer_load_dwordx4 v99, s[32:35], s50 offen offset:2048 lds
  buffer_load_dwordx4 v100, s[32:35], s50 offen offset:3072 lds
  s_waitcnt vmcnt(56)
  s_mov_b32 s50, 114688
  buffer_load_dwordx4 a[64:67], v101, s[24:27], s50 offen offset:0 nt
  buffer_load_dwordx4 a[68:71], v102, s[24:27], s50 offen offset:1024 nt
  buffer_load_dwordx4 a[72:75], v103, s[24:27], s50 offen offset:2048 nt
  buffer_load_dwordx4 a[76:79], v104, s[24:27], s50 offen offset:3072 nt
  s_waitcnt vmcnt(56)
  s_mov_b32 s50, 118784
  buffer_load_dwordx4 a[80:83], v101, s[24:27], s50 offen offset:0 nt
  buffer_load_dwordx4 a[84:87], v102, s[24:27], s50 offen offset:1024 nt
  buffer_load_dwordx4 a[88:91], v103, s[24:27], s50 offen offset:2048 nt
  buffer_load_dwordx4 a[92:95], v104, s[24:27], s50 offen offset:3072 nt
  s_waitcnt vmcnt(54)
  s_mov_b32 s50, 122880
  buffer_load_dwordx4 a[96:99], v101, s[24:27], s50 offen offset:0 nt
  buffer_load_dwordx4 a[100:103], v102, s[24:27], s50 offen offset:1024 nt
  buffer_load_dwordx4 a[104:107], v103, s[24:27], s50 offen offset:2048 nt
  buffer_load_dwordx4 a[108:111], v104, s[24:27], s50 offen offset:3072 nt
  s_waitcnt vmcnt(54)
  s_mov_b32 s50, 126976
  buffer_load_dwordx4 a[112:115], v101, s[24:27], s50 offen offset:0 nt
  buffer_load_dwordx4 a[116:119], v102, s[24:27], s50 offen offset:1024 nt
  buffer_load_dwordx4 a[120:123], v103, s[24:27], s50 offen offset:2048 nt
  buffer_load_dwordx4 a[124:127], v104, s[24:27], s50 offen offset:3072 nt
  s_waitcnt vmcnt(54)
  s_mov_b32 m0, 94208
  s_lshl_b32 s50, s84, 7
  buffer_load_dwordx4 v93, s[20:23], s50 offen offset:0 lds
  buffer_load_dwordx4 v94, s[20:23], s50 offen offset:1024 lds
  buffer_load_dwordx4 v95, s[20:23], s50 offen offset:2048 lds
  buffer_load_dwordx4 v96, s[20:23], s50 offen offset:3072 lds
  s_waitcnt vmcnt(54)
  s_mov_b32 m0, 98304
  s_add_u32 s50, s50, 40960
  buffer_load_dwordx4 v93, s[20:23], s50 offen offset:0 lds
  buffer_load_dwordx4 v94, s[20:23], s50 offen offset:1024 lds
  buffer_load_dwordx4 v95, s[20:23], s50 offen offset:2048 lds
  buffer_load_dwordx4 v96, s[20:23], s50 offen offset:3072 lds
  s_barrier
  s_waitcnt vmcnt(54)
  s_mov_b32 m0, 102400
  s_add_u32 s50, s50, 40960
  buffer_load_dwordx4 v93, s[20:23], s50 offen offset:0 lds
  buffer_load_dwordx4 v94, s[20:23], s50 offen offset:1024 lds
  buffer_load_dwordx4 v95, s[20:23], s50 offen offset:2048 lds
  buffer_load_dwordx4 v96, s[20:23], s50 offen offset:3072 lds
  s_waitcnt vmcnt(54)
  s_mov_b32 m0, 106496
  s_add_u32 s50, s50, 40960
  buffer_load_dwordx4 v93, s[20:23], s50 offen offset:0 lds
  buffer_load_dwordx4 v94, s[20:23], s50 offen offset:1024 lds
  buffer_load_dwordx4 v95, s[20:23], s50 offen offset:2048 lds
  buffer_load_dwordx4 v96, s[20:23], s50 offen offset:3072 lds
  s_mov_b32 m0, 110592
  s_add_u32 s50, s50, 40960
  buffer_load_dwordx4 v93, s[20:23], s50 offen offset:0 lds
  buffer_load_dwordx4 v94, s[20:23], s50 offen offset:1024 lds
  s_waitcnt vmcnt(56)
  s_mov_b32 m0, 112640
  s_lshl_b32 s50, s84, 19
  buffer_load_dwordx4 v97, s[32:35], s50 offen offset:0 lds
  buffer_load_dwordx4 v98, s[32:35], s50 offen offset:1024 lds
  buffer_load_dwordx4 v99, s[32:35], s50 offen offset:2048 lds
  buffer_load_dwordx4 v100, s[32:35], s50 offen offset:3072 lds
  s_waitcnt vmcnt(56)
  s_mov_b32 m0, 116736
  s_add_u32 s50, s50, 131072
  buffer_load_dwordx4 v97, s[32:35], s50 offen offset:0 lds
  buffer_load_dwordx4 v98, s[32:35], s50 offen offset:1024 lds
  buffer_load_dwordx4 v99, s[32:35], s50 offen offset:2048 lds
  buffer_load_dwordx4 v100, s[32:35], s50 offen offset:3072 lds
  s_waitcnt vmcnt(54)
  s_mov_b32 m0, 120832
  s_add_u32 s50, s50, 131072
  buffer_load_dwordx4 v97, s[32:35], s50 offen offset:0 lds
  buffer_load_dwordx4 v98, s[32:35], s50 offen offset:1024 lds
  buffer_load_dwordx4 v99, s[32:35], s50 offen offset:2048 lds
  buffer_load_dwordx4 v100, s[32:35], s50 offen offset:3072 lds
  s_waitcnt vmcnt(54)
  s_mov_b32 m0, 124928
  s_add_u32 s50, s50, 131072
  buffer_load_dwordx4 v97, s[32:35], s50 offen offset:0 lds
  buffer_load_dwordx4 v98, s[32:35], s50 offen offset:1024 lds
  buffer_load_dwordx4 v99, s[32:35], s50 offen offset:2048 lds
  buffer_load_dwordx4 v100, s[32:35], s50 offen offset:3072 lds
  s_waitcnt vmcnt(54)
  s_mov_b32 m0, 129024
  s_lshl_b32 s50, s85, 7
  buffer_load_dwordx4 v93, s[20:23], s50 offen offset:0 lds
  buffer_load_dwordx4 v94, s[20:23], s50 offen offset:1024 lds
  buffer_load_dwordx4 v95, s[20:23], s50 offen offset:2048 lds
  buffer_load_dwordx4 v96, s[20:23], s50 offen offset:3072 lds
  s_waitcnt vmcnt(54)
  s_mov_b32 m0, 133120
  s_add_u32 s50, s50, 40960
  buffer_load_dwordx4 v93, s[20:23], s50 offen offset:0 lds
  buffer_load_dwordx4 v94, s[20:23], s50 offen offset:1024 lds
  buffer_load_dwordx4 v95, s[20:23], s50 offen offset:2048 lds
  buffer_load_dwordx4 v96, s[20:23], s50 offen offset:3072 lds
  s_barrier
  s_waitcnt vmcnt(54)
  s_mov_b32 m0, 137216
  s_add_u32 s50, s50, 40960
  buffer_load_dwordx4 v93, s[20:23], s50 offen offset:0 lds
  buffer_load_dwordx4 v94, s[20:23], s50 offen offset:1024 lds
  buffer_load_dwordx4 v95, s[20:23], s50 offen offset:2048 lds
  buffer_load_dwordx4 v96, s[20:23], s50 offen offset:3072 lds
  s_waitcnt vmcnt(54)
  s_mov_b32 m0, 141312
  s_add_u32 s50, s50, 40960
  buffer_load_dwordx4 v93, s[20:23], s50 offen offset:0 lds
  buffer_load_dwordx4 v94, s[20:23], s50 offen offset:1024 lds
  buffer_load_dwordx4 v95, s[20:23], s50 offen offset:2048 lds
  buffer_load_dwordx4 v96, s[20:23], s50 offen offset:3072 lds
  s_mov_b32 m0, 145408
  s_add_u32 s50, s50, 40960
  buffer_load_dwordx4 v93, s[20:23], s50 offen offset:0 lds
  buffer_load_dwordx4 v94, s[20:23], s50 offen offset:1024 lds
  s_waitcnt vmcnt(56)
  s_mov_b32 m0, 147456
  s_lshl_b32 s50, s85, 19
  buffer_load_dwordx4 v97, s[32:35], s50 offen offset:0 lds
  buffer_load_dwordx4 v98, s[32:35], s50 offen offset:1024 lds
  buffer_load_dwordx4 v99, s[32:35], s50 offen offset:2048 lds
  buffer_load_dwordx4 v100, s[32:35], s50 offen offset:3072 lds
  s_waitcnt vmcnt(56)
  s_mov_b32 m0, 151552
  s_add_u32 s50, s50, 131072
  buffer_load_dwordx4 v97, s[32:35], s50 offen offset:0 lds
  buffer_load_dwordx4 v98, s[32:35], s50 offen offset:1024 lds
  buffer_load_dwordx4 v99, s[32:35], s50 offen offset:2048 lds
  buffer_load_dwordx4 v100, s[32:35], s50 offen offset:3072 lds
  s_waitcnt vmcnt(56)
  s_mov_b32 m0, 155648
  s_add_u32 s50, s50, 131072
  buffer_load_dwordx4 v97, s[32:35], s50 offen offset:0 lds
  buffer_load_dwordx4 v98, s[32:35], s50 offen offset:1024 lds
  buffer_load_dwordx4 v99, s[32:35], s50 offen offset:2048 lds
  buffer_load_dwordx4 v100, s[32:35], s50 offen offset:3072 lds
  s_waitcnt vmcnt(56)
  s_mov_b32 m0, 159744
  s_add_u32 s50, s50, 131072
  buffer_load_dwordx4 v97, s[32:35], s50 offen offset:0 lds
  buffer_load_dwordx4 v98, s[32:35], s50 offen offset:1024 lds
  buffer_load_dwordx4 v99, s[32:35], s50 offen offset:2048 lds
  buffer_load_dwordx4 v100, s[32:35], s50 offen offset:3072 lds
  s_waitcnt vmcnt(56)
  s_mov_b32 s50, 147456
  buffer_load_dwordx4 a[128:131], v105, s[28:31], s50 offen offset:0 nt
  buffer_load_dwordx4 a[132:135], v106, s[28:31], s50 offen offset:1024 nt
  buffer_load_dwordx4 a[136:139], v105, s[28:31], s50 offen offset:2048 nt
  buffer_load_dwordx4 a[140:143], v106, s[28:31], s50 offen offset:3072 nt
  s_waitcnt vmcnt(56)
  s_mov_b32 s50, 151552
  buffer_load_dwordx4 a[144:147], v105, s[28:31], s50 offen offset:0 nt
  buffer_load_dwordx4 a[148:151], v106, s[28:31], s50 offen offset:1024 nt
  buffer_load_dwordx4 a[152:155], v105, s[28:31], s50 offen offset:2048 nt
  buffer_load_dwordx4 a[156:159], v106, s[28:31], s50 offen offset:3072 nt
  s_waitcnt vmcnt(54)
  s_mov_b32 s50, 155648
  buffer_load_dwordx4 a[160:163], v105, s[28:31], s50 offen offset:0 nt
  buffer_load_dwordx4 a[164:167], v106, s[28:31], s50 offen offset:1024 nt
  buffer_load_dwordx4 a[168:171], v105, s[28:31], s50 offen offset:2048 nt
  buffer_load_dwordx4 a[172:175], v106, s[28:31], s50 offen offset:3072 nt
  s_waitcnt vmcnt(54)
  s_mov_b32 s50, 159744
  buffer_load_dwordx4 a[176:179], v105, s[28:31], s50 offen offset:0 nt
  buffer_load_dwordx4 a[180:183], v106, s[28:31], s50 offen offset:1024 nt
  buffer_load_dwordx4 a[184:187], v105, s[28:31], s50 offen offset:2048 nt
  buffer_load_dwordx4 a[188:191], v106, s[28:31], s50 offen offset:3072 nt
  s_waitcnt vmcnt(54)
  s_mov_b32 m0, 24576
  s_lshl_b32 s50, s86, 7
  buffer_load_dwordx4 v93, s[20:23], s50 offen offset:0 lds
  buffer_load_dwordx4 v94, s[20:23], s50 offen offset:1024 lds
  buffer_load_dwordx4 v95, s[20:23], s50 offen offset:2048 lds
  buffer_load_dwordx4 v96, s[20:23], s50 offen offset:3072 lds
  s_waitcnt vmcnt(54)
  s_mov_b32 m0, 28672
  s_add_u32 s50, s50, 40960
  buffer_load_dwordx4 v93, s[20:23], s50 offen offset:0 lds
  buffer_load_dwordx4 v94, s[20:23], s50 offen offset:1024 lds
  buffer_load_dwordx4 v95, s[20:23], s50 offen offset:2048 lds
  buffer_load_dwordx4 v96, s[20:23], s50 offen offset:3072 lds
  s_barrier
  s_waitcnt vmcnt(54)
  s_mov_b32 m0, 32768
  s_add_u32 s50, s50, 40960
  buffer_load_dwordx4 v93, s[20:23], s50 offen offset:0 lds
  buffer_load_dwordx4 v94, s[20:23], s50 offen offset:1024 lds
  buffer_load_dwordx4 v95, s[20:23], s50 offen offset:2048 lds
  buffer_load_dwordx4 v96, s[20:23], s50 offen offset:3072 lds
  s_waitcnt vmcnt(54)
  s_mov_b32 m0, 36864
  s_add_u32 s50, s50, 40960
  buffer_load_dwordx4 v93, s[20:23], s50 offen offset:0 lds
  buffer_load_dwordx4 v94, s[20:23], s50 offen offset:1024 lds
  buffer_load_dwordx4 v95, s[20:23], s50 offen offset:2048 lds
  buffer_load_dwordx4 v96, s[20:23], s50 offen offset:3072 lds
  s_mov_b32 m0, 40960
  s_add_u32 s50, s50, 40960
  buffer_load_dwordx4 v93, s[20:23], s50 offen offset:0 lds
  buffer_load_dwordx4 v94, s[20:23], s50 offen offset:1024 lds
  s_waitcnt vmcnt(56)
  s_mov_b32 m0, 43008
  s_lshl_b32 s50, s86, 19
  buffer_load_dwordx4 v97, s[32:35], s50 offen offset:0 lds
  buffer_load_dwordx4 v98, s[32:35], s50 offen offset:1024 lds
  buffer_load_dwordx4 v99, s[32:35], s50 offen offset:2048 lds
  buffer_load_dwordx4 v100, s[32:35], s50 offen offset:3072 lds
  s_waitcnt vmcnt(56)
  s_mov_b32 m0, 47104
  s_add_u32 s50, s50, 131072
  buffer_load_dwordx4 v97, s[32:35], s50 offen offset:0 lds
  buffer_load_dwordx4 v98, s[32:35], s50 offen offset:1024 lds
  buffer_load_dwordx4 v99, s[32:35], s50 offen offset:2048 lds
  buffer_load_dwordx4 v100, s[32:35], s50 offen offset:3072 lds
  s_waitcnt vmcnt(54)
  s_mov_b32 m0, 51200
  s_add_u32 s50, s50, 131072
  buffer_load_dwordx4 v97, s[32:35], s50 offen offset:0 lds
  buffer_load_dwordx4 v98, s[32:35], s50 offen offset:1024 lds
  buffer_load_dwordx4 v99, s[32:35], s50 offen offset:2048 lds
  buffer_load_dwordx4 v100, s[32:35], s50 offen offset:3072 lds
  s_waitcnt vmcnt(54)
  s_mov_b32 m0, 55296
  s_add_u32 s50, s50, 131072
  buffer_load_dwordx4 v97, s[32:35], s50 offen offset:0 lds
  buffer_load_dwordx4 v98, s[32:35], s50 offen offset:1024 lds
  buffer_load_dwordx4 v99, s[32:35], s50 offen offset:2048 lds
  buffer_load_dwordx4 v100, s[32:35], s50 offen offset:3072 lds
  s_waitcnt vmcnt(54)
  s_mov_b32 m0, 59392
  s_lshl_b32 s50, s87, 7
  buffer_load_dwordx4 v93, s[20:23], s50 offen offset:0 lds
  buffer_load_dwordx4 v94, s[20:23], s50 offen offset:1024 lds
  buffer_load_dwordx4 v95, s[20:23], s50 offen offset:2048 lds
  buffer_load_dwordx4 v96, s[20:23], s50 offen offset:3072 lds
  s_waitcnt vmcnt(54)
  s_mov_b32 m0, 63488
  s_add_u32 s50, s50, 40960
  buffer_load_dwordx4 v93, s[20:23], s50 offen offset:0 lds
  buffer_load_dwordx4 v94, s[20:23], s50 offen offset:1024 lds
  buffer_load_dwordx4 v95, s[20:23], s50 offen offset:2048 lds
  buffer_load_dwordx4 v96, s[20:23], s50 offen offset:3072 lds
  s_barrier
  s_waitcnt vmcnt(54)
  s_mov_b32 m0, 67584
  s_add_u32 s50, s50, 40960
  buffer_load_dwordx4 v93, s[20:23], s50 offen offset:0 lds
  buffer_load_dwordx4 v94, s[20:23], s50 offen offset:1024 lds
  buffer_load_dwordx4 v95, s[20:23], s50 offen offset:2048 lds
  buffer_load_dwordx4 v96, s[20:23], s50 offen offset:3072 lds
  s_waitcnt vmcnt(54)
  s_mov_b32 m0, 71680
  s_add_u32 s50, s50, 40960
  buffer_load_dwordx4 v93, s[20:23], s50 offen offset:0 lds
  buffer_load_dwordx4 v94, s[20:23], s50 offen offset:1024 lds
  buffer_load_dwordx4 v95, s[20:23], s50 offen offset:2048 lds
  buffer_load_dwordx4 v96, s[20:23], s50 offen offset:3072 lds
  s_mov_b32 m0, 75776
  s_add_u32 s50, s50, 40960
  buffer_load_dwordx4 v93, s[20:23], s50 offen offset:0 lds
  buffer_load_dwordx4 v94, s[20:23], s50 offen offset:1024 lds
  s_waitcnt vmcnt(56)
  s_mov_b32 m0, 77824
  s_lshl_b32 s50, s87, 19
  buffer_load_dwordx4 v97, s[32:35], s50 offen offset:0 lds
  buffer_load_dwordx4 v98, s[32:35], s50 offen offset:1024 lds
  buffer_load_dwordx4 v99, s[32:35], s50 offen offset:2048 lds
  buffer_load_dwordx4 v100, s[32:35], s50 offen offset:3072 lds
  s_waitcnt vmcnt(56)
  s_mov_b32 m0, 81920
  s_add_u32 s50, s50, 131072
  buffer_load_dwordx4 v97, s[32:35], s50 offen offset:0 lds
  buffer_load_dwordx4 v98, s[32:35], s50 offen offset:1024 lds
  buffer_load_dwordx4 v99, s[32:35], s50 offen offset:2048 lds
  buffer_load_dwordx4 v100, s[32:35], s50 offen offset:3072 lds
  s_waitcnt vmcnt(56)
  s_mov_b32 m0, 86016
  s_add_u32 s50, s50, 131072
  buffer_load_dwordx4 v97, s[32:35], s50 offen offset:0 lds
  buffer_load_dwordx4 v98, s[32:35], s50 offen offset:1024 lds
  buffer_load_dwordx4 v99, s[32:35], s50 offen offset:2048 lds
  buffer_load_dwordx4 v100, s[32:35], s50 offen offset:3072 lds
  s_waitcnt vmcnt(56)
  s_mov_b32 m0, 90112
  s_add_u32 s50, s50, 131072
  buffer_load_dwordx4 v97, s[32:35], s50 offen offset:0 lds
  buffer_load_dwordx4 v98, s[32:35], s50 offen offset:1024 lds
  buffer_load_dwordx4 v99, s[32:35], s50 offen offset:2048 lds
  buffer_load_dwordx4 v100, s[32:35], s50 offen offset:3072 lds
  s_waitcnt vmcnt(56)
  s_mov_b32 s50, 229376
  buffer_load_dwordx4 a[192:195], v101, s[24:27], s50 offen offset:0 nt
  buffer_load_dwordx4 a[196:199], v102, s[24:27], s50 offen offset:1024 nt
  buffer_load_dwordx4 a[200:203], v103, s[24:27], s50 offen offset:2048 nt
  buffer_load_dwordx4 a[204:207], v104, s[24:27], s50 offen offset:3072 nt
  s_waitcnt vmcnt(56)
  s_mov_b32 s50, 233472
  buffer_load_dwordx4 a[208:211], v101, s[24:27], s50 offen offset:0 nt
  buffer_load_dwordx4 a[212:215], v102, s[24:27], s50 offen offset:1024 nt
  buffer_load_dwordx4 a[216:219], v103, s[24:27], s50 offen offset:2048 nt
  buffer_load_dwordx4 a[220:223], v104, s[24:27], s50 offen offset:3072 nt
  s_waitcnt vmcnt(54)
  s_mov_b32 s50, 237568
  buffer_load_dwordx4 a[224:227], v101, s[24:27], s50 offen offset:0 nt
  buffer_load_dwordx4 a[228:231], v102, s[24:27], s50 offen offset:1024 nt
  buffer_load_dwordx4 a[232:235], v103, s[24:27], s50 offen offset:2048 nt
  buffer_load_dwordx4 a[236:239], v104, s[24:27], s50 offen offset:3072 nt
  s_waitcnt vmcnt(54)
  s_mov_b32 s50, 241664
  buffer_load_dwordx4 a[240:243], v101, s[24:27], s50 offen offset:0 nt
  buffer_load_dwordx4 a[244:247], v102, s[24:27], s50 offen offset:1024 nt
  buffer_load_dwordx4 a[248:251], v103, s[24:27], s50 offen offset:2048 nt
  buffer_load_dwordx4 a[252:255], v104, s[24:27], s50 offen offset:3072 nt
  s_waitcnt vmcnt(54)
  s_mov_b32 m0, 94208
  s_lshl_b32 s50, s88, 7
  buffer_load_dwordx4 v93, s[20:23], s50 offen offset:0 lds
  buffer_load_dwordx4 v94, s[20:23], s50 offen offset:1024 lds
  buffer_load_dwordx4 v95, s[20:23], s50 offen offset:2048 lds
  buffer_load_dwordx4 v96, s[20:23], s50 offen offset:3072 lds
  s_waitcnt vmcnt(54)
  s_mov_b32 m0, 98304
  s_add_u32 s50, s50, 40960
  buffer_load_dwordx4 v93, s[20:23], s50 offen offset:0 lds
  buffer_load_dwordx4 v94, s[20:23], s50 offen offset:1024 lds
  buffer_load_dwordx4 v95, s[20:23], s50 offen offset:2048 lds
  buffer_load_dwordx4 v96, s[20:23], s50 offen offset:3072 lds
  s_barrier
  s_waitcnt vmcnt(54)
  s_mov_b32 m0, 102400
  s_add_u32 s50, s50, 40960
  buffer_load_dwordx4 v93, s[20:23], s50 offen offset:0 lds
  buffer_load_dwordx4 v94, s[20:23], s50 offen offset:1024 lds
  buffer_load_dwordx4 v95, s[20:23], s50 offen offset:2048 lds
  buffer_load_dwordx4 v96, s[20:23], s50 offen offset:3072 lds
  s_waitcnt vmcnt(54)
  s_mov_b32 m0, 106496
  s_add_u32 s50, s50, 40960
  buffer_load_dwordx4 v93, s[20:23], s50 offen offset:0 lds
  buffer_load_dwordx4 v94, s[20:23], s50 offen offset:1024 lds
  buffer_load_dwordx4 v95, s[20:23], s50 offen offset:2048 lds
  buffer_load_dwordx4 v96, s[20:23], s50 offen offset:3072 lds
  s_mov_b32 m0, 110592
  s_add_u32 s50, s50, 40960
  buffer_load_dwordx4 v93, s[20:23], s50 offen offset:0 lds
  buffer_load_dwordx4 v94, s[20:23], s50 offen offset:1024 lds
  s_waitcnt vmcnt(56)
  s_mov_b32 m0, 112640
  s_lshl_b32 s50, s88, 19
  buffer_load_dwordx4 v97, s[32:35], s50 offen offset:0 lds
  buffer_load_dwordx4 v98, s[32:35], s50 offen offset:1024 lds
  buffer_load_dwordx4 v99, s[32:35], s50 offen offset:2048 lds
  buffer_load_dwordx4 v100, s[32:35], s50 offen offset:3072 lds
  s_waitcnt vmcnt(56)
  s_mov_b32 m0, 116736
  s_add_u32 s50, s50, 131072
  buffer_load_dwordx4 v97, s[32:35], s50 offen offset:0 lds
  buffer_load_dwordx4 v98, s[32:35], s50 offen offset:1024 lds
  buffer_load_dwordx4 v99, s[32:35], s50 offen offset:2048 lds
  buffer_load_dwordx4 v100, s[32:35], s50 offen offset:3072 lds
  s_waitcnt vmcnt(54)
  s_mov_b32 m0, 120832
  s_add_u32 s50, s50, 131072
  buffer_load_dwordx4 v97, s[32:35], s50 offen offset:0 lds
  buffer_load_dwordx4 v98, s[32:35], s50 offen offset:1024 lds
  buffer_load_dwordx4 v99, s[32:35], s50 offen offset:2048 lds
  buffer_load_dwordx4 v100, s[32:35], s50 offen offset:3072 lds
  s_waitcnt vmcnt(54)
  s_mov_b32 m0, 124928
  s_add_u32 s50, s50, 131072
  buffer_load_dwordx4 v97, s[32:35], s50 offen offset:0 lds
  buffer_load_dwordx4 v98, s[32:35], s50 offen offset:1024 lds
  buffer_load_dwordx4 v99, s[32:35], s50 offen offset:2048 lds
  buffer_load_dwordx4 v100, s[32:35], s50 offen offset:3072 lds
  s_waitcnt vmcnt(54)
  s_mov_b32 m0, 129024
  s_lshl_b32 s50, s89, 7
  buffer_load_dwordx4 v93, s[20:23], s50 offen offset:0 lds
  buffer_load_dwordx4 v94, s[20:23], s50 offen offset:1024 lds
  buffer_load_dwordx4 v95, s[20:23], s50 offen offset:2048 lds
  buffer_load_dwordx4 v96, s[20:23], s50 offen offset:3072 lds
  s_waitcnt vmcnt(54)
  s_mov_b32 m0, 133120
  s_add_u32 s50, s50, 40960
  buffer_load_dwordx4 v93, s[20:23], s50 offen offset:0 lds
  buffer_load_dwordx4 v94, s[20:23], s50 offen offset:1024 lds
  buffer_load_dwordx4 v95, s[20:23], s50 offen offset:2048 lds
  buffer_load_dwordx4 v96, s[20:23], s50 offen offset:3072 lds
  s_barrier
  s_waitcnt vmcnt(54)
  s_mov_b32 m0, 137216
  s_add_u32 s50, s50, 40960
  buffer_load_dwordx4 v93, s[20:23], s50 offen offset:0 lds
  buffer_load_dwordx4 v94, s[20:23], s50 offen offset:1024 lds
  buffer_load_dwordx4 v95, s[20:23], s50 offen offset:2048 lds
  buffer_load_dwordx4 v96, s[20:23], s50 offen offset:3072 lds
  s_waitcnt vmcnt(54)
  s_mov_b32 m0, 141312
  s_add_u32 s50, s50, 40960
  buffer_load_dwordx4 v93, s[20:23], s50 offen offset:0 lds
  buffer_load_dwordx4 v94, s[20:23], s50 offen offset:1024 lds
  buffer_load_dwordx4 v95, s[20:23], s50 offen offset:2048 lds
  buffer_load_dwordx4 v96, s[20:23], s50 offen offset:3072 lds
  s_mov_b32 m0, 145408
  s_add_u32 s50, s50, 40960
  buffer_load_dwordx4 v93, s[20:23], s50 offen offset:0 lds
  buffer_load_dwordx4 v94, s[20:23], s50 offen offset:1024 lds
  s_waitcnt vmcnt(56)
  s_mov_b32 m0, 147456
  s_lshl_b32 s50, s89, 19
  buffer_load_dwordx4 v97, s[32:35], s50 offen offset:0 lds
  buffer_load_dwordx4 v98, s[32:35], s50 offen offset:1024 lds
  buffer_load_dwordx4 v99, s[32:35], s50 offen offset:2048 lds
  buffer_load_dwordx4 v100, s[32:35], s50 offen offset:3072 lds
  s_waitcnt vmcnt(56)
  s_mov_b32 m0, 151552
  s_add_u32 s50, s50, 131072
  buffer_load_dwordx4 v97, s[32:35], s50 offen offset:0 lds
  buffer_load_dwordx4 v98, s[32:35], s50 offen offset:1024 lds
  buffer_load_dwordx4 v99, s[32:35], s50 offen offset:2048 lds
  buffer_load_dwordx4 v100, s[32:35], s50 offen offset:3072 lds
  s_waitcnt vmcnt(56)
  s_mov_b32 m0, 155648
  s_add_u32 s50, s50, 131072
  buffer_load_dwordx4 v97, s[32:35], s50 offen offset:0 lds
  buffer_load_dwordx4 v98, s[32:35], s50 offen offset:1024 lds
  buffer_load_dwordx4 v99, s[32:35], s50 offen offset:2048 lds
  buffer_load_dwordx4 v100, s[32:35], s50 offen offset:3072 lds
  s_waitcnt vmcnt(56)
  s_mov_b32 m0, 159744
  s_add_u32 s50, s50, 131072
  buffer_load_dwordx4 v97, s[32:35], s50 offen offset:0 lds
  buffer_load_dwordx4 v98, s[32:35], s50 offen offset:1024 lds
  buffer_load_dwordx4 v99, s[32:35], s50 offen offset:2048 lds
  buffer_load_dwordx4 v100, s[32:35], s50 offen offset:3072 lds
  s_waitcnt vmcnt(56)
  s_mov_b32 m0, 0
  s_mov_b32 s50, 0
  buffer_load_dwordx4 v101, s[24:27], s50 offen offset:0 nt lds
  buffer_load_dwordx4 v102, s[24:27], s50 offen offset:1024 nt lds
  buffer_load_dwordx4 v103, s[24:27], s50 offen offset:2048 nt lds
  buffer_load_dwordx4 v104, s[24:27], s50 offen offset:3072 nt lds
  s_waitcnt vmcnt(56)
  s_mov_b32 m0, 4096
  s_mov_b32 s50, 4096
  buffer_load_dwordx4 v101, s[24:27], s50 offen offset:0 nt lds
  buffer_load_dwordx4 v102, s[24:27], s50 offen offset:1024 nt lds
  buffer_load_dwordx4 v103, s[24:27], s50 offen offset:2048 nt lds
  buffer_load_dwordx4 v104, s[24:27], s50 offen offset:3072 nt lds
  s_waitcnt vmcnt(54)
  s_mov_b32 m0, 8192
  s_mov_b32 s50, 8192
  buffer_load_dwordx4 v101, s[24:27], s50 offen offset:0 nt lds
  buffer_load_dwordx4 v102, s[24:27], s50 offen offset:1024 nt lds
  buffer_load_dwordx4 v103, s[24:27], s50 offen offset:2048 nt lds
  buffer_load_dwordx4 v104, s[24:27], s50 offen offset:3072 nt lds
  s_waitcnt vmcnt(54)
  s_mov_b32 m0, 12288
  s_mov_b32 s50, 12288
  buffer_load_dwordx4 v101, s[24:27], s50 offen offset:0 nt lds
  buffer_load_dwordx4 v102, s[24:27], s50 offen offset:1024 nt lds
  buffer_load_dwordx4 v103, s[24:27], s50 offen offset:2048 nt lds
  buffer_load_dwordx4 v104, s[24:27], s50 offen offset:3072 nt lds
  s_waitcnt vmcnt(54)
  s_waitcnt vmcnt(50)
  s_barrier
  s_waitcnt vmcnt(46)
  s_waitcnt vmcnt(42)
  s_waitcnt vmcnt(38)
  s_waitcnt vmcnt(34)
  s_waitcnt vmcnt(28)
  s_waitcnt vmcnt(24)
  s_mov_b32 m0, 16384
  s_mov_b32 s50, 16384
  buffer_load_dwordx4 v101, s[24:27], s50 offen offset:0 nt lds
  buffer_load_dwordx4 v102, s[24:27], s50 offen offset:1024 nt lds
  buffer_load_dwordx4 v103, s[24:27], s50 offen offset:2048 nt lds
  buffer_load_dwordx4 v104, s[24:27], s50 offen offset:3072 nt lds
  s_waitcnt vmcnt(24)
  s_mov_b32 m0, 20480
  s_mov_b32 s50, 20480
  buffer_load_dwordx4 v101, s[24:27], s50 offen offset:0 nt lds
  buffer_load_dwordx4 v102, s[24:27], s50 offen offset:1024 nt lds
  buffer_load_dwordx4 v103, s[24:27], s50 offen offset:2048 nt lds
  buffer_load_dwordx4 v104, s[24:27], s50 offen offset:3072 nt lds
  s_waitcnt vmcnt(24)
  s_mov_b32 m0, 24576
  s_mov_b32 s50, 24576
  buffer_load_dwordx4 v101, s[24:27], s50 offen offset:0 nt lds
  buffer_load_dwordx4 v102, s[24:27], s50 offen offset:1024 nt lds
  buffer_load_dwordx4 v103, s[24:27], s50 offen offset:2048 nt lds
  buffer_load_dwordx4 v104, s[24:27], s50 offen offset:3072 nt lds
  s_barrier
L_HJ_standalone__gqa_block_cached__near_ridge_kernel:
  ds_write_b128 v117, a[0:3] offset:32768
  ds_write_b128 v117, a[4:7] offset:33792
  ds_write_b128 v117, a[8:11] offset:34816
  ds_write_b128 v117, a[12:15] offset:35840
  ds_write_b128 v117, a[16:19] offset:36864
  ds_write_b128 v117, a[20:23] offset:37888
  ds_write_b128 v117, a[24:27] offset:38912
  ds_write_b128 v117, a[28:31] offset:39936
  s_waitcnt vmcnt(24)
  s_mov_b32 m0, 28672
  s_mov_b32 s50, 28672
  buffer_load_dwordx4 v101, s[24:27], s50 offen offset:0 nt lds
  buffer_load_dwordx4 v102, s[24:27], s50 offen offset:1024 nt lds
  buffer_load_dwordx4 v103, s[24:27], s50 offen offset:2048 nt lds
  buffer_load_dwordx4 v104, s[24:27], s50 offen offset:3072 nt lds
  s_waitcnt vmcnt(24)
  s_mov_b32 m0, 65536
  s_mov_b32 s50, 0
  buffer_load_dwordx4 v105, s[28:31], s50 offen offset:0 nt lds
  buffer_load_dwordx4 v106, s[28:31], s50 offen offset:1024 nt lds
  buffer_load_dwordx4 v105, s[28:31], s50 offen offset:2048 nt lds
  buffer_load_dwordx4 v106, s[28:31], s50 offen offset:3072 nt lds
  s_waitcnt vmcnt(24)
  s_mov_b32 m0, 69632
  s_mov_b32 s50, 4096
  buffer_load_dwordx4 v105, s[28:31], s50 offen offset:0 nt lds
  buffer_load_dwordx4 v106, s[28:31], s50 offen offset:1024 nt lds
  buffer_load_dwordx4 v105, s[28:31], s50 offen offset:2048 nt lds
  buffer_load_dwordx4 v106, s[28:31], s50 offen offset:3072 nt lds
  s_waitcnt vmcnt(24)
  s_mov_b32 m0, 73728
  s_mov_b32 s50, 8192
  buffer_load_dwordx4 v105, s[28:31], s50 offen offset:0 nt lds
  buffer_load_dwordx4 v106, s[28:31], s50 offen offset:1024 nt lds
  buffer_load_dwordx4 v105, s[28:31], s50 offen offset:2048 nt lds
  buffer_load_dwordx4 v106, s[28:31], s50 offen offset:3072 nt lds
  s_barrier
  s_add_u32 s80, s3, 0
  s_and_b32 s80, s80, 3
  s_mul_i32 s80, s80, 1310720
  s_add_u32 s81, s3, 1
  s_and_b32 s81, s81, 3
  s_mul_i32 s81, s81, 1310720
  s_add_u32 s82, s3, 2
  s_and_b32 s82, s82, 3
  s_mul_i32 s82, s82, 1310720
  s_add_u32 s83, s3, 3
  s_and_b32 s83, s83, 3
  s_mul_i32 s83, s83, 1310720
  ds_write_b128 v117, a[32:35] offset:40960
  ds_write_b128 v117, a[36:39] offset:41984
  ds_write_b128 v117, a[40:43] offset:43008
  ds_write_b128 v117, a[44:47] offset:44032
  ds_write_b128 v117, a[48:51] offset:45056
  ds_write_b128 v117, a[52:55] offset:46080
  ds_write_b128 v117, a[56:59] offset:47104
  ds_write_b128 v117, a[60:63] offset:48128
  s_waitcnt vmcnt(24)
  s_mov_b32 m0, 77824
  s_mov_b32 s50, 12288
  buffer_load_dwordx4 v105, s[28:31], s50 offen offset:0 nt lds
  buffer_load_dwordx4 v106, s[28:31], s50 offen offset:1024 nt lds
  buffer_load_dwordx4 v105, s[28:31], s50 offen offset:2048 nt lds
  buffer_load_dwordx4 v106, s[28:31], s50 offen offset:3072 nt lds
  s_waitcnt vmcnt(24)
  s_mov_b32 m0, 32768
  s_mov_b32 s50, 32768
  buffer_load_dwordx4 v101, s[24:27], s50 offen offset:0 nt lds
  buffer_load_dwordx4 v102, s[24:27], s50 offen offset:1024 nt lds
  buffer_load_dwordx4 v103, s[24:27], s50 offen offset:2048 nt lds
  buffer_load_dwordx4 v104, s[24:27], s50 offen offset:3072 nt lds
  s_waitcnt vmcnt(24)
  s_mov_b32 m0, 36864
  s_mov_b32 s50, 36864
  buffer_load_dwordx4 v101, s[24:27], s50 offen offset:0 nt lds
  buffer_load_dwordx4 v102, s[24:27], s50 offen offset:1024 nt lds
  buffer_load_dwordx4 v103, s[24:27], s50 offen offset:2048 nt lds
  buffer_load_dwordx4 v104, s[24:27], s50 offen offset:3072 nt lds
  s_waitcnt vmcnt(24)
  s_mov_b32 m0, 40960
  s_mov_b32 s50, 40960
  buffer_load_dwordx4 v101, s[24:27], s50 offen offset:0 nt lds
  buffer_load_dwordx4 v102, s[24:27], s50 offen offset:1024 nt lds
  buffer_load_dwordx4 v103, s[24:27], s50 offen offset:2048 nt lds
  buffer_load_dwordx4 v104, s[24:27], s50 offen offset:3072 nt lds
  s_waitcnt vmcnt(24)
  s_mov_b32 m0, 45056
  s_mov_b32 s50, 45056
  buffer_load_dwordx4 v101, s[24:27], s50 offen offset:0 nt lds
  buffer_load_dwordx4 v102, s[24:27], s50 offen offset:1024 nt lds
  buffer_load_dwordx4 v103, s[24:27], s50 offen offset:2048 nt lds
  buffer_load_dwordx4 v104, s[24:27], s50 offen offset:3072 nt lds
  s_waitcnt vmcnt(24)
  s_mov_b32 m0, 81920
  s_mov_b32 s50, 16384
  buffer_load_dwordx4 v105, s[28:31], s50 offen offset:0 nt lds
  buffer_load_dwordx4 v106, s[28:31], s50 offen offset:1024 nt lds
  buffer_load_dwordx4 v105, s[28:31], s50 offen offset:2048 nt lds
  buffer_load_dwordx4 v106, s[28:31], s50 offen offset:3072 nt lds
  s_waitcnt vmcnt(24)
  s_mov_b32 m0, 86016
  s_mov_b32 s50, 20480
  buffer_load_dwordx4 v105, s[28:31], s50 offen offset:0 nt lds
  buffer_load_dwordx4 v106, s[28:31], s50 offen offset:1024 nt lds
  buffer_load_dwordx4 v105, s[28:31], s50 offen offset:2048 nt lds
  buffer_load_dwordx4 v106, s[28:31], s50 offen offset:3072 nt lds
  s_waitcnt vmcnt(24)
  s_mov_b32 m0, 90112
  s_mov_b32 s50, 24576
  buffer_load_dwordx4 v105, s[28:31], s50 offen offset:0 nt lds
  buffer_load_dwordx4 v106, s[28:31], s50 offen offset:1024 nt lds
  buffer_load_dwordx4 v105, s[28:31], s50 offen offset:2048 nt lds
  buffer_load_dwordx4 v106, s[28:31], s50 offen offset:3072 nt lds
  s_barrier
  s_waitcnt vmcnt(24)
  s_mov_b32 m0, 94208
  s_mov_b32 s50, 28672
  buffer_load_dwordx4 v105, s[28:31], s50 offen offset:0 nt lds
  buffer_load_dwordx4 v106, s[28:31], s50 offen offset:1024 nt lds
  buffer_load_dwordx4 v105, s[28:31], s50 offen offset:2048 nt lds
  buffer_load_dwordx4 v106, s[28:31], s50 offen offset:3072 nt lds
  s_waitcnt vmcnt(24)
  s_mov_b32 m0, 49152
  s_mov_b32 s50, 49152
  buffer_load_dwordx4 v101, s[24:27], s50 offen offset:0 nt lds
  buffer_load_dwordx4 v102, s[24:27], s50 offen offset:1024 nt lds
  buffer_load_dwordx4 v103, s[24:27], s50 offen offset:2048 nt lds
  buffer_load_dwordx4 v104, s[24:27], s50 offen offset:3072 nt lds
  s_waitcnt vmcnt(24)
  s_mov_b32 m0, 53248
  s_mov_b32 s50, 53248
  buffer_load_dwordx4 v101, s[24:27], s50 offen offset:0 nt lds
  buffer_load_dwordx4 v102, s[24:27], s50 offen offset:1024 nt lds
  buffer_load_dwordx4 v103, s[24:27], s50 offen offset:2048 nt lds
  buffer_load_dwordx4 v104, s[24:27], s50 offen offset:3072 nt lds
  s_waitcnt vmcnt(24)
  s_mov_b32 m0, 57344
  s_mov_b32 s50, 57344
  buffer_load_dwordx4 v101, s[24:27], s50 offen offset:0 nt lds
  buffer_load_dwordx4 v102, s[24:27], s50 offen offset:1024 nt lds
  buffer_load_dwordx4 v103, s[24:27], s50 offen offset:2048 nt lds
  buffer_load_dwordx4 v104, s[24:27], s50 offen offset:3072 nt lds
  s_waitcnt vmcnt(24)
  s_mov_b32 m0, 61440
  s_mov_b32 s50, 61440
  buffer_load_dwordx4 v101, s[24:27], s50 offen offset:0 nt lds
  buffer_load_dwordx4 v102, s[24:27], s50 offen offset:1024 nt lds
  buffer_load_dwordx4 v103, s[24:27], s50 offen offset:2048 nt lds
  buffer_load_dwordx4 v104, s[24:27], s50 offen offset:3072 nt lds
  s_waitcnt vmcnt(24)
  s_mov_b32 m0, 0
  s_mov_b32 s50, 65536
  buffer_load_dwordx4 v101, s[24:27], s50 offen offset:0 nt lds
  buffer_load_dwordx4 v102, s[24:27], s50 offen offset:1024 nt lds
  buffer_load_dwordx4 v103, s[24:27], s50 offen offset:2048 nt lds
  buffer_load_dwordx4 v104, s[24:27], s50 offen offset:3072 nt lds
  s_waitcnt vmcnt(24)
  s_mov_b32 m0, 4096
  s_mov_b32 s50, 69632
  buffer_load_dwordx4 v101, s[24:27], s50 offen offset:0 nt lds
  buffer_load_dwordx4 v102, s[24:27], s50 offen offset:1024 nt lds
  buffer_load_dwordx4 v103, s[24:27], s50 offen offset:2048 nt lds
  buffer_load_dwordx4 v104, s[24:27], s50 offen offset:3072 nt lds
  s_waitcnt vmcnt(24)
  s_mov_b32 m0, 8192
  s_mov_b32 s50, 73728
  buffer_load_dwordx4 v101, s[24:27], s50 offen offset:0 nt lds
  buffer_load_dwordx4 v102, s[24:27], s50 offen offset:1024 nt lds
  buffer_load_dwordx4 v103, s[24:27], s50 offen offset:2048 nt lds
  buffer_load_dwordx4 v104, s[24:27], s50 offen offset:3072 nt lds
  s_barrier
  s_waitcnt vmcnt(24)
  s_mov_b32 m0, 12288
  s_mov_b32 s50, 77824
  buffer_load_dwordx4 v101, s[24:27], s50 offen offset:0 nt lds
  buffer_load_dwordx4 v102, s[24:27], s50 offen offset:1024 nt lds
  buffer_load_dwordx4 v103, s[24:27], s50 offen offset:2048 nt lds
  buffer_load_dwordx4 v104, s[24:27], s50 offen offset:3072 nt lds
  s_waitcnt vmcnt(24)
  s_mov_b32 m0, 114688
  s_mov_b32 s50, 49152
  buffer_load_dwordx4 v105, s[28:31], s50 offen offset:0 nt lds
  buffer_load_dwordx4 v106, s[28:31], s50 offen offset:1024 nt lds
  buffer_load_dwordx4 v105, s[28:31], s50 offen offset:2048 nt lds
  buffer_load_dwordx4 v106, s[28:31], s50 offen offset:3072 nt lds
  s_waitcnt vmcnt(24)
  s_mov_b32 m0, 118784
  s_mov_b32 s50, 53248
  buffer_load_dwordx4 v105, s[28:31], s50 offen offset:0 nt lds
  buffer_load_dwordx4 v106, s[28:31], s50 offen offset:1024 nt lds
  buffer_load_dwordx4 v105, s[28:31], s50 offen offset:2048 nt lds
  buffer_load_dwordx4 v106, s[28:31], s50 offen offset:3072 nt lds
  s_waitcnt vmcnt(24)
  s_mov_b32 m0, 122880
  s_mov_b32 s50, 57344
  buffer_load_dwordx4 v105, s[28:31], s50 offen offset:0 nt lds
  buffer_load_dwordx4 v106, s[28:31], s50 offen offset:1024 nt lds
  buffer_load_dwordx4 v105, s[28:31], s50 offen offset:2048 nt lds
  buffer_load_dwordx4 v106, s[28:31], s50 offen offset:3072 nt lds
  s_waitcnt lgkmcnt(0)
  s_barrier
  s_waitcnt vmcnt(24)
  s_mov_b32 m0, 126976
  s_mov_b32 s50, 61440
  buffer_load_dwordx4 v105, s[28:31], s50 offen offset:0 nt lds
  buffer_load_dwordx4 v106, s[28:31], s50 offen offset:1024 nt lds
  buffer_load_dwordx4 v105, s[28:31], s50 offen offset:2048 nt lds
  buffer_load_dwordx4 v106, s[28:31], s50 offen offset:3072 nt lds
  s_waitcnt vmcnt(24)
  s_mov_b32 m0, 16384
  s_mov_b32 s50, 81920
  buffer_load_dwordx4 v101, s[24:27], s50 offen offset:0 nt lds
  buffer_load_dwordx4 v102, s[24:27], s50 offen offset:1024 nt lds
  buffer_load_dwordx4 v103, s[24:27], s50 offen offset:2048 nt lds
  buffer_load_dwordx4 v104, s[24:27], s50 offen offset:3072 nt lds
  s_waitcnt vmcnt(24)
  s_mov_b32 m0, 20480
  s_mov_b32 s50, 86016
  buffer_load_dwordx4 v101, s[24:27], s50 offen offset:0 nt lds
  buffer_load_dwordx4 v102, s[24:27], s50 offen offset:1024 nt lds
  buffer_load_dwordx4 v103, s[24:27], s50 offen offset:2048 nt lds
  buffer_load_dwordx4 v104, s[24:27], s50 offen offset:3072 nt lds
  s_waitcnt vmcnt(24)
  s_mov_b32 m0, 24576
  s_mov_b32 s50, 90112
  buffer_load_dwordx4 v101, s[24:27], s50 offen offset:0 nt lds
  buffer_load_dwordx4 v102, s[24:27], s50 offen offset:1024 nt lds
  buffer_load_dwordx4 v103, s[24:27], s50 offen offset:2048 nt lds
  buffer_load_dwordx4 v104, s[24:27], s50 offen offset:3072 nt lds
  s_waitcnt vmcnt(24)
  s_mov_b32 m0, 28672
  s_mov_b32 s50, 94208
  buffer_load_dwordx4 v101, s[24:27], s50 offen offset:0 nt lds
  buffer_load_dwordx4 v102, s[24:27], s50 offen offset:1024 nt lds
  buffer_load_dwordx4 v103, s[24:27], s50 offen offset:2048 nt lds
  buffer_load_dwordx4 v104, s[24:27], s50 offen offset:3072 nt lds
  s_waitcnt vmcnt(24)
  s_mov_b32 m0, 65536
  s_mov_b32 s50, 65536
  buffer_load_dwordx4 v105, s[28:31], s50 offen offset:0 nt lds
  buffer_load_dwordx4 v106, s[28:31], s50 offen offset:1024 nt lds
  buffer_load_dwordx4 v105, s[28:31], s50 offen offset:2048 nt lds
  buffer_load_dwordx4 v106, s[28:31], s50 offen offset:3072 nt lds
  s_waitcnt vmcnt(24)
  s_mov_b32 m0, 69632
  s_mov_b32 s50, 69632
  buffer_load_dwordx4 v105, s[28:31], s50 offen offset:0 nt lds
  buffer_load_dwordx4 v106, s[28:31], s50 offen offset:1024 nt lds
  buffer_load_dwordx4 v105, s[28:31], s50 offen offset:2048 nt lds
  buffer_load_dwordx4 v106, s[28:31], s50 offen offset:3072 nt lds
  s_waitcnt vmcnt(24)
  s_mov_b32 m0, 73728
  s_mov_b32 s50, 73728
  buffer_load_dwordx4 v105, s[28:31], s50 offen offset:0 nt lds
  buffer_load_dwordx4 v106, s[28:31], s50 offen offset:1024 nt lds
  buffer_load_dwordx4 v105, s[28:31], s50 offen offset:2048 nt lds
  buffer_load_dwordx4 v106, s[28:31], s50 offen offset:3072 nt lds
  s_barrier
  ds_write_b128 v116, a[64:67] offset:49152
  ds_write_b128 v116, a[68:71] offset:50176
  ds_write_b128 v116, a[72:75] offset:51200
  ds_write_b128 v116, a[76:79] offset:52224
  ds_write_b128 v116, a[80:83] offset:53248
  ds_write_b128 v116, a[84:87] offset:54272
  ds_write_b128 v116, a[88:91] offset:55296
  ds_write_b128 v116, a[92:95] offset:56320
  s_waitcnt vmcnt(24)
  s_mov_b32 m0, 77824
  s_mov_b32 s50, 77824
  buffer_load_dwordx4 v105, s[28:31], s50 offen offset:0 nt lds
  buffer_load_dwordx4 v106, s[28:31], s50 offen offset:1024 nt lds
  buffer_load_dwordx4 v105, s[28:31], s50 offen offset:2048 nt lds
  buffer_load_dwordx4 v106, s[28:31], s50 offen offset:3072 nt lds
  s_waitcnt vmcnt(24)
  s_mov_b32 m0, 32768
  s_mov_b32 s50, 98304
  buffer_load_dwordx4 v101, s[24:27], s50 offen offset:0 nt lds
  buffer_load_dwordx4 v102, s[24:27], s50 offen offset:1024 nt lds
  buffer_load_dwordx4 v103, s[24:27], s50 offen offset:2048 nt lds
  buffer_load_dwordx4 v104, s[24:27], s50 offen offset:3072 nt lds
  s_waitcnt vmcnt(24)
  s_mov_b32 m0, 36864
  s_mov_b32 s50, 102400
  buffer_load_dwordx4 v101, s[24:27], s50 offen offset:0 nt lds
  buffer_load_dwordx4 v102, s[24:27], s50 offen offset:1024 nt lds
  buffer_load_dwordx4 v103, s[24:27], s50 offen offset:2048 nt lds
  buffer_load_dwordx4 v104, s[24:27], s50 offen offset:3072 nt lds
  s_waitcnt vmcnt(24)
  s_mov_b32 m0, 40960
  s_mov_b32 s50, 106496
  buffer_load_dwordx4 v101, s[24:27], s50 offen offset:0 nt lds
  buffer_load_dwordx4 v102, s[24:27], s50 offen offset:1024 nt lds
  buffer_load_dwordx4 v103, s[24:27], s50 offen offset:2048 nt lds
  buffer_load_dwordx4 v104, s[24:27], s50 offen offset:3072 nt lds
  s_waitcnt vmcnt(24)
  s_mov_b32 m0, 45056
  s_mov_b32 s50, 110592
  buffer_load_dwordx4 v101, s[24:27], s50 offen offset:0 nt lds
  buffer_load_dwordx4 v102, s[24:27], s50 offen offset:1024 nt lds
  buffer_load_dwordx4 v103, s[24:27], s50 offen offset:2048 nt lds
  buffer_load_dwordx4 v104, s[24:27], s50 offen offset:3072 nt lds
  s_waitcnt vmcnt(24)
  s_mov_b32 m0, 81920
  s_mov_b32 s50, 81920
  buffer_load_dwordx4 v105, s[28:31], s50 offen offset:0 nt lds
  buffer_load_dwordx4 v106, s[28:31], s50 offen offset:1024 nt lds
  buffer_load_dwordx4 v105, s[28:31], s50 offen offset:2048 nt lds
  buffer_load_dwordx4 v106, s[28:31], s50 offen offset:3072 nt lds
  s_waitcnt vmcnt(24)
  s_mov_b32 m0, 86016
  s_mov_b32 s50, 86016
  buffer_load_dwordx4 v105, s[28:31], s50 offen offset:0 nt lds
  buffer_load_dwordx4 v106, s[28:31], s50 offen offset:1024 nt lds
  buffer_load_dwordx4 v105, s[28:31], s50 offen offset:2048 nt lds
  buffer_load_dwordx4 v106, s[28:31], s50 offen offset:3072 nt lds
  s_waitcnt vmcnt(24)
  s_mov_b32 m0, 90112
  s_mov_b32 s50, 90112
  buffer_load_dwordx4 v105, s[28:31], s50 offen offset:0 nt lds
  buffer_load_dwordx4 v106, s[28:31], s50 offen offset:1024 nt lds
  buffer_load_dwordx4 v105, s[28:31], s50 offen offset:2048 nt lds
  buffer_load_dwordx4 v106, s[28:31], s50 offen offset:3072 nt lds
  s_barrier
  ds_write_b128 v116, a[96:99] offset:57344
  ds_write_b128 v116, a[100:103] offset:58368
  ds_write_b128 v116, a[104:107] offset:59392
  ds_write_b128 v116, a[108:111] offset:60416
  ds_write_b128 v116, a[112:115] offset:61440
  ds_write_b128 v116, a[116:119] offset:62464
  ds_write_b128 v116, a[120:123] offset:63488
  ds_write_b128 v116, a[124:127] offset:64512
  s_waitcnt vmcnt(24)
  s_mov_b32 m0, 94208
  s_mov_b32 s50, 94208
  buffer_load_dwordx4 v105, s[28:31], s50 offen offset:0 nt lds
  buffer_load_dwordx4 v106, s[28:31], s50 offen offset:1024 nt lds
  buffer_load_dwordx4 v105, s[28:31], s50 offen offset:2048 nt lds
  buffer_load_dwordx4 v106, s[28:31], s50 offen offset:3072 nt lds
  s_waitcnt vmcnt(24)
  s_mov_b32 m0, 98304
  s_mov_b32 s50, 98304
  buffer_load_dwordx4 v105, s[28:31], s50 offen offset:0 nt lds
  buffer_load_dwordx4 v106, s[28:31], s50 offen offset:1024 nt lds
  buffer_load_dwordx4 v105, s[28:31], s50 offen offset:2048 nt lds
  buffer_load_dwordx4 v106, s[28:31], s50 offen offset:3072 nt lds
  s_waitcnt vmcnt(24)
  s_mov_b32 m0, 102400
  s_mov_b32 s50, 102400
  buffer_load_dwordx4 v105, s[28:31], s50 offen offset:0 nt lds
  buffer_load_dwordx4 v106, s[28:31], s50 offen offset:1024 nt lds
  buffer_load_dwordx4 v105, s[28:31], s50 offen offset:2048 nt lds
  buffer_load_dwordx4 v106, s[28:31], s50 offen offset:3072 nt lds
  s_waitcnt vmcnt(24)
  s_mov_b32 m0, 106496
  s_mov_b32 s50, 106496
  buffer_load_dwordx4 v105, s[28:31], s50 offen offset:0 nt lds
  buffer_load_dwordx4 v106, s[28:31], s50 offen offset:1024 nt lds
  buffer_load_dwordx4 v105, s[28:31], s50 offen offset:2048 nt lds
  buffer_load_dwordx4 v106, s[28:31], s50 offen offset:3072 nt lds
  s_waitcnt vmcnt(24)
  s_mov_b32 m0, 110592
  s_mov_b32 s50, 110592
  buffer_load_dwordx4 v105, s[28:31], s50 offen offset:0 nt lds
  buffer_load_dwordx4 v106, s[28:31], s50 offen offset:1024 nt lds
  buffer_load_dwordx4 v105, s[28:31], s50 offen offset:2048 nt lds
  buffer_load_dwordx4 v106, s[28:31], s50 offen offset:3072 nt lds
  s_waitcnt vmcnt(24)
  s_mov_b32 m0, 0
  s_mov_b32 s50, 131072
  buffer_load_dwordx4 v101, s[24:27], s50 offen offset:0 nt lds
  buffer_load_dwordx4 v102, s[24:27], s50 offen offset:1024 nt lds
  buffer_load_dwordx4 v103, s[24:27], s50 offen offset:2048 nt lds
  buffer_load_dwordx4 v104, s[24:27], s50 offen offset:3072 nt lds
  s_waitcnt vmcnt(24)
  s_mov_b32 m0, 4096
  s_mov_b32 s50, 135168
  buffer_load_dwordx4 v101, s[24:27], s50 offen offset:0 nt lds
  buffer_load_dwordx4 v102, s[24:27], s50 offen offset:1024 nt lds
  buffer_load_dwordx4 v103, s[24:27], s50 offen offset:2048 nt lds
  buffer_load_dwordx4 v104, s[24:27], s50 offen offset:3072 nt lds
  s_waitcnt vmcnt(24)
  s_mov_b32 m0, 8192
  s_mov_b32 s50, 139264
  buffer_load_dwordx4 v101, s[24:27], s50 offen offset:0 nt lds
  buffer_load_dwordx4 v102, s[24:27], s50 offen offset:1024 nt lds
  buffer_load_dwordx4 v103, s[24:27], s50 offen offset:2048 nt lds
  buffer_load_dwordx4 v104, s[24:27], s50 offen offset:3072 nt lds
  s_barrier
  s_waitcnt vmcnt(24)
  s_mov_b32 m0, 12288
  s_mov_b32 s50, 143360
  buffer_load_dwordx4 v101, s[24:27], s50 offen offset:0 nt lds
  buffer_load_dwordx4 v102, s[24:27], s50 offen offset:1024 nt lds
  buffer_load_dwordx4 v103, s[24:27], s50 offen offset:2048 nt lds
  buffer_load_dwordx4 v104, s[24:27], s50 offen offset:3072 nt lds
  s_waitcnt vmcnt(24)
  s_mov_b32 m0, 114688
  s_mov_b32 s50, 114688
  buffer_load_dwordx4 v105, s[28:31], s50 offen offset:0 nt lds
  buffer_load_dwordx4 v106, s[28:31], s50 offen offset:1024 nt lds
  buffer_load_dwordx4 v105, s[28:31], s50 offen offset:2048 nt lds
  buffer_load_dwordx4 v106, s[28:31], s50 offen offset:3072 nt lds
  s_waitcnt vmcnt(24)
  s_mov_b32 m0, 118784
  s_mov_b32 s50, 118784
  buffer_load_dwordx4 v105, s[28:31], s50 offen offset:0 nt lds
  buffer_load_dwordx4 v106, s[28:31], s50 offen offset:1024 nt lds
  buffer_load_dwordx4 v105, s[28:31], s50 offen offset:2048 nt lds
  buffer_load_dwordx4 v106, s[28:31], s50 offen offset:3072 nt lds
  s_waitcnt vmcnt(24)
  s_mov_b32 m0, 122880
  s_mov_b32 s50, 122880
  buffer_load_dwordx4 v105, s[28:31], s50 offen offset:0 nt lds
  buffer_load_dwordx4 v106, s[28:31], s50 offen offset:1024 nt lds
  buffer_load_dwordx4 v105, s[28:31], s50 offen offset:2048 nt lds
  buffer_load_dwordx4 v106, s[28:31], s50 offen offset:3072 nt lds
  s_waitcnt lgkmcnt(0)
  s_barrier
  ds_write_b128 v117, a[128:131] offset:16384
  ds_write_b128 v117, a[132:135] offset:17408
  ds_write_b128 v117, a[136:139] offset:18432
  ds_write_b128 v117, a[140:143] offset:19456
  ds_write_b128 v117, a[144:147] offset:20480
  ds_write_b128 v117, a[148:151] offset:21504
  ds_write_b128 v117, a[152:155] offset:22528
  ds_write_b128 v117, a[156:159] offset:23552
  s_waitcnt vmcnt(24)
  s_mov_b32 m0, 126976
  s_mov_b32 s50, 126976
  buffer_load_dwordx4 v105, s[28:31], s50 offen offset:0 nt lds
  buffer_load_dwordx4 v106, s[28:31], s50 offen offset:1024 nt lds
  buffer_load_dwordx4 v105, s[28:31], s50 offen offset:2048 nt lds
  buffer_load_dwordx4 v106, s[28:31], s50 offen offset:3072 nt lds
  s_waitcnt vmcnt(24)
  s_mov_b32 m0, 16384
  s_mov_b32 s50, 147456
  buffer_load_dwordx4 v101, s[24:27], s50 offen offset:0 nt lds
  buffer_load_dwordx4 v102, s[24:27], s50 offen offset:1024 nt lds
  buffer_load_dwordx4 v103, s[24:27], s50 offen offset:2048 nt lds
  buffer_load_dwordx4 v104, s[24:27], s50 offen offset:3072 nt lds
  s_waitcnt vmcnt(24)
  s_mov_b32 m0, 20480
  s_mov_b32 s50, 151552
  buffer_load_dwordx4 v101, s[24:27], s50 offen offset:0 nt lds
  buffer_load_dwordx4 v102, s[24:27], s50 offen offset:1024 nt lds
  buffer_load_dwordx4 v103, s[24:27], s50 offen offset:2048 nt lds
  buffer_load_dwordx4 v104, s[24:27], s50 offen offset:3072 nt lds
  s_waitcnt vmcnt(24)
  s_mov_b32 m0, 24576
  s_mov_b32 s50, 155648
  buffer_load_dwordx4 v101, s[24:27], s50 offen offset:0 nt lds
  buffer_load_dwordx4 v102, s[24:27], s50 offen offset:1024 nt lds
  buffer_load_dwordx4 v103, s[24:27], s50 offen offset:2048 nt lds
  buffer_load_dwordx4 v104, s[24:27], s50 offen offset:3072 nt lds
  s_waitcnt vmcnt(24)
  s_mov_b32 m0, 28672
  s_mov_b32 s50, 159744
  buffer_load_dwordx4 v101, s[24:27], s50 offen offset:0 nt lds
  buffer_load_dwordx4 v102, s[24:27], s50 offen offset:1024 nt lds
  buffer_load_dwordx4 v103, s[24:27], s50 offen offset:2048 nt lds
  buffer_load_dwordx4 v104, s[24:27], s50 offen offset:3072 nt lds
  s_waitcnt vmcnt(24)
  s_mov_b32 m0, 65536
  s_mov_b32 s50, 131072
  buffer_load_dwordx4 v105, s[28:31], s50 offen offset:0 nt lds
  buffer_load_dwordx4 v106, s[28:31], s50 offen offset:1024 nt lds
  buffer_load_dwordx4 v105, s[28:31], s50 offen offset:2048 nt lds
  buffer_load_dwordx4 v106, s[28:31], s50 offen offset:3072 nt lds
  s_waitcnt vmcnt(24)
  s_mov_b32 m0, 69632
  s_mov_b32 s50, 135168
  buffer_load_dwordx4 v105, s[28:31], s50 offen offset:0 nt lds
  buffer_load_dwordx4 v106, s[28:31], s50 offen offset:1024 nt lds
  buffer_load_dwordx4 v105, s[28:31], s50 offen offset:2048 nt lds
  buffer_load_dwordx4 v106, s[28:31], s50 offen offset:3072 nt lds
  s_waitcnt vmcnt(24)
  s_mov_b32 m0, 73728
  s_mov_b32 s50, 139264
  buffer_load_dwordx4 v105, s[28:31], s50 offen offset:0 nt lds
  buffer_load_dwordx4 v106, s[28:31], s50 offen offset:1024 nt lds
  buffer_load_dwordx4 v105, s[28:31], s50 offen offset:2048 nt lds
  buffer_load_dwordx4 v106, s[28:31], s50 offen offset:3072 nt lds
  s_barrier
  ds_write_b128 v117, a[160:163] offset:24576
  ds_write_b128 v117, a[164:167] offset:25600
  ds_write_b128 v117, a[168:171] offset:26624
  ds_write_b128 v117, a[172:175] offset:27648
  ds_write_b128 v117, a[176:179] offset:28672
  ds_write_b128 v117, a[180:183] offset:29696
  ds_write_b128 v117, a[184:187] offset:30720
  ds_write_b128 v117, a[188:191] offset:31744
  s_waitcnt vmcnt(24)
  s_mov_b32 m0, 77824
  s_mov_b32 s50, 143360
  buffer_load_dwordx4 v105, s[28:31], s50 offen offset:0 nt lds
  buffer_load_dwordx4 v106, s[28:31], s50 offen offset:1024 nt lds
  buffer_load_dwordx4 v105, s[28:31], s50 offen offset:2048 nt lds
  buffer_load_dwordx4 v106, s[28:31], s50 offen offset:3072 nt lds
  s_waitcnt vmcnt(24)
  s_mov_b32 m0, 32768
  s_mov_b32 s50, 163840
  buffer_load_dwordx4 v101, s[24:27], s50 offen offset:0 nt lds
  buffer_load_dwordx4 v102, s[24:27], s50 offen offset:1024 nt lds
  buffer_load_dwordx4 v103, s[24:27], s50 offen offset:2048 nt lds
  buffer_load_dwordx4 v104, s[24:27], s50 offen offset:3072 nt lds
  s_waitcnt vmcnt(24)
  s_mov_b32 m0, 36864
  s_mov_b32 s50, 167936
  buffer_load_dwordx4 v101, s[24:27], s50 offen offset:0 nt lds
  buffer_load_dwordx4 v102, s[24:27], s50 offen offset:1024 nt lds
  buffer_load_dwordx4 v103, s[24:27], s50 offen offset:2048 nt lds
  buffer_load_dwordx4 v104, s[24:27], s50 offen offset:3072 nt lds
  s_waitcnt vmcnt(24)
  s_mov_b32 m0, 40960
  s_mov_b32 s50, 172032
  buffer_load_dwordx4 v101, s[24:27], s50 offen offset:0 nt lds
  buffer_load_dwordx4 v102, s[24:27], s50 offen offset:1024 nt lds
  buffer_load_dwordx4 v103, s[24:27], s50 offen offset:2048 nt lds
  buffer_load_dwordx4 v104, s[24:27], s50 offen offset:3072 nt lds
  s_waitcnt vmcnt(24)
  s_mov_b32 m0, 45056
  s_mov_b32 s50, 176128
  buffer_load_dwordx4 v101, s[24:27], s50 offen offset:0 nt lds
  buffer_load_dwordx4 v102, s[24:27], s50 offen offset:1024 nt lds
  buffer_load_dwordx4 v103, s[24:27], s50 offen offset:2048 nt lds
  buffer_load_dwordx4 v104, s[24:27], s50 offen offset:3072 nt lds
  s_waitcnt vmcnt(24)
  s_mov_b32 m0, 49152
  s_mov_b32 s50, 180224
  buffer_load_dwordx4 v101, s[24:27], s50 offen offset:0 nt lds
  buffer_load_dwordx4 v102, s[24:27], s50 offen offset:1024 nt lds
  buffer_load_dwordx4 v103, s[24:27], s50 offen offset:2048 nt lds
  buffer_load_dwordx4 v104, s[24:27], s50 offen offset:3072 nt lds
  s_waitcnt vmcnt(24)
  s_mov_b32 m0, 53248
  s_mov_b32 s50, 184320
  buffer_load_dwordx4 v101, s[24:27], s50 offen offset:0 nt lds
  buffer_load_dwordx4 v102, s[24:27], s50 offen offset:1024 nt lds
  buffer_load_dwordx4 v103, s[24:27], s50 offen offset:2048 nt lds
  buffer_load_dwordx4 v104, s[24:27], s50 offen offset:3072 nt lds
  s_waitcnt vmcnt(24)
  s_mov_b32 m0, 57344
  s_mov_b32 s50, 188416
  buffer_load_dwordx4 v101, s[24:27], s50 offen offset:0 nt lds
  buffer_load_dwordx4 v102, s[24:27], s50 offen offset:1024 nt lds
  buffer_load_dwordx4 v103, s[24:27], s50 offen offset:2048 nt lds
  buffer_load_dwordx4 v104, s[24:27], s50 offen offset:3072 nt lds
  s_barrier
  s_waitcnt vmcnt(24)
  s_mov_b32 m0, 61440
  s_mov_b32 s50, 192512
  buffer_load_dwordx4 v101, s[24:27], s50 offen offset:0 nt lds
  buffer_load_dwordx4 v102, s[24:27], s50 offen offset:1024 nt lds
  buffer_load_dwordx4 v103, s[24:27], s50 offen offset:2048 nt lds
  buffer_load_dwordx4 v104, s[24:27], s50 offen offset:3072 nt lds
  s_waitcnt vmcnt(24)
  s_mov_b32 m0, 98304
  s_mov_b32 s50, 163840
  buffer_load_dwordx4 v105, s[28:31], s50 offen offset:0 nt lds
  buffer_load_dwordx4 v106, s[28:31], s50 offen offset:1024 nt lds
  buffer_load_dwordx4 v105, s[28:31], s50 offen offset:2048 nt lds
  buffer_load_dwordx4 v106, s[28:31], s50 offen offset:3072 nt lds
  s_waitcnt vmcnt(24)
  s_mov_b32 m0, 102400
  s_mov_b32 s50, 167936
  buffer_load_dwordx4 v105, s[28:31], s50 offen offset:0 nt lds
  buffer_load_dwordx4 v106, s[28:31], s50 offen offset:1024 nt lds
  buffer_load_dwordx4 v105, s[28:31], s50 offen offset:2048 nt lds
  buffer_load_dwordx4 v106, s[28:31], s50 offen offset:3072 nt lds
  s_waitcnt vmcnt(24)
  s_mov_b32 m0, 106496
  s_mov_b32 s50, 172032
  buffer_load_dwordx4 v105, s[28:31], s50 offen offset:0 nt lds
  buffer_load_dwordx4 v106, s[28:31], s50 offen offset:1024 nt lds
  buffer_load_dwordx4 v105, s[28:31], s50 offen offset:2048 nt lds
  buffer_load_dwordx4 v106, s[28:31], s50 offen offset:3072 nt lds
  s_waitcnt lgkmcnt(0)
  s_barrier
  s_waitcnt vmcnt(24)
  s_mov_b32 m0, 110592
  s_mov_b32 s50, 176128
  buffer_load_dwordx4 v105, s[28:31], s50 offen offset:0 nt lds
  buffer_load_dwordx4 v106, s[28:31], s50 offen offset:1024 nt lds
  buffer_load_dwordx4 v105, s[28:31], s50 offen offset:2048 nt lds
  buffer_load_dwordx4 v106, s[28:31], s50 offen offset:3072 nt lds
  s_waitcnt vmcnt(24)
  s_mov_b32 m0, 0
  s_mov_b32 s50, 196608
  buffer_load_dwordx4 v101, s[24:27], s50 offen offset:0 nt lds
  buffer_load_dwordx4 v102, s[24:27], s50 offen offset:1024 nt lds
  buffer_load_dwordx4 v103, s[24:27], s50 offen offset:2048 nt lds
  buffer_load_dwordx4 v104, s[24:27], s50 offen offset:3072 nt lds
  s_waitcnt vmcnt(24)
  s_mov_b32 m0, 4096
  s_mov_b32 s50, 200704
  buffer_load_dwordx4 v101, s[24:27], s50 offen offset:0 nt lds
  buffer_load_dwordx4 v102, s[24:27], s50 offen offset:1024 nt lds
  buffer_load_dwordx4 v103, s[24:27], s50 offen offset:2048 nt lds
  buffer_load_dwordx4 v104, s[24:27], s50 offen offset:3072 nt lds
  s_waitcnt vmcnt(24)
  s_mov_b32 m0, 8192
  s_mov_b32 s50, 204800
  buffer_load_dwordx4 v101, s[24:27], s50 offen offset:0 nt lds
  buffer_load_dwordx4 v102, s[24:27], s50 offen offset:1024 nt lds
  buffer_load_dwordx4 v103, s[24:27], s50 offen offset:2048 nt lds
  buffer_load_dwordx4 v104, s[24:27], s50 offen offset:3072 nt lds
  s_waitcnt vmcnt(24)
  s_mov_b32 m0, 12288
  s_mov_b32 s50, 208896
  buffer_load_dwordx4 v101, s[24:27], s50 offen offset:0 nt lds
  buffer_load_dwordx4 v102, s[24:27], s50 offen offset:1024 nt lds
  buffer_load_dwordx4 v103, s[24:27], s50 offen offset:2048 nt lds
  buffer_load_dwordx4 v104, s[24:27], s50 offen offset:3072 nt lds
  s_waitcnt vmcnt(24)
  s_mov_b32 m0, 114688
  s_mov_b32 s50, 180224
  buffer_load_dwordx4 v105, s[28:31], s50 offen offset:0 nt lds
  buffer_load_dwordx4 v106, s[28:31], s50 offen offset:1024 nt lds
  buffer_load_dwordx4 v105, s[28:31], s50 offen offset:2048 nt lds
  buffer_load_dwordx4 v106, s[28:31], s50 offen offset:3072 nt lds
  s_waitcnt vmcnt(24)
  s_mov_b32 m0, 118784
  s_mov_b32 s50, 184320
  buffer_load_dwordx4 v105, s[28:31], s50 offen offset:0 nt lds
  buffer_load_dwordx4 v106, s[28:31], s50 offen offset:1024 nt lds
  buffer_load_dwordx4 v105, s[28:31], s50 offen offset:2048 nt lds
  buffer_load_dwordx4 v106, s[28:31], s50 offen offset:3072 nt lds
  s_waitcnt vmcnt(24)
  s_mov_b32 m0, 122880
  s_mov_b32 s50, 188416
  buffer_load_dwordx4 v105, s[28:31], s50 offen offset:0 nt lds
  buffer_load_dwordx4 v106, s[28:31], s50 offen offset:1024 nt lds
  buffer_load_dwordx4 v105, s[28:31], s50 offen offset:2048 nt lds
  buffer_load_dwordx4 v106, s[28:31], s50 offen offset:3072 nt lds
  s_barrier
  ds_write_b128 v116, a[192:195] offset:32768
  ds_write_b128 v116, a[196:199] offset:33792
  ds_write_b128 v116, a[200:203] offset:34816
  ds_write_b128 v116, a[204:207] offset:35840
  ds_write_b128 v116, a[208:211] offset:36864
  ds_write_b128 v116, a[212:215] offset:37888
  ds_write_b128 v116, a[216:219] offset:38912
  ds_write_b128 v116, a[220:223] offset:39936
  s_waitcnt vmcnt(24)
  s_mov_b32 m0, 126976
  s_mov_b32 s50, 192512
  buffer_load_dwordx4 v105, s[28:31], s50 offen offset:0 nt lds
  buffer_load_dwordx4 v106, s[28:31], s50 offen offset:1024 nt lds
  buffer_load_dwordx4 v105, s[28:31], s50 offen offset:2048 nt lds
  buffer_load_dwordx4 v106, s[28:31], s50 offen offset:3072 nt lds
  s_waitcnt vmcnt(24)
  s_mov_b32 m0, 16384
  s_mov_b32 s50, 212992
  buffer_load_dwordx4 v101, s[24:27], s50 offen offset:0 nt lds
  buffer_load_dwordx4 v102, s[24:27], s50 offen offset:1024 nt lds
  buffer_load_dwordx4 v103, s[24:27], s50 offen offset:2048 nt lds
  buffer_load_dwordx4 v104, s[24:27], s50 offen offset:3072 nt lds
  s_waitcnt vmcnt(24)
  s_mov_b32 m0, 20480
  s_mov_b32 s50, 217088
  buffer_load_dwordx4 v101, s[24:27], s50 offen offset:0 nt lds
  buffer_load_dwordx4 v102, s[24:27], s50 offen offset:1024 nt lds
  buffer_load_dwordx4 v103, s[24:27], s50 offen offset:2048 nt lds
  buffer_load_dwordx4 v104, s[24:27], s50 offen offset:3072 nt lds
  s_waitcnt vmcnt(24)
  s_mov_b32 m0, 24576
  s_mov_b32 s50, 221184
  buffer_load_dwordx4 v101, s[24:27], s50 offen offset:0 nt lds
  buffer_load_dwordx4 v102, s[24:27], s50 offen offset:1024 nt lds
  buffer_load_dwordx4 v103, s[24:27], s50 offen offset:2048 nt lds
  buffer_load_dwordx4 v104, s[24:27], s50 offen offset:3072 nt lds
  s_waitcnt vmcnt(24)
  s_mov_b32 m0, 28672
  s_mov_b32 s50, 225280
  buffer_load_dwordx4 v101, s[24:27], s50 offen offset:0 nt lds
  buffer_load_dwordx4 v102, s[24:27], s50 offen offset:1024 nt lds
  buffer_load_dwordx4 v103, s[24:27], s50 offen offset:2048 nt lds
  buffer_load_dwordx4 v104, s[24:27], s50 offen offset:3072 nt lds
  s_waitcnt vmcnt(24)
  s_mov_b32 m0, 65536
  s_mov_b32 s50, 196608
  buffer_load_dwordx4 v105, s[28:31], s50 offen offset:0 nt lds
  buffer_load_dwordx4 v106, s[28:31], s50 offen offset:1024 nt lds
  buffer_load_dwordx4 v105, s[28:31], s50 offen offset:2048 nt lds
  buffer_load_dwordx4 v106, s[28:31], s50 offen offset:3072 nt lds
  s_waitcnt vmcnt(24)
  s_mov_b32 m0, 69632
  s_mov_b32 s50, 200704
  buffer_load_dwordx4 v105, s[28:31], s50 offen offset:0 nt lds
  buffer_load_dwordx4 v106, s[28:31], s50 offen offset:1024 nt lds
  buffer_load_dwordx4 v105, s[28:31], s50 offen offset:2048 nt lds
  buffer_load_dwordx4 v106, s[28:31], s50 offen offset:3072 nt lds
  s_waitcnt vmcnt(24)
  s_mov_b32 m0, 73728
  s_mov_b32 s50, 204800
  buffer_load_dwordx4 v105, s[28:31], s50 offen offset:0 nt lds
  buffer_load_dwordx4 v106, s[28:31], s50 offen offset:1024 nt lds
  buffer_load_dwordx4 v105, s[28:31], s50 offen offset:2048 nt lds
  buffer_load_dwordx4 v106, s[28:31], s50 offen offset:3072 nt lds
  s_barrier
  ds_write_b128 v116, a[224:227] offset:40960
  ds_write_b128 v116, a[228:231] offset:41984
  ds_write_b128 v116, a[232:235] offset:43008
  ds_write_b128 v116, a[236:239] offset:44032
  ds_write_b128 v116, a[240:243] offset:45056
  ds_write_b128 v116, a[244:247] offset:46080
  ds_write_b128 v116, a[248:251] offset:47104
  ds_write_b128 v116, a[252:255] offset:48128
  s_waitcnt vmcnt(24)
  s_mov_b32 m0, 77824
  s_mov_b32 s50, 208896
  buffer_load_dwordx4 v105, s[28:31], s50 offen offset:0 nt lds
  buffer_load_dwordx4 v106, s[28:31], s50 offen offset:1024 nt lds
  buffer_load_dwordx4 v105, s[28:31], s50 offen offset:2048 nt lds
  buffer_load_dwordx4 v106, s[28:31], s50 offen offset:3072 nt lds
  s_waitcnt vmcnt(24)
  s_mov_b32 m0, 81920
  s_mov_b32 s50, 212992
  buffer_load_dwordx4 v105, s[28:31], s50 offen offset:0 nt lds
  buffer_load_dwordx4 v106, s[28:31], s50 offen offset:1024 nt lds
  buffer_load_dwordx4 v105, s[28:31], s50 offen offset:2048 nt lds
  buffer_load_dwordx4 v106, s[28:31], s50 offen offset:3072 nt lds
  s_waitcnt vmcnt(24)
  s_mov_b32 m0, 86016
  s_mov_b32 s50, 217088
  buffer_load_dwordx4 v105, s[28:31], s50 offen offset:0 nt lds
  buffer_load_dwordx4 v106, s[28:31], s50 offen offset:1024 nt lds
  buffer_load_dwordx4 v105, s[28:31], s50 offen offset:2048 nt lds
  buffer_load_dwordx4 v106, s[28:31], s50 offen offset:3072 nt lds
  s_waitcnt vmcnt(24)
  s_mov_b32 m0, 90112
  s_mov_b32 s50, 221184
  buffer_load_dwordx4 v105, s[28:31], s50 offen offset:0 nt lds
  buffer_load_dwordx4 v106, s[28:31], s50 offen offset:1024 nt lds
  buffer_load_dwordx4 v105, s[28:31], s50 offen offset:2048 nt lds
  buffer_load_dwordx4 v106, s[28:31], s50 offen offset:3072 nt lds
  s_waitcnt vmcnt(24)
  s_mov_b32 m0, 94208
  s_mov_b32 s50, 225280
  buffer_load_dwordx4 v105, s[28:31], s50 offen offset:0 nt lds
  buffer_load_dwordx4 v106, s[28:31], s50 offen offset:1024 nt lds
  buffer_load_dwordx4 v105, s[28:31], s50 offen offset:2048 nt lds
  buffer_load_dwordx4 v106, s[28:31], s50 offen offset:3072 nt lds
  s_waitcnt vmcnt(24)
  s_mov_b32 m0, 49152
  s_mov_b32 s50, 245760
  buffer_load_dwordx4 v101, s[24:27], s50 offen offset:0 nt lds
  buffer_load_dwordx4 v102, s[24:27], s50 offen offset:1024 nt lds
  buffer_load_dwordx4 v103, s[24:27], s50 offen offset:2048 nt lds
  buffer_load_dwordx4 v104, s[24:27], s50 offen offset:3072 nt lds
  s_waitcnt vmcnt(24)
  s_mov_b32 m0, 53248
  s_mov_b32 s50, 249856
  buffer_load_dwordx4 v101, s[24:27], s50 offen offset:0 nt lds
  buffer_load_dwordx4 v102, s[24:27], s50 offen offset:1024 nt lds
  buffer_load_dwordx4 v103, s[24:27], s50 offen offset:2048 nt lds
  buffer_load_dwordx4 v104, s[24:27], s50 offen offset:3072 nt lds
  s_waitcnt vmcnt(24)
  s_mov_b32 m0, 57344
  s_mov_b32 s50, 253952
  buffer_load_dwordx4 v101, s[24:27], s50 offen offset:0 nt lds
  buffer_load_dwordx4 v102, s[24:27], s50 offen offset:1024 nt lds
  buffer_load_dwordx4 v103, s[24:27], s50 offen offset:2048 nt lds
  buffer_load_dwordx4 v104, s[24:27], s50 offen offset:3072 nt lds
  s_barrier
  s_waitcnt vmcnt(24)
  s_mov_b32 m0, 61440
  s_mov_b32 s50, 258048
  buffer_load_dwordx4 v101, s[24:27], s50 offen offset:0 nt lds
  buffer_load_dwordx4 v102, s[24:27], s50 offen offset:1024 nt lds
  buffer_load_dwordx4 v103, s[24:27], s50 offen offset:2048 nt lds
  buffer_load_dwordx4 v104, s[24:27], s50 offen offset:3072 nt lds
  s_waitcnt vmcnt(24)
  s_mov_b32 m0, 98304
  s_mov_b32 s50, 229376
  buffer_load_dwordx4 v105, s[28:31], s50 offen offset:0 nt lds
  buffer_load_dwordx4 v106, s[28:31], s50 offen offset:1024 nt lds
  buffer_load_dwordx4 v105, s[28:31], s50 offen offset:2048 nt lds
  buffer_load_dwordx4 v106, s[28:31], s50 offen offset:3072 nt lds
  s_waitcnt vmcnt(24)
  s_mov_b32 m0, 102400
  s_mov_b32 s50, 233472
  buffer_load_dwordx4 v105, s[28:31], s50 offen offset:0 nt lds
  buffer_load_dwordx4 v106, s[28:31], s50 offen offset:1024 nt lds
  buffer_load_dwordx4 v105, s[28:31], s50 offen offset:2048 nt lds
  buffer_load_dwordx4 v106, s[28:31], s50 offen offset:3072 nt lds
  s_waitcnt vmcnt(24)
  s_mov_b32 m0, 106496
  s_mov_b32 s50, 237568
  buffer_load_dwordx4 v105, s[28:31], s50 offen offset:0 nt lds
  buffer_load_dwordx4 v106, s[28:31], s50 offen offset:1024 nt lds
  buffer_load_dwordx4 v105, s[28:31], s50 offen offset:2048 nt lds
  buffer_load_dwordx4 v106, s[28:31], s50 offen offset:3072 nt lds
  s_waitcnt lgkmcnt(0)
  s_barrier
  s_waitcnt vmcnt(24)
  s_mov_b32 m0, 110592
  s_mov_b32 s50, 241664
  buffer_load_dwordx4 v105, s[28:31], s50 offen offset:0 nt lds
  buffer_load_dwordx4 v106, s[28:31], s50 offen offset:1024 nt lds
  buffer_load_dwordx4 v105, s[28:31], s50 offen offset:2048 nt lds
  buffer_load_dwordx4 v106, s[28:31], s50 offen offset:3072 nt lds
  s_waitcnt vmcnt(24)
  s_mov_b32 m0, 114688
  s_mov_b32 s50, 245760
  buffer_load_dwordx4 v105, s[28:31], s50 offen offset:0 nt lds
  buffer_load_dwordx4 v106, s[28:31], s50 offen offset:1024 nt lds
  buffer_load_dwordx4 v105, s[28:31], s50 offen offset:2048 nt lds
  buffer_load_dwordx4 v106, s[28:31], s50 offen offset:3072 nt lds
  s_waitcnt vmcnt(24)
  s_mov_b32 m0, 118784
  s_mov_b32 s50, 249856
  buffer_load_dwordx4 v105, s[28:31], s50 offen offset:0 nt lds
  buffer_load_dwordx4 v106, s[28:31], s50 offen offset:1024 nt lds
  buffer_load_dwordx4 v105, s[28:31], s50 offen offset:2048 nt lds
  buffer_load_dwordx4 v106, s[28:31], s50 offen offset:3072 nt lds
  s_waitcnt vmcnt(24)
  s_mov_b32 m0, 122880
  s_mov_b32 s50, 253952
  buffer_load_dwordx4 v105, s[28:31], s50 offen offset:0 nt lds
  buffer_load_dwordx4 v106, s[28:31], s50 offen offset:1024 nt lds
  buffer_load_dwordx4 v105, s[28:31], s50 offen offset:2048 nt lds
  buffer_load_dwordx4 v106, s[28:31], s50 offen offset:3072 nt lds
  s_waitcnt vmcnt(24)
  s_mov_b32 m0, 126976
  s_mov_b32 s50, 258048
  buffer_load_dwordx4 v105, s[28:31], s50 offen offset:0 nt lds
  buffer_load_dwordx4 v106, s[28:31], s50 offen offset:1024 nt lds
  buffer_load_dwordx4 v105, s[28:31], s50 offen offset:2048 nt lds
  buffer_load_dwordx4 v106, s[28:31], s50 offen offset:3072 nt lds
  s_add_u32 s50, s91, 0
  buffer_load_dwordx4 v[112:115], v107, s[4:7], s50 offen
  buffer_load_dwordx4 v[112:115], v108, s[4:7], s50 offen
  buffer_load_dwordx4 v[112:115], v109, s[4:7], s50 offen
  buffer_load_dwordx4 v[112:115], v110, s[4:7], s50 offen
  buffer_load_dwordx4 v[112:115], v111, s[4:7], s50 offen
  s_add_u32 s50, s91, 20480
  buffer_load_dwordx4 v[112:115], v107, s[4:7], s50 offen
  buffer_load_dwordx4 v[112:115], v108, s[4:7], s50 offen
  buffer_load_dwordx4 v[112:115], v109, s[4:7], s50 offen
  buffer_load_dwordx4 v[112:115], v110, s[4:7], s50 offen
  buffer_load_dwordx4 v[112:115], v111, s[4:7], s50 offen
  s_add_u32 s50, s91, 40960
  buffer_load_dwordx4 v[112:115], v107, s[4:7], s50 offen
  buffer_load_dwordx4 v[112:115], v108, s[4:7], s50 offen
  buffer_load_dwordx4 v[112:115], v109, s[4:7], s50 offen
  buffer_load_dwordx4 v[112:115], v110, s[4:7], s50 offen
  buffer_load_dwordx4 v[112:115], v111, s[4:7], s50 offen
  s_add_u32 s50, s91, 61440
  buffer_load_dwordx4 v[112:115], v107, s[4:7], s50 offen
  buffer_load_dwordx4 v[112:115], v108, s[4:7], s50 offen
  buffer_load_dwordx4 v[112:115], v109, s[4:7], s50 offen
  buffer_load_dwordx4 v[112:115], v110, s[4:7], s50 offen
  buffer_load_dwordx4 v[112:115], v111, s[4:7], s50 offen
  s_waitcnt vmcnt(44)
  s_mov_b32 m0, 0
  s_add_u32 s50, s80, 0
  buffer_load_dwordx4 v107, s[4:7], s50 offen lds
  s_mov_b32 m0, 1024
  s_nop 0
  buffer_load_dwordx4 v108, s[4:7], s50 offen lds
  s_mov_b32 m0, 2048
  s_nop 0
  buffer_load_dwordx4 v109, s[4:7], s50 offen lds
  s_mov_b32 m0, 3072
  s_nop 0
  buffer_load_dwordx4 v110, s[4:7], s50 offen lds
  s_waitcnt vmcnt(44)
  s_mov_b32 m0, 4096
  s_nop 0
  buffer_load_dwordx4 v111, s[4:7], s50 offen lds
  s_mov_b32 m0, 5120
  s_add_u32 s50, s80, 20480
  buffer_load_dwordx4 v107, s[4:7], s50 offen lds
  s_mov_b32 m0, 6144
  s_nop 0
  buffer_load_dwordx4 v108, s[4:7], s50 offen lds
  s_mov_b32 m0, 7168
  s_nop 0
  buffer_load_dwordx4 v109, s[4:7], s50 offen lds
  s_waitcnt vmcnt(44)
  s_mov_b32 m0, 8192
  s_nop 0
  buffer_load_dwordx4 v110, s[4:7], s50 offen lds
  s_mov_b32 m0, 9216
  s_nop 0
  buffer_load_dwordx4 v111, s[4:7], s50 offen lds
  s_mov_b32 m0, 10240
  s_add_u32 s50, s80, 40960
  buffer_load_dwordx4 v107, s[4:7], s50 offen lds
  s_mov_b32 m0, 11264
  s_nop 0
  buffer_load_dwordx4 v108, s[4:7], s50 offen lds
  s_barrier
  s_waitcnt vmcnt(44)
  s_mov_b32 m0, 12288
  s_nop 0
  buffer_load_dwordx4 v109, s[4:7], s50 offen lds
  s_mov_b32 m0, 13312
  s_nop 0
  buffer_load_dwordx4 v110, s[4:7], s50 offen lds
  s_mov_b32 m0, 14336
  s_nop 0
  buffer_load_dwordx4 v111, s[4:7], s50 offen lds
  s_mov_b32 m0, 15360
  s_add_u32 s50, s80, 61440
  buffer_load_dwordx4 v107, s[4:7], s50 offen lds
  s_waitcnt vmcnt(44)
  s_mov_b32 m0, 16384
  s_nop 0
  buffer_load_dwordx4 v108, s[4:7], s50 offen lds
  s_mov_b32 m0, 17408
  s_nop 0
  buffer_load_dwordx4 v109, s[4:7], s50 offen lds
  s_mov_b32 m0, 18432
  s_nop 0
  buffer_load_dwordx4 v110, s[4:7], s50 offen lds
  s_mov_b32 m0, 19456
  s_nop 0
  buffer_load_dwordx4 v111, s[4:7], s50 offen lds
  s_waitcnt vmcnt(44)
  s_mov_b32 m0, 20480
  s_add_u32 s50, s80, 81920
  buffer_load_dwordx4 v107, s[4:7], s50 offen lds
  s_mov_b32 m0, 21504
  s_nop 0
  buffer_load_dwordx4 v108, s[4:7], s50 offen lds
  s_mov_b32 m0, 22528
  s_nop 0
  buffer_load_dwordx4 v109, s[4:7], s50 offen lds
  s_mov_b32 m0, 23552
  s_nop 0
  buffer_load_dwordx4 v110, s[4:7], s50 offen lds
  s_waitcnt vmcnt(44)
  s_mov_b32 m0, 24576
  s_nop 0
  buffer_load_dwordx4 v111, s[4:7], s50 offen lds
  s_mov_b32 m0, 25600
  s_add_u32 s50, s80, 102400
  buffer_load_dwordx4 v107, s[4:7], s50 offen lds
  s_mov_b32 m0, 26624
  s_nop 0
  buffer_load_dwordx4 v108, s[4:7], s50 offen lds
  s_mov_b32 m0, 27648
  s_nop 0
  buffer_load_dwordx4 v109, s[4:7], s50 offen lds
  s_barrier
  s_mov_b32 m0, 28672
  s_nop 0
  buffer_load_dwordx4 v110, s[4:7], s50 offen lds
  s_mov_b32 m0, 29696
  s_nop 0
  buffer_load_dwordx4 v111, s[4:7], s50 offen lds
  s_mov_b32 m0, 30720
  s_add_u32 s50, s80, 122880
  buffer_load_dwordx4 v107, s[4:7], s50 offen lds
  s_mov_b32 m0, 31744
  s_nop 0
  buffer_load_dwordx4 v108, s[4:7], s50 offen lds
  s_mov_b32 m0, 32768
  s_nop 0
  buffer_load_dwordx4 v109, s[4:7], s50 offen lds
  s_mov_b32 m0, 33792
  s_nop 0
  buffer_load_dwordx4 v110, s[4:7], s50 offen lds
  s_mov_b32 m0, 34816
  s_nop 0
  buffer_load_dwordx4 v111, s[4:7], s50 offen lds
  s_mov_b32 m0, 35840
  s_add_u32 s50, s80, 143360
  buffer_load_dwordx4 v107, s[4:7], s50 offen lds
  s_mov_b32 m0, 36864
  s_nop 0
  buffer_load_dwordx4 v108, s[4:7], s50 offen lds
  s_mov_b32 m0, 37888
  s_nop 0
  buffer_load_dwordx4 v109, s[4:7], s50 offen lds
  s_mov_b32 m0, 38912
  s_nop 0
  buffer_load_dwordx4 v110, s[4:7], s50 offen lds
  s_mov_b32 m0, 39936
  s_nop 0
  buffer_load_dwordx4 v111, s[4:7], s50 offen lds
  s_waitcnt vmcnt(56)
  s_add_u32 s50, s82, 122880
  buffer_load_dwordx4 a[0:3], v109, s[4:7], s50 offen
  buffer_load_dwordx4 a[4:7], v110, s[4:7], s50 offen
  buffer_load_dwordx4 a[8:11], v111, s[4:7], s50 offen
  s_add_u32 s50, s82, 143360
  buffer_load_dwordx4 a[12:15], v107, s[4:7], s50 offen
  s_waitcnt vmcnt(56)
  buffer_load_dwordx4 a[16:19], v108, s[4:7], s50 offen
  buffer_load_dwordx4 a[20:23], v109, s[4:7], s50 offen
  buffer_load_dwordx4 a[24:27], v110, s[4:7], s50 offen
  buffer_load_dwordx4 a[28:31], v111, s[4:7], s50 offen
  s_waitcnt vmcnt(56)
  s_add_u32 s50, s83, 0
  buffer_load_dwordx4 a[32:35], v107, s[4:7], s50 offen
  buffer_load_dwordx4 a[36:39], v108, s[4:7], s50 offen
  buffer_load_dwordx4 a[40:43], v109, s[4:7], s50 offen
  buffer_load_dwordx4 a[44:47], v110, s[4:7], s50 offen
  s_waitcnt vmcnt(56)
  buffer_load_dwordx4 a[48:51], v111, s[4:7], s50 offen
  s_add_u32 s50, s83, 20480
  buffer_load_dwordx4 a[52:55], v107, s[4:7], s50 offen
  buffer_load_dwordx4 a[56:59], v108, s[4:7], s50 offen
  buffer_load_dwordx4 a[60:63], v109, s[4:7], s50 offen
  s_waitcnt vmcnt(56)
  s_mov_b32 m0, 40960
  s_add_u32 s50, s81, 0
  buffer_load_dwordx4 v107, s[4:7], s50 offen lds
  s_mov_b32 m0, 41984
  s_nop 0
  buffer_load_dwordx4 v108, s[4:7], s50 offen lds
  s_mov_b32 m0, 43008
  s_nop 0
  buffer_load_dwordx4 v109, s[4:7], s50 offen lds
  s_mov_b32 m0, 44032
  s_nop 0
  buffer_load_dwordx4 v110, s[4:7], s50 offen lds
  s_waitcnt vmcnt(56)
  s_mov_b32 m0, 45056
  s_nop 0
  buffer_load_dwordx4 v111, s[4:7], s50 offen lds
  s_mov_b32 m0, 46080
  s_add_u32 s50, s81, 20480
  buffer_load_dwordx4 v107, s[4:7], s50 offen lds
  s_mov_b32 m0, 47104
  s_nop 0
  buffer_load_dwordx4 v108, s[4:7], s50 offen lds
  s_mov_b32 m0, 48128
  s_nop 0
  buffer_load_dwordx4 v109, s[4:7], s50 offen lds
  s_waitcnt vmcnt(56)
  s_mov_b32 m0, 65536
  s_add_u32 s50, s81, 81920
  buffer_load_dwordx4 v111, s[4:7], s50 offen lds
  s_mov_b32 m0, 66560
  s_add_u32 s50, s81, 102400
  buffer_load_dwordx4 v107, s[4:7], s50 offen lds
  s_mov_b32 m0, 67584
  s_nop 0
  buffer_load_dwordx4 v108, s[4:7], s50 offen lds
  s_mov_b32 m0, 68608
  s_nop 0
  buffer_load_dwordx4 v109, s[4:7], s50 offen lds
  s_waitcnt vmcnt(56)
  s_mov_b32 m0, 69632
  s_nop 0
  buffer_load_dwordx4 v110, s[4:7], s50 offen lds
  s_mov_b32 m0, 70656
  s_nop 0
  buffer_load_dwordx4 v111, s[4:7], s50 offen lds
  s_mov_b32 m0, 71680
  s_add_u32 s50, s81, 122880
  buffer_load_dwordx4 v107, s[4:7], s50 offen lds
  s_mov_b32 m0, 72704
  s_nop 0
  buffer_load_dwordx4 v108, s[4:7], s50 offen lds
  s_waitcnt vmcnt(56)
  s_mov_b32 m0, 73728
  s_nop 0
  buffer_load_dwordx4 v109, s[4:7], s50 offen lds
  s_mov_b32 m0, 74752
  s_nop 0
  buffer_load_dwordx4 v110, s[4:7], s50 offen lds
  s_mov_b32 m0, 75776
  s_nop 0
  buffer_load_dwordx4 v111, s[4:7], s50 offen lds
  s_mov_b32 m0, 76800
  s_add_u32 s50, s81, 143360
  buffer_load_dwordx4 v107, s[4:7], s50 offen lds
  s_waitcnt vmcnt(56)
  s_mov_b32 m0, 77824
  s_nop 0
  buffer_load_dwordx4 v108, s[4:7], s50 offen lds
  s_mov_b32 m0, 78848
  s_nop 0
  buffer_load_dwordx4 v109, s[4:7], s50 offen lds
  s_mov_b32 m0, 79872
  s_nop 0
  buffer_load_dwordx4 v110, s[4:7], s50 offen lds
  s_mov_b32 m0, 80896
  s_nop 0
  buffer_load_dwordx4 v111, s[4:7], s50 offen lds
  s_waitcnt vmcnt(56)
  s_mov_b32 m0, 81920
  s_add_u32 s50, s82, 0
  buffer_load_dwordx4 v107, s[4:7], s50 offen lds
  s_mov_b32 m0, 82944
  s_nop 0
  buffer_load_dwordx4 v108, s[4:7], s50 offen lds
  s_mov_b32 m0, 83968
  s_nop 0
  buffer_load_dwordx4 v109, s[4:7], s50 offen lds
  s_mov_b32 m0, 84992
  s_nop 0
  buffer_load_dwordx4 v110, s[4:7], s50 offen lds
  s_waitcnt vmcnt(56)
  s_mov_b32 m0, 86016
  s_nop 0
  buffer_load_dwordx4 v111, s[4:7], s50 offen lds
  s_mov_b32 m0, 87040
  s_add_u32 s50, s82, 20480
  buffer_load_dwordx4 v107, s[4:7], s50 offen lds
  s_mov_b32 m0, 88064
  s_nop 0
  buffer_load_dwordx4 v108, s[4:7], s50 offen lds
  s_mov_b32 m0, 89088
  s_nop 0
  buffer_load_dwordx4 v109, s[4:7], s50 offen lds
  s_waitcnt vmcnt(56)
  s_mov_b32 m0, 90112
  s_nop 0
  buffer_load_dwordx4 v110, s[4:7], s50 offen lds
  s_mov_b32 m0, 91136
  s_nop 0
  buffer_load_dwordx4 v111, s[4:7], s50 offen lds
  s_mov_b32 m0, 92160
  s_add_u32 s50, s82, 40960
  buffer_load_dwordx4 v107, s[4:7], s50 offen lds
  s_mov_b32 m0, 93184
  s_nop 0
  buffer_load_dwordx4 v108, s[4:7], s50 offen lds
  s_waitcnt vmcnt(56)
  s_mov_b32 m0, 94208
  s_nop 0
  buffer_load_dwordx4 v109, s[4:7], s50 offen lds
  s_mov_b32 m0, 95232
  s_nop 0
  buffer_load_dwordx4 v110, s[4:7], s50 offen lds
  s_mov_b32 m0, 96256
  s_nop 0
  buffer_load_dwordx4 v111, s[4:7], s50 offen lds
  s_mov_b32 m0, 97280
  s_add_u32 s50, s82, 61440
  buffer_load_dwordx4 v107, s[4:7], s50 offen lds
  s_waitcnt vmcnt(56)
  s_mov_b32 m0, 131072
  s_add_u32 s50, s83, 20480
  buffer_load_dwordx4 v110, s[4:7], s50 offen lds
  s_mov_b32 m0, 132096
  s_nop 0
  buffer_load_dwordx4 v111, s[4:7], s50 offen lds
  s_mov_b32 m0, 133120
  s_add_u32 s50, s83, 40960
  buffer_load_dwordx4 v107, s[4:7], s50 offen lds
  s_mov_b32 m0, 134144
  s_nop 0
  buffer_load_dwordx4 v108, s[4:7], s50 offen lds
  s_barrier
  s_waitcnt vmcnt(59)
  ds_write_b128 v117, a[0:3] offset:49152
  s_waitcnt vmcnt(58)
  ds_write_b128 v117, a[4:7] offset:50176
  s_waitcnt vmcnt(57)
  ds_write_b128 v117, a[8:11] offset:51200
  s_waitcnt vmcnt(56)
  ds_write_b128 v117, a[12:15] offset:52224
  s_waitcnt vmcnt(55)
  ds_write_b128 v117, a[16:19] offset:53248
  s_waitcnt vmcnt(54)
  ds_write_b128 v117, a[20:23] offset:54272
  s_waitcnt vmcnt(53)
  ds_write_b128 v117, a[24:27] offset:55296
  s_waitcnt vmcnt(52)
  ds_write_b128 v117, a[28:31] offset:56320
  s_waitcnt vmcnt(51)
  ds_write_b128 v117, a[32:35] offset:57344
  s_waitcnt vmcnt(50)
  ds_write_b128 v117, a[36:39] offset:58368
  s_waitcnt vmcnt(49)
  ds_write_b128 v117, a[40:43] offset:59392
  s_waitcnt vmcnt(48)
  ds_write_b128 v117, a[44:47] offset:60416
  s_waitcnt vmcnt(47)
  ds_write_b128 v117, a[48:51] offset:61440
  s_waitcnt vmcnt(46)
  ds_write_b128 v117, a[52:55] offset:62464
  s_waitcnt vmcnt(45)
  ds_write_b128 v117, a[56:59] offset:63488
  s_waitcnt vmcnt(44)
  ds_write_b128 v117, a[60:63] offset:64512
  s_waitcnt vmcnt(40)
  s_mov_b32 m0, 135168
  s_nop 0
  buffer_load_dwordx4 v109, s[4:7], s50 offen lds
  s_mov_b32 m0, 136192
  s_nop 0
  buffer_load_dwordx4 v110, s[4:7], s50 offen lds
  s_mov_b32 m0, 137216
  s_nop 0
  buffer_load_dwordx4 v111, s[4:7], s50 offen lds
  s_mov_b32 m0, 138240
  s_add_u32 s50, s83, 61440
  buffer_load_dwordx4 v107, s[4:7], s50 offen lds
  s_mov_b32 m0, 139264
  s_nop 0
  buffer_load_dwordx4 v108, s[4:7], s50 offen lds
  s_mov_b32 m0, 140288
  s_nop 0
  buffer_load_dwordx4 v109, s[4:7], s50 offen lds
  s_mov_b32 m0, 141312
  s_nop 0
  buffer_load_dwordx4 v110, s[4:7], s50 offen lds
  s_mov_b32 m0, 142336
  s_nop 0
  buffer_load_dwordx4 v111, s[4:7], s50 offen lds
  s_mov_b32 m0, 143360
  s_add_u32 s50, s83, 81920
  buffer_load_dwordx4 v107, s[4:7], s50 offen lds
  s_mov_b32 m0, 144384
  s_nop 0
  buffer_load_dwordx4 v108, s[4:7], s50 offen lds
  s_mov_b32 m0, 145408
  s_nop 0
  buffer_load_dwordx4 v109, s[4:7], s50 offen lds
  s_mov_b32 m0, 146432
  s_nop 0
  buffer_load_dwordx4 v110, s[4:7], s50 offen lds
  s_mov_b32 m0, 147456
  s_nop 0
  buffer_load_dwordx4 v111, s[4:7], s50 offen lds
  s_mov_b32 m0, 148480
  s_add_u32 s50, s83, 102400
  buffer_load_dwordx4 v107, s[4:7], s50 offen lds
  s_mov_b32 m0, 149504
  s_nop 0
  buffer_load_dwordx4 v108, s[4:7], s50 offen lds
  s_mov_b32 m0, 150528
  s_nop 0
  buffer_load_dwordx4 v109, s[4:7], s50 offen lds
  s_mov_b32 m0, 151552
  s_nop 0
  buffer_load_dwordx4 v110, s[4:7], s50 offen lds
  s_mov_b32 m0, 152576
  s_nop 0
  buffer_load_dwordx4 v111, s[4:7], s50 offen lds
  s_mov_b32 m0, 153600
  s_add_u32 s50, s83, 122880
  buffer_load_dwordx4 v107, s[4:7], s50 offen lds
  s_mov_b32 m0, 154624
  s_nop 0
  buffer_load_dwordx4 v108, s[4:7], s50 offen lds
  s_waitcnt vmcnt(56)
  s_mov_b32 m0, 155648
  s_nop 0
  buffer_load_dwordx4 v109, s[4:7], s50 offen lds
  s_mov_b32 m0, 156672
  s_nop 0
  buffer_load_dwordx4 v110, s[4:7], s50 offen lds
  s_mov_b32 m0, 157696
  s_nop 0
  buffer_load_dwordx4 v111, s[4:7], s50 offen lds
  s_mov_b32 m0, 158720
  s_add_u32 s50, s83, 143360
  buffer_load_dwordx4 v107, s[4:7], s50 offen lds
  s_waitcnt vmcnt(56)
  s_mov_b32 m0, 159744
  s_nop 0
  buffer_load_dwordx4 v108, s[4:7], s50 offen lds
  s_mov_b32 m0, 160768
  s_nop 0
  buffer_load_dwordx4 v109, s[4:7], s50 offen lds
  s_mov_b32 m0, 161792
  s_nop 0
  buffer_load_dwordx4 v110, s[4:7], s50 offen lds
  s_mov_b32 m0, 162816
  s_nop 0
  buffer_load_dwordx4 v111, s[4:7], s50 offen lds
  s_waitcnt vmcnt(56)
  s_mov_b32 m0, 49152
  s_add_u32 s50, s81, 20480
  buffer_load_dwordx4 v110, s[4:7], s50 offen lds
  s_mov_b32 m0, 50176
  s_nop 0
  buffer_load_dwordx4 v111, s[4:7], s50 offen lds
  s_mov_b32 m0, 51200
  s_add_u32 s50, s81, 40960
  buffer_load_dwordx4 v107, s[4:7], s50 offen lds
  s_mov_b32 m0, 52224
  s_nop 0
  buffer_load_dwordx4 v108, s[4:7], s50 offen lds
  s_waitcnt vmcnt(56)
  s_mov_b32 m0, 53248
  s_nop 0
  buffer_load_dwordx4 v109, s[4:7], s50 offen lds
  s_mov_b32 m0, 54272
  s_nop 0
  buffer_load_dwordx4 v110, s[4:7], s50 offen lds
  s_mov_b32 m0, 55296
  s_nop 0
  buffer_load_dwordx4 v111, s[4:7], s50 offen lds
  s_mov_b32 m0, 56320
  s_add_u32 s50, s81, 61440
  buffer_load_dwordx4 v107, s[4:7], s50 offen lds
  s_waitcnt vmcnt(56)
  s_mov_b32 m0, 57344
  s_nop 0
  buffer_load_dwordx4 v108, s[4:7], s50 offen lds
  s_mov_b32 m0, 58368
  s_nop 0
  buffer_load_dwordx4 v109, s[4:7], s50 offen lds
  s_mov_b32 m0, 59392
  s_nop 0
  buffer_load_dwordx4 v110, s[4:7], s50 offen lds
  s_mov_b32 m0, 60416
  s_nop 0
  buffer_load_dwordx4 v111, s[4:7], s50 offen lds
  s_waitcnt vmcnt(56)
  s_mov_b32 m0, 61440
  s_add_u32 s50, s81, 81920
  buffer_load_dwordx4 v107, s[4:7], s50 offen lds
  s_mov_b32 m0, 62464
  s_nop 0
  buffer_load_dwordx4 v108, s[4:7], s50 offen lds
  s_mov_b32 m0, 63488
  s_nop 0
  buffer_load_dwordx4 v109, s[4:7], s50 offen lds
  s_mov_b32 m0, 64512
  s_nop 0
  buffer_load_dwordx4 v110, s[4:7], s50 offen lds
  s_waitcnt vmcnt(56)
  s_mov_b32 m0, 98304
  s_add_u32 s50, s82, 61440
  buffer_load_dwordx4 v108, s[4:7], s50 offen lds
  s_mov_b32 m0, 99328
  s_nop 0
  buffer_load_dwordx4 v109, s[4:7], s50 offen lds
  s_mov_b32 m0, 100352
  s_nop 0
  buffer_load_dwordx4 v110, s[4:7], s50 offen lds
  s_mov_b32 m0, 101376
  s_nop 0
  buffer_load_dwordx4 v111, s[4:7], s50 offen lds
  s_waitcnt vmcnt(56)
  s_mov_b32 m0, 102400
  s_add_u32 s50, s82, 81920
  buffer_load_dwordx4 v107, s[4:7], s50 offen lds
  s_mov_b32 m0, 103424
  s_nop 0
  buffer_load_dwordx4 v108, s[4:7], s50 offen lds
  s_mov_b32 m0, 104448
  s_nop 0
  buffer_load_dwordx4 v109, s[4:7], s50 offen lds
  s_mov_b32 m0, 105472
  s_nop 0
  buffer_load_dwordx4 v110, s[4:7], s50 offen lds
  s_waitcnt vmcnt(56)
  s_mov_b32 m0, 106496
  s_nop 0
  buffer_load_dwordx4 v111, s[4:7], s50 offen lds
  s_mov_b32 m0, 107520
  s_add_u32 s50, s82, 102400
  buffer_load_dwordx4 v107, s[4:7], s50 offen lds
  s_mov_b32 m0, 108544
  s_nop 0
  buffer_load_dwordx4 v108, s[4:7], s50 offen lds
  s_mov_b32 m0, 109568
  s_nop 0
  buffer_load_dwordx4 v109, s[4:7], s50 offen lds
  s_waitcnt vmcnt(56)
  s_mov_b32 m0, 110592
  s_nop 0
  buffer_load_dwordx4 v110, s[4:7], s50 offen lds
  s_mov_b32 m0, 111616
  s_nop 0
  buffer_load_dwordx4 v111, s[4:7], s50 offen lds
  s_mov_b32 m0, 112640
  s_add_u32 s50, s82, 122880
  buffer_load_dwordx4 v107, s[4:7], s50 offen lds
  s_mov_b32 m0, 113664
  s_nop 0
  buffer_load_dwordx4 v108, s[4:7], s50 offen lds
  s_waitcnt vmcnt(56)
  s_waitcnt vmcnt(52)
  s_waitcnt vmcnt(48)
  s_waitcnt vmcnt(44)
  s_waitcnt vmcnt(40)
  s_waitcnt vmcnt(36)
  s_waitcnt vmcnt(32)
  s_waitcnt vmcnt(28)
  s_waitcnt vmcnt(24)
  s_waitcnt vmcnt(20)
  s_waitcnt vmcnt(16)
  s_waitcnt vmcnt(12)
  s_waitcnt vmcnt(8)
  s_waitcnt vmcnt(4)
  s_waitcnt vmcnt(0)
  s_waitcnt lgkmcnt(0)
  s_barrier
  s_mov_b32 s48, 0
  s_mov_b32 s46, 0xffff
  s_cmp_lt_u32 s40, 2
  s_cselect_b32 s46, 0xff, s46
L_pl_H_standalone__gqa_block_cached__near_ridge_kernel:
  s_mov_b32 exec_lo, s46
  s_mov_b32 exec_hi, 0
  buffer_load_dword v84, v123, s[16:19], 0 offen sc1
  s_waitcnt vmcnt(0)
L_ev_H_standalone__gqa_block_cached__near_ridge_kernel:
  v_cmp_ne_u32 vcc, v124, v84
  s_mov_b64 exec, -1
  s_add_u32 s48, s48, 1
  s_cmp_ge_u32 s48, 50000
  s_cselect_b32 s47, s46, vcc_lo
  s_and_b32 s47, s47, s46
  s_cbranch_scc1 L_nw_H_standalone__gqa_block_cached__near_ridge_kernel
  s_sleep 10
  s_branch L_pl_H_standalone__gqa_block_cached__near_ridge_kernel
L_nw_H_standalone__gqa_block_cached__near_ridge_kernel:
  s_bitcmp1_b32 s47, 0
  s_cbranch_scc1 L_fs0_H_standalone__gqa_block_cached__near_ridge_kernel
L_fr0_H_standalone__gqa_block_cached__near_ridge_kernel:
  s_bitcmp1_b32 s47, 1
  s_cbranch_scc1 L_fs1_H_standalone__gqa_block_cached__near_ridge_kernel
L_fr1_H_standalone__gqa_block_cached__near_ridge_kernel:
  s_bitcmp1_b32 s47, 2
  s_cbranch_scc1 L_fs2_H_standalone__gqa_block_cached__near_ridge_kernel
L_fr2_H_standalone__gqa_block_cached__near_ridge_kernel:
  s_bitcmp1_b32 s47, 3
  s_cbranch_scc1 L_fs3_H_standalone__gqa_block_cached__near_ridge_kernel
L_fr3_H_standalone__gqa_block_cached__near_ridge_kernel:
  s_bitcmp1_b32 s47, 4
  s_cbranch_scc1 L_fs4_H_standalone__gqa_block_cached__near_ridge_kernel
L_fr4_H_standalone__gqa_block_cached__near_ridge_kernel:
  s_bitcmp1_b32 s47, 5
  s_cbranch_scc1 L_fs5_H_standalone__gqa_block_cached__near_ridge_kernel
L_fr5_H_standalone__gqa_block_cached__near_ridge_kernel:
  s_bitcmp1_b32 s47, 6
  s_cbranch_scc1 L_fs6_H_standalone__gqa_block_cached__near_ridge_kernel
L_fr6_H_standalone__gqa_block_cached__near_ridge_kernel:
  s_bitcmp1_b32 s47, 7
  s_cbranch_scc1 L_fs7_H_standalone__gqa_block_cached__near_ridge_kernel
L_fr7_H_standalone__gqa_block_cached__near_ridge_kernel:
  s_bitcmp1_b32 s47, 8
  s_cbranch_scc1 L_fs8_H_standalone__gqa_block_cached__near_ridge_kernel
L_fr8_H_standalone__gqa_block_cached__near_ridge_kernel:
  s_bitcmp1_b32 s47, 9
  s_cbranch_scc1 L_fs9_H_standalone__gqa_block_cached__near_ridge_kernel
L_fr9_H_standalone__gqa_block_cached__near_ridge_kernel:
  s_bitcmp1_b32 s47, 10
  s_cbranch_scc1 L_fs10_H_standalone__gqa_block_cached__near_ridge_kernel
L_fr10_H_standalone__gqa_block_cached__near_ridge_kernel:
  s_bitcmp1_b32 s47, 11
  s_cbranch_scc1 L_fs11_H_standalone__gqa_block_cached__near_ridge_kernel
L_fr11_H_standalone__gqa_block_cached__near_ridge_kernel:
  s_bitcmp1_b32 s47, 12
  s_cbranch_scc1 L_fs12_H_standalone__gqa_block_cached__near_ridge_kernel
L_fr12_H_standalone__gqa_block_cached__near_ridge_kernel:
  s_bitcmp1_b32 s47, 13
  s_cbranch_scc1 L_fs13_H_standalone__gqa_block_cached__near_ridge_kernel
L_fr13_H_standalone__gqa_block_cached__near_ridge_kernel:
  s_bitcmp1_b32 s47, 14
  s_cbranch_scc1 L_fs14_H_standalone__gqa_block_cached__near_ridge_kernel
L_fr14_H_standalone__gqa_block_cached__near_ridge_kernel:
  s_bitcmp1_b32 s47, 15
  s_cbranch_scc1 L_fs15_H_standalone__gqa_block_cached__near_ridge_kernel
L_fr15_H_standalone__gqa_block_cached__near_ridge_kernel:
  s_andn2_b32 s46, s46, s47
  s_cbranch_scc1 L_pl_H_standalone__gqa_block_cached__near_ridge_kernel
  s_waitcnt vmcnt(0)
  s_mov_b32 s43, 0x3f80
  s_mov_b32 s44, 0x3f800000
  v_dot2_f32_bf16 v4, v12, s43, 0
  v_dot2_f32_bf16 v5, v12, s44, 0
  v_dot2_f32_bf16 v6, v13, s43, 0
  v_dot2_f32_bf16 v7, v13, s44, 0
  v_dot2_f32_bf16 v8, v14, s43, 0
  v_dot2_f32_bf16 v9, v14, s44, 0
  v_dot2_f32_bf16 v10, v15, s43, 0
  v_dot2_f32_bf16 v11, v15, s44, 0
  v_dot2_f32_bf16 v4, v16, s43, v4
  v_dot2_f32_bf16 v5, v16, s44, v5
  v_dot2_f32_bf16 v6, v17, s43, v6
  v_dot2_f32_bf16 v7, v17, s44, v7
  v_dot2_f32_bf16 v8, v18, s43, v8
  v_dot2_f32_bf16 v9, v18, s44, v9
  v_dot2_f32_bf16 v10, v19, s43, v10
  v_dot2_f32_bf16 v11, v19, s44, v11
  v_dot2_f32_bf16 v4, v20, s43, v4
  v_dot2_f32_bf16 v5, v20, s44, v5
  v_dot2_f32_bf16 v6, v21, s43, v6
  v_dot2_f32_bf16 v7, v21, s44, v7
  v_dot2_f32_bf16 v8, v22, s43, v8
  v_dot2_f32_bf16 v9, v22, s44, v9
  v_dot2_f32_bf16 v10, v23, s43, v10
  v_dot2_f32_bf16 v11, v23, s44, v11
  v_dot2_f32_bf16 v4, v24, s43, v4
  v_dot2_f32_bf16 v5, v24, s44, v5
  v_dot2_f32_bf16 v6, v25, s43, v6
  v_dot2_f32_bf16 v7, v25, s44, v7
  v_dot2_f32_bf16 v8, v26, s43, v8
  v_dot2_f32_bf16 v9, v26, s44, v9
  v_dot2_f32_bf16 v10, v27, s43, v10
  v_dot2_f32_bf16 v11, v27, s44, v11
  v_dot2_f32_bf16 v4, v28, s43, v4
  v_dot2_f32_bf16 v5, v28, s44, v5
  v_dot2_f32_bf16 v6, v29, s43, v6
  v_dot2_f32_bf16 v7, v29, s44, v7
  v_dot2_f32_bf16 v8, v30, s43, v8
  v_dot2_f32_bf16 v9, v30, s44, v9
  v_dot2_f32_bf16 v10, v31, s43, v10
  v_dot2_f32_bf16 v11, v31, s44, v11
  v_dot2_f32_bf16 v4, v32, s43, v4
  v_dot2_f32_bf16 v5, v32, s44, v5
  v_dot2_f32_bf16 v6, v33, s43, v6
  v_dot2_f32_bf16 v7, v33, s44, v7
  v_dot2_f32_bf16 v8, v34, s43, v8
  v_dot2_f32_bf16 v9, v34, s44, v9
  v_dot2_f32_bf16 v10, v35, s43, v10
  v_dot2_f32_bf16 v11, v35, s44, v11
  v_dot2_f32_bf16 v4, v36, s43, v4
  v_dot2_f32_bf16 v5, v36, s44, v5
  v_dot2_f32_bf16 v6, v37, s43, v6
  v_dot2_f32_bf16 v7, v37, s44, v7
  v_dot2_f32_bf16 v8, v38, s43, v8
  v_dot2_f32_bf16 v9, v38, s44, v9
  v_dot2_f32_bf16 v10, v39, s43, v10
  v_dot2_f32_bf16 v11, v39, s44, v11
  v_dot2_f32_bf16 v4, v40, s43, v4
  v_dot2_f32_bf16 v5, v40, s44, v5
  v_dot2_f32_bf16 v6, v41, s43, v6
  v_dot2_f32_bf16 v7, v41, s44, v7
  v_dot2_f32_bf16 v8, v42, s43, v8
  v_dot2_f32_bf16 v9, v42, s44, v9
  v_dot2_f32_bf16 v10, v43, s43, v10
  v_dot2_f32_bf16 v11, v43, s44, v11
  s_nop 2
  v_cvt_pk_bf16_f32 v4, v4, v5
  v_cvt_pk_bf16_f32 v5, v6, v7
  v_cvt_pk_bf16_f32 v6, v8, v9
  v_cvt_pk_bf16_f32 v7, v10, v11
  buffer_store_dwordx4 v[4:7], v121, s[36:39], 0 offen sc1
  s_cmp_lt_u32 s40, 2
  s_cbranch_scc1 L_fd_H_standalone__gqa_block_cached__near_ridge_kernel
  v_dot2_f32_bf16 v44, v52, s43, 0
  v_dot2_f32_bf16 v45, v52, s44, 0
  v_dot2_f32_bf16 v46, v53, s43, 0
  v_dot2_f32_bf16 v47, v53, s44, 0
  v_dot2_f32_bf16 v48, v54, s43, 0
  v_dot2_f32_bf16 v49, v54, s44, 0
  v_dot2_f32_bf16 v50, v55, s43, 0
  v_dot2_f32_bf16 v51, v55, s44, 0
  v_dot2_f32_bf16 v44, v56, s43, v44
  v_dot2_f32_bf16 v45, v56, s44, v45
  v_dot2_f32_bf16 v46, v57, s43, v46
  v_dot2_f32_bf16 v47, v57, s44, v47
  v_dot2_f32_bf16 v48, v58, s43, v48
  v_dot2_f32_bf16 v49, v58, s44, v49
  v_dot2_f32_bf16 v50, v59, s43, v50
  v_dot2_f32_bf16 v51, v59, s44, v51
  v_dot2_f32_bf16 v44, v60, s43, v44
  v_dot2_f32_bf16 v45, v60, s44, v45
  v_dot2_f32_bf16 v46, v61, s43, v46
  v_dot2_f32_bf16 v47, v61, s44, v47
  v_dot2_f32_bf16 v48, v62, s43, v48
  v_dot2_f32_bf16 v49, v62, s44, v49
  v_dot2_f32_bf16 v50, v63, s43, v50
  v_dot2_f32_bf16 v51, v63, s44, v51
  v_dot2_f32_bf16 v44, v64, s43, v44
  v_dot2_f32_bf16 v45, v64, s44, v45
  v_dot2_f32_bf16 v46, v65, s43, v46
  v_dot2_f32_bf16 v47, v65, s44, v47
  v_dot2_f32_bf16 v48, v66, s43, v48
  v_dot2_f32_bf16 v49, v66, s44, v49
  v_dot2_f32_bf16 v50, v67, s43, v50
  v_dot2_f32_bf16 v51, v67, s44, v51
  v_dot2_f32_bf16 v44, v68, s43, v44
  v_dot2_f32_bf16 v45, v68, s44, v45
  v_dot2_f32_bf16 v46, v69, s43, v46
  v_dot2_f32_bf16 v47, v69, s44, v47
  v_dot2_f32_bf16 v48, v70, s43, v48
  v_dot2_f32_bf16 v49, v70, s44, v49
  v_dot2_f32_bf16 v50, v71, s43, v50
  v_dot2_f32_bf16 v51, v71, s44, v51
  v_dot2_f32_bf16 v44, v72, s43, v44
  v_dot2_f32_bf16 v45, v72, s44, v45
  v_dot2_f32_bf16 v46, v73, s43, v46
  v_dot2_f32_bf16 v47, v73, s44, v47
  v_dot2_f32_bf16 v48, v74, s43, v48
  v_dot2_f32_bf16 v49, v74, s44, v49
  v_dot2_f32_bf16 v50, v75, s43, v50
  v_dot2_f32_bf16 v51, v75, s44, v51
  v_dot2_f32_bf16 v44, v76, s43, v44
  v_dot2_f32_bf16 v45, v76, s44, v45
  v_dot2_f32_bf16 v46, v77, s43, v46
  v_dot2_f32_bf16 v47, v77, s44, v47
  v_dot2_f32_bf16 v48, v78, s43, v48
  v_dot2_f32_bf16 v49, v78, s44, v49
  v_dot2_f32_bf16 v50, v79, s43, v50
  v_dot2_f32_bf16 v51, v79, s44, v51
  v_dot2_f32_bf16 v44, v80, s43, v44
  v_dot2_f32_bf16 v45, v80, s44, v45
  v_dot2_f32_bf16 v46, v81, s43, v46
  v_dot2_f32_bf16 v47, v81, s44, v47
  v_dot2_f32_bf16 v48, v82, s43, v48
  v_dot2_f32_bf16 v49, v82, s44, v49
  v_dot2_f32_bf16 v50, v83, s43, v50
  v_dot2_f32_bf16 v51, v83, s44, v51
  s_nop 2
  v_cvt_pk_bf16_f32 v44, v44, v45
  v_cvt_pk_bf16_f32 v45, v46, v47
  v_cvt_pk_bf16_f32 v46, v48, v49
  v_cvt_pk_bf16_f32 v47, v50, v51
  buffer_store_dwordx4 v[44:47], v122, s[36:39], 0 offen sc1
L_fd_H_standalone__gqa_block_cached__near_ridge_kernel:
  s_endpgm
L_fs0_H_standalone__gqa_block_cached__near_ridge_kernel:
  s_mov_b32 s50, 0
  buffer_load_dwordx4 v[12:15], v119, s[12:15], s50 offen sc1
  s_branch L_fr0_H_standalone__gqa_block_cached__near_ridge_kernel
L_fs1_H_standalone__gqa_block_cached__near_ridge_kernel:
  s_mov_b32 s50, 46080
  buffer_load_dwordx4 v[16:19], v119, s[12:15], s50 offen sc1
  s_branch L_fr1_H_standalone__gqa_block_cached__near_ridge_kernel
L_fs2_H_standalone__gqa_block_cached__near_ridge_kernel:
  s_mov_b32 s50, 92160
  buffer_load_dwordx4 v[20:23], v119, s[12:15], s50 offen sc1
  s_branch L_fr2_H_standalone__gqa_block_cached__near_ridge_kernel
L_fs3_H_standalone__gqa_block_cached__near_ridge_kernel:
  s_mov_b32 s50, 138240
  buffer_load_dwordx4 v[24:27], v119, s[12:15], s50 offen sc1
  s_branch L_fr3_H_standalone__gqa_block_cached__near_ridge_kernel
L_fs4_H_standalone__gqa_block_cached__near_ridge_kernel:
  s_mov_b32 s50, 184320
  buffer_load_dwordx4 v[28:31], v119, s[12:15], s50 offen sc1
  s_branch L_fr4_H_standalone__gqa_block_cached__near_ridge_kernel
L_fs5_H_standalone__gqa_block_cached__near_ridge_kernel:
  s_mov_b32 s50, 230400
  buffer_load_dwordx4 v[32:35], v119, s[12:15], s50 offen sc1
  s_branch L_fr5_H_standalone__gqa_block_cached__near_ridge_kernel
L_fs6_H_standalone__gqa_block_cached__near_ridge_kernel:
  s_mov_b32 s50, 276480
  buffer_load_dwordx4 v[36:39], v119, s[12:15], s50 offen sc1
  s_branch L_fr6_H_standalone__gqa_block_cached__near_ridge_kernel
L_fs7_H_standalone__gqa_block_cached__near_ridge_kernel:
  s_mov_b32 s50, 322560
  buffer_load_dwordx4 v[40:43], v119, s[12:15], s50 offen sc1
  s_branch L_fr7_H_standalone__gqa_block_cached__near_ridge_kernel
L_fs8_H_standalone__gqa_block_cached__near_ridge_kernel:
  s_mov_b32 s50, 0
  buffer_load_dwordx4 v[52:55], v120, s[12:15], s50 offen sc1
  s_branch L_fr8_H_standalone__gqa_block_cached__near_ridge_kernel
L_fs9_H_standalone__gqa_block_cached__near_ridge_kernel:
  s_mov_b32 s50, 46080
  buffer_load_dwordx4 v[56:59], v120, s[12:15], s50 offen sc1
  s_branch L_fr9_H_standalone__gqa_block_cached__near_ridge_kernel
L_fs10_H_standalone__gqa_block_cached__near_ridge_kernel:
  s_mov_b32 s50, 92160
  buffer_load_dwordx4 v[60:63], v120, s[12:15], s50 offen sc1
  s_branch L_fr10_H_standalone__gqa_block_cached__near_ridge_kernel
L_fs11_H_standalone__gqa_block_cached__near_ridge_kernel:
  s_mov_b32 s50, 138240
  buffer_load_dwordx4 v[64:67], v120, s[12:15], s50 offen sc1
  s_branch L_fr11_H_standalone__gqa_block_cached__near_ridge_kernel
L_fs12_H_standalone__gqa_block_cached__near_ridge_kernel:
  s_mov_b32 s50, 184320
  buffer_load_dwordx4 v[68:71], v120, s[12:15], s50 offen sc1
  s_branch L_fr12_H_standalone__gqa_block_cached__near_ridge_kernel
L_fs13_H_standalone__gqa_block_cached__near_ridge_kernel:
  s_mov_b32 s50, 230400
  buffer_load_dwordx4 v[72:75], v120, s[12:15], s50 offen sc1
  s_branch L_fr13_H_standalone__gqa_block_cached__near_ridge_kernel
L_fs14_H_standalone__gqa_block_cached__near_ridge_kernel:
  s_mov_b32 s50, 276480
  buffer_load_dwordx4 v[76:79], v120, s[12:15], s50 offen sc1
  s_branch L_fr14_H_standalone__gqa_block_cached__near_ridge_kernel
L_fs15_H_standalone__gqa_block_cached__near_ridge_kernel:
  s_mov_b32 s50, 322560
  buffer_load_dwordx4 v[80:83], v120, s[12:15], s50 offen sc1
  s_branch L_fr15_H_standalone__gqa_block_cached__near_ridge_kernel
  s_waitcnt vmcnt(0)
L_HB_standalone__gqa_block_cached__near_ridge_kernel:
  s_waitcnt vmcnt(57)
  s_mov_b32 m0, 24576
  s_lshl_b32 s50, s82, 7
  buffer_load_dwordx4 v93, s[20:23], s50 offen offset:0 lds
  buffer_load_dwordx4 v94, s[20:23], s50 offen offset:1024 lds
  buffer_load_dwordx4 v95, s[20:23], s50 offen offset:2048 lds
  buffer_load_dwordx4 v96, s[20:23], s50 offen offset:3072 lds
  s_waitcnt vmcnt(57)
  s_mov_b32 m0, 28672
  s_add_u32 s50, s50, 40960
  buffer_load_dwordx4 v93, s[20:23], s50 offen offset:0 lds
  buffer_load_dwordx4 v94, s[20:23], s50 offen offset:1024 lds
  buffer_load_dwordx4 v95, s[20:23], s50 offen offset:2048 lds
  buffer_load_dwordx4 v96, s[20:23], s50 offen offset:3072 lds
  s_waitcnt vmcnt(55)
  s_mov_b32 m0, 32768
  s_add_u32 s50, s50, 40960
  buffer_load_dwordx4 v93, s[20:23], s50 offen offset:0 lds
  buffer_load_dwordx4 v94, s[20:23], s50 offen offset:1024 lds
  buffer_load_dwordx4 v95, s[20:23], s50 offen offset:2048 lds
  buffer_load_dwordx4 v96, s[20:23], s50 offen offset:3072 lds
  s_waitcnt vmcnt(55)
  s_mov_b32 m0, 36864
  s_add_u32 s50, s50, 40960
  buffer_load_dwordx4 v93, s[20:23], s50 offen offset:0 lds
  buffer_load_dwordx4 v94, s[20:23], s50 offen offset:1024 lds
  buffer_load_dwordx4 v95, s[20:23], s50 offen offset:2048 lds
  buffer_load_dwordx4 v96, s[20:23], s50 offen offset:3072 lds
  s_mov_b32 m0, 40960
  s_add_u32 s50, s50, 40960
  buffer_load_dwordx4 v93, s[20:23], s50 offen offset:0 lds
  buffer_load_dwordx4 v94, s[20:23], s50 offen offset:1024 lds
  s_waitcnt vmcnt(57)
  s_mov_b32 m0, 43008
  s_lshl_b32 s50, s82, 19
  buffer_load_dwordx4 v97, s[32:35], s50 offen offset:0 lds
  buffer_load_dwordx4 v98, s[32:35], s50 offen offset:1024 lds
  buffer_load_dwordx4 v99, s[32:35], s50 offen offset:2048 lds
  buffer_load_dwordx4 v100, s[32:35], s50 offen offset:3072 lds
  s_waitcnt vmcnt(57)
  s_mov_b32 m0, 47104
  s_add_u32 s50, s50, 131072
  buffer_load_dwordx4 v97, s[32:35], s50 offen offset:0 lds
  buffer_load_dwordx4 v98, s[32:35], s50 offen offset:1024 lds
  buffer_load_dwordx4 v99, s[32:35], s50 offen offset:2048 lds
  buffer_load_dwordx4 v100, s[32:35], s50 offen offset:3072 lds
  s_barrier
  s_waitcnt vmcnt(57)
  s_mov_b32 m0, 51200
  s_add_u32 s50, s50, 131072
  buffer_load_dwordx4 v97, s[32:35], s50 offen offset:0 lds
  buffer_load_dwordx4 v98, s[32:35], s50 offen offset:1024 lds
  buffer_load_dwordx4 v99, s[32:35], s50 offen offset:2048 lds
  buffer_load_dwordx4 v100, s[32:35], s50 offen offset:3072 lds
  s_waitcnt vmcnt(57)
  s_mov_b32 m0, 55296
  s_add_u32 s50, s50, 131072
  buffer_load_dwordx4 v97, s[32:35], s50 offen offset:0 lds
  buffer_load_dwordx4 v98, s[32:35], s50 offen offset:1024 lds
  buffer_load_dwordx4 v99, s[32:35], s50 offen offset:2048 lds
  buffer_load_dwordx4 v100, s[32:35], s50 offen offset:3072 lds
  s_waitcnt vmcnt(57)
  s_mov_b32 s50, 32768
  buffer_load_dwordx4 a[0:3], v105, s[28:31], s50 offen offset:0 nt
  buffer_load_dwordx4 a[4:7], v106, s[28:31], s50 offen offset:1024 nt
  buffer_load_dwordx4 a[8:11], v105, s[28:31], s50 offen offset:2048 nt
  buffer_load_dwordx4 a[12:15], v106, s[28:31], s50 offen offset:3072 nt
  s_waitcnt vmcnt(57)
  s_mov_b32 s50, 36864
  buffer_load_dwordx4 a[16:19], v105, s[28:31], s50 offen offset:0 nt
  buffer_load_dwordx4 a[20:23], v106, s[28:31], s50 offen offset:1024 nt
  buffer_load_dwordx4 a[24:27], v105, s[28:31], s50 offen offset:2048 nt
  buffer_load_dwordx4 a[28:31], v106, s[28:31], s50 offen offset:3072 nt
  s_waitcnt vmcnt(55)
  s_mov_b32 s50, 40960
  buffer_load_dwordx4 a[32:35], v105, s[28:31], s50 offen offset:0 nt
  buffer_load_dwordx4 a[36:39], v106, s[28:31], s50 offen offset:1024 nt
  buffer_load_dwordx4 a[40:43], v105, s[28:31], s50 offen offset:2048 nt
  buffer_load_dwordx4 a[44:47], v106, s[28:31], s50 offen offset:3072 nt
  s_waitcnt vmcnt(55)
  s_mov_b32 s50, 45056
  buffer_load_dwordx4 a[48:51], v105, s[28:31], s50 offen offset:0 nt
  buffer_load_dwordx4 a[52:55], v106, s[28:31], s50 offen offset:1024 nt
  buffer_load_dwordx4 a[56:59], v105, s[28:31], s50 offen offset:2048 nt
  buffer_load_dwordx4 a[60:63], v106, s[28:31], s50 offen offset:3072 nt
  s_waitcnt vmcnt(54)
  s_mov_b32 m0, 59392
  s_lshl_b32 s50, s83, 7
  buffer_load_dwordx4 v93, s[20:23], s50 offen offset:0 lds
  buffer_load_dwordx4 v94, s[20:23], s50 offen offset:1024 lds
  buffer_load_dwordx4 v95, s[20:23], s50 offen offset:2048 lds
  buffer_load_dwordx4 v96, s[20:23], s50 offen offset:3072 lds
  s_waitcnt vmcnt(54)
  s_mov_b32 m0, 63488
  s_add_u32 s50, s50, 40960
  buffer_load_dwordx4 v93, s[20:23], s50 offen offset:0 lds
  buffer_load_dwordx4 v94, s[20:23], s50 offen offset:1024 lds
  buffer_load_dwordx4 v95, s[20:23], s50 offen offset:2048 lds
  buffer_load_dwordx4 v96, s[20:23], s50 offen offset:3072 lds
  s_barrier
  s_waitcnt vmcnt(54)
  s_mov_b32 m0, 67584
  s_add_u32 s50, s50, 40960
  buffer_load_dwordx4 v93, s[20:23], s50 offen offset:0 lds
  buffer_load_dwordx4 v94, s[20:23], s50 offen offset:1024 lds
  buffer_load_dwordx4 v95, s[20:23], s50 offen offset:2048 lds
  buffer_load_dwordx4 v96, s[20:23], s50 offen offset:3072 lds
  s_waitcnt vmcnt(54)
  s_mov_b32 m0, 71680
  s_add_u32 s50, s50, 40960
  buffer_load_dwordx4 v93, s[20:23], s50 offen offset:0 lds
  buffer_load_dwordx4 v94, s[20:23], s50 offen offset:1024 lds
  buffer_load_dwordx4 v95, s[20:23], s50 offen offset:2048 lds
  buffer_load_dwordx4 v96, s[20:23], s50 offen offset:3072 lds
  s_mov_b32 m0, 75776
  s_add_u32 s50, s50, 40960
  buffer_load_dwordx4 v93, s[20:23], s50 offen offset:0 lds
  buffer_load_dwordx4 v94, s[20:23], s50 offen offset:1024 lds
  s_waitcnt vmcnt(56)
  s_mov_b32 m0, 77824
  s_lshl_b32 s50, s83, 19
  buffer_load_dwordx4 v97, s[32:35], s50 offen offset:0 lds
  buffer_load_dwordx4 v98, s[32:35], s50 offen offset:1024 lds
  buffer_load_dwordx4 v99, s[32:35], s50 offen offset:2048 lds
  buffer_load_dwordx4 v100, s[32:35], s50 offen offset:3072 lds
  s_waitcnt vmcnt(56)
  s_mov_b32 m0, 81920
  s_add_u32 s50, s50, 131072
  buffer_load_dwordx4 v97, s[32:35], s50 offen offset:0 lds
  buffer_load_dwordx4 v98, s[32:35], s50 offen offset:1024 lds
  buffer_load_dwordx4 v99, s[32:35], s50 offen offset:2048 lds
  buffer_load_dwordx4 v100, s[32:35], s50 offen offset:3072 lds
  s_waitcnt vmcnt(54)
  s_mov_b32 m0, 86016
  s_add_u32 s50, s50, 131072
  buffer_load_dwordx4 v97, s[32:35], s50 offen offset:0 lds
  buffer_load_dwordx4 v98, s[32:35], s50 offen offset:1024 lds
  buffer_load_dwordx4 v99, s[32:35], s50 offen offset:2048 lds
  buffer_load_dwordx4 v100, s[32:35], s50 offen offset:3072 lds
  s_waitcnt vmcnt(54)
  s_mov_b32 m0, 90112
  s_add_u32 s50, s50, 131072
  buffer_load_dwordx4 v97, s[32:35], s50 offen offset:0 lds
  buffer_load_dwordx4 v98, s[32:35], s50 offen offset:1024 lds
  buffer_load_dwordx4 v99, s[32:35], s50 offen offset:2048 lds
  buffer_load_dwordx4 v100, s[32:35], s50 offen offset:3072 lds
  s_waitcnt vmcnt(54)
  s_mov_b32 m0, 94208
  s_lshl_b32 s50, s84, 7
  buffer_load_dwordx4 v93, s[20:23], s50 offen offset:0 lds
  buffer_load_dwordx4 v94, s[20:23], s50 offen offset:1024 lds
  buffer_load_dwordx4 v95, s[20:23], s50 offen offset:2048 lds
  buffer_load_dwordx4 v96, s[20:23], s50 offen offset:3072 lds
  s_waitcnt vmcnt(54)
  s_mov_b32 m0, 98304
  s_add_u32 s50, s50, 40960
  buffer_load_dwordx4 v93, s[20:23], s50 offen offset:0 lds
  buffer_load_dwordx4 v94, s[20:23], s50 offen offset:1024 lds
  buffer_load_dwordx4 v95, s[20:23], s50 offen offset:2048 lds
  buffer_load_dwordx4 v96, s[20:23], s50 offen offset:3072 lds
  s_barrier
  s_waitcnt vmcnt(54)
  s_mov_b32 m0, 102400
  s_add_u32 s50, s50, 40960
  buffer_load_dwordx4 v93, s[20:23], s50 offen offset:0 lds
  buffer_load_dwordx4 v94, s[20:23], s50 offen offset:1024 lds
  buffer_load_dwordx4 v95, s[20:23], s50 offen offset:2048 lds
  buffer_load_dwordx4 v96, s[20:23], s50 offen offset:3072 lds
  s_waitcnt vmcnt(54)
  s_mov_b32 m0, 106496
  s_add_u32 s50, s50, 40960
  buffer_load_dwordx4 v93, s[20:23], s50 offen offset:0 lds
  buffer_load_dwordx4 v94, s[20:23], s50 offen offset:1024 lds
  buffer_load_dwordx4 v95, s[20:23], s50 offen offset:2048 lds
  buffer_load_dwordx4 v96, s[20:23], s50 offen offset:3072 lds
  s_mov_b32 m0, 110592
  s_add_u32 s50, s50, 40960
  buffer_load_dwordx4 v93, s[20:23], s50 offen offset:0 lds
  buffer_load_dwordx4 v94, s[20:23], s50 offen offset:1024 lds
  s_waitcnt vmcnt(56)
  s_mov_b32 m0, 112640
  s_lshl_b32 s50, s84, 19
  buffer_load_dwordx4 v97, s[32:35], s50 offen offset:0 lds
  buffer_load_dwordx4 v98, s[32:35], s50 offen offset:1024 lds
  buffer_load_dwordx4 v99, s[32:35], s50 offen offset:2048 lds
  buffer_load_dwordx4 v100, s[32:35], s50 offen offset:3072 lds
  s_waitcnt vmcnt(56)
  s_mov_b32 m0, 116736
  s_add_u32 s50, s50, 131072
  buffer_load_dwordx4 v97, s[32:35], s50 offen offset:0 lds
  buffer_load_dwordx4 v98, s[32:35], s50 offen offset:1024 lds
  buffer_load_dwordx4 v99, s[32:35], s50 offen offset:2048 lds
  buffer_load_dwordx4 v100, s[32:35], s50 offen offset:3072 lds
  s_waitcnt vmcnt(56)
  s_mov_b32 m0, 120832
  s_add_u32 s50, s50, 131072
  buffer_load_dwordx4 v97, s[32:35], s50 offen offset:0 lds
  buffer_load_dwordx4 v98, s[32:35], s50 offen offset:1024 lds
  buffer_load_dwordx4 v99, s[32:35], s50 offen offset:2048 lds
  buffer_load_dwordx4 v100, s[32:35], s50 offen offset:3072 lds
  s_waitcnt vmcnt(56)
  s_mov_b32 m0, 124928
  s_add_u32 s50, s50, 131072
  buffer_load_dwordx4 v97, s[32:35], s50 offen offset:0 lds
  buffer_load_dwordx4 v98, s[32:35], s50 offen offset:1024 lds
  buffer_load_dwordx4 v99, s[32:35], s50 offen offset:2048 lds
  buffer_load_dwordx4 v100, s[32:35], s50 offen offset:3072 lds
  s_waitcnt vmcnt(56)
  s_mov_b32 s50, 114688
  buffer_load_dwordx4 a[64:67], v101, s[24:27], s50 offen offset:0 nt
  buffer_load_dwordx4 a[68:71], v102, s[24:27], s50 offen offset:1024 nt
  buffer_load_dwordx4 a[72:75], v103, s[24:27], s50 offen offset:2048 nt
  buffer_load_dwordx4 a[76:79], v104, s[24:27], s50 offen offset:3072 nt
  s_waitcnt vmcnt(56)
  s_mov_b32 s50, 118784
  buffer_load_dwordx4 a[80:83], v101, s[24:27], s50 offen offset:0 nt
  buffer_load_dwordx4 a[84:87], v102, s[24:27], s50 offen offset:1024 nt
  buffer_load_dwordx4 a[88:91], v103, s[24:27], s50 offen offset:2048 nt
  buffer_load_dwordx4 a[92:95], v104, s[24:27], s50 offen offset:3072 nt
  s_waitcnt vmcnt(54)
  s_mov_b32 s50, 122880
  buffer_load_dwordx4 a[96:99], v101, s[24:27], s50 offen offset:0 nt
  buffer_load_dwordx4 a[100:103], v102, s[24:27], s50 offen offset:1024 nt
  buffer_load_dwordx4 a[104:107], v103, s[24:27], s50 offen offset:2048 nt
  buffer_load_dwordx4 a[108:111], v104, s[24:27], s50 offen offset:3072 nt
  s_waitcnt vmcnt(54)
  s_mov_b32 s50, 126976
  buffer_load_dwordx4 a[112:115], v101, s[24:27], s50 offen offset:0 nt
  buffer_load_dwordx4 a[116:119], v102, s[24:27], s50 offen offset:1024 nt
  buffer_load_dwordx4 a[120:123], v103, s[24:27], s50 offen offset:2048 nt
  buffer_load_dwordx4 a[124:127], v104, s[24:27], s50 offen offset:3072 nt
  s_waitcnt vmcnt(54)
  s_mov_b32 m0, 129024
  s_lshl_b32 s50, s85, 7
  buffer_load_dwordx4 v93, s[20:23], s50 offen offset:0 lds
  buffer_load_dwordx4 v94, s[20:23], s50 offen offset:1024 lds
  buffer_load_dwordx4 v95, s[20:23], s50 offen offset:2048 lds
  buffer_load_dwordx4 v96, s[20:23], s50 offen offset:3072 lds
  s_waitcnt vmcnt(54)
  s_mov_b32 m0, 133120
  s_add_u32 s50, s50, 40960
  buffer_load_dwordx4 v93, s[20:23], s50 offen offset:0 lds
  buffer_load_dwordx4 v94, s[20:23], s50 offen offset:1024 lds
  buffer_load_dwordx4 v95, s[20:23], s50 offen offset:2048 lds
  buffer_load_dwordx4 v96, s[20:23], s50 offen offset:3072 lds
  s_barrier
  s_waitcnt vmcnt(54)
  s_mov_b32 m0, 137216
  s_add_u32 s50, s50, 40960
  buffer_load_dwordx4 v93, s[20:23], s50 offen offset:0 lds
  buffer_load_dwordx4 v94, s[20:23], s50 offen offset:1024 lds
  buffer_load_dwordx4 v95, s[20:23], s50 offen offset:2048 lds
  buffer_load_dwordx4 v96, s[20:23], s50 offen offset:3072 lds
  s_waitcnt vmcnt(54)
  s_mov_b32 m0, 141312
  s_add_u32 s50, s50, 40960
  buffer_load_dwordx4 v93, s[20:23], s50 offen offset:0 lds
  buffer_load_dwordx4 v94, s[20:23], s50 offen offset:1024 lds
  buffer_load_dwordx4 v95, s[20:23], s50 offen offset:2048 lds
  buffer_load_dwordx4 v96, s[20:23], s50 offen offset:3072 lds
  s_mov_b32 m0, 145408
  s_add_u32 s50, s50, 40960
  buffer_load_dwordx4 v93, s[20:23], s50 offen offset:0 lds
  buffer_load_dwordx4 v94, s[20:23], s50 offen offset:1024 lds
  s_waitcnt vmcnt(56)
  s_mov_b32 m0, 147456
  s_lshl_b32 s50, s85, 19
  buffer_load_dwordx4 v97, s[32:35], s50 offen offset:0 lds
  buffer_load_dwordx4 v98, s[32:35], s50 offen offset:1024 lds
  buffer_load_dwordx4 v99, s[32:35], s50 offen offset:2048 lds
  buffer_load_dwordx4 v100, s[32:35], s50 offen offset:3072 lds
  s_waitcnt vmcnt(56)
  s_mov_b32 m0, 151552
  s_add_u32 s50, s50, 131072
  buffer_load_dwordx4 v97, s[32:35], s50 offen offset:0 lds
  buffer_load_dwordx4 v98, s[32:35], s50 offen offset:1024 lds
  buffer_load_dwordx4 v99, s[32:35], s50 offen offset:2048 lds
  buffer_load_dwordx4 v100, s[32:35], s50 offen offset:3072 lds
  s_waitcnt vmcnt(54)
  s_mov_b32 m0, 155648
  s_add_u32 s50, s50, 131072
  buffer_load_dwordx4 v97, s[32:35], s50 offen offset:0 lds
  buffer_load_dwordx4 v98, s[32:35], s50 offen offset:1024 lds
  buffer_load_dwordx4 v99, s[32:35], s50 offen offset:2048 lds
  buffer_load_dwordx4 v100, s[32:35], s50 offen offset:3072 lds
  s_waitcnt vmcnt(54)
  s_mov_b32 m0, 159744
  s_add_u32 s50, s50, 131072
  buffer_load_dwordx4 v97, s[32:35], s50 offen offset:0 lds
  buffer_load_dwordx4 v98, s[32:35], s50 offen offset:1024 lds
  buffer_load_dwordx4 v99, s[32:35], s50 offen offset:2048 lds
  buffer_load_dwordx4 v100, s[32:35], s50 offen offset:3072 lds
  s_waitcnt vmcnt(54)
  s_mov_b32 m0, 24576
  s_lshl_b32 s50, s86, 7
  buffer_load_dwordx4 v93, s[20:23], s50 offen offset:0 lds
  buffer_load_dwordx4 v94, s[20:23], s50 offen offset:1024 lds
  buffer_load_dwordx4 v95, s[20:23], s50 offen offset:2048 lds
  buffer_load_dwordx4 v96, s[20:23], s50 offen offset:3072 lds
  s_waitcnt vmcnt(54)
  s_mov_b32 m0, 28672
  s_add_u32 s50, s50, 40960
  buffer_load_dwordx4 v93, s[20:23], s50 offen offset:0 lds
  buffer_load_dwordx4 v94, s[20:23], s50 offen offset:1024 lds
  buffer_load_dwordx4 v95, s[20:23], s50 offen offset:2048 lds
  buffer_load_dwordx4 v96, s[20:23], s50 offen offset:3072 lds
  s_barrier
  s_waitcnt vmcnt(54)
  s_mov_b32 m0, 32768
  s_add_u32 s50, s50, 40960
  buffer_load_dwordx4 v93, s[20:23], s50 offen offset:0 lds
  buffer_load_dwordx4 v94, s[20:23], s50 offen offset:1024 lds
  buffer_load_dwordx4 v95, s[20:23], s50 offen offset:2048 lds
  buffer_load_dwordx4 v96, s[20:23], s50 offen offset:3072 lds
  s_waitcnt vmcnt(54)
  s_mov_b32 m0, 36864
  s_add_u32 s50, s50, 40960
  buffer_load_dwordx4 v93, s[20:23], s50 offen offset:0 lds
  buffer_load_dwordx4 v94, s[20:23], s50 offen offset:1024 lds
  buffer_load_dwordx4 v95, s[20:23], s50 offen offset:2048 lds
  buffer_load_dwordx4 v96, s[20:23], s50 offen offset:3072 lds
  s_mov_b32 m0, 40960
  s_add_u32 s50, s50, 40960
  buffer_load_dwordx4 v93, s[20:23], s50 offen offset:0 lds
  buffer_load_dwordx4 v94, s[20:23], s50 offen offset:1024 lds
  s_waitcnt vmcnt(56)
  s_mov_b32 m0, 43008
  s_lshl_b32 s50, s86, 19
  buffer_load_dwordx4 v97, s[32:35], s50 offen offset:0 lds
  buffer_load_dwordx4 v98, s[32:35], s50 offen offset:1024 lds
  buffer_load_dwordx4 v99, s[32:35], s50 offen offset:2048 lds
  buffer_load_dwordx4 v100, s[32:35], s50 offen offset:3072 lds
  s_waitcnt vmcnt(56)
  s_mov_b32 m0, 47104
  s_add_u32 s50, s50, 131072
  buffer_load_dwordx4 v97, s[32:35], s50 offen offset:0 lds
  buffer_load_dwordx4 v98, s[32:35], s50 offen offset:1024 lds
  buffer_load_dwordx4 v99, s[32:35], s50 offen offset:2048 lds
  buffer_load_dwordx4 v100, s[32:35], s50 offen offset:3072 lds
  s_waitcnt vmcnt(56)
  s_mov_b32 m0, 51200
  s_add_u32 s50, s50, 131072
  buffer_load_dwordx4 v97, s[32:35], s50 offen offset:0 lds
  buffer_load_dwordx4 v98, s[32:35], s50 offen offset:1024 lds
  buffer_load_dwordx4 v99, s[32:35], s50 offen offset:2048 lds
  buffer_load_dwordx4 v100, s[32:35], s50 offen offset:3072 lds
  s_waitcnt vmcnt(56)
  s_mov_b32 m0, 55296
  s_add_u32 s50, s50, 131072
  buffer_load_dwordx4 v97, s[32:35], s50 offen offset:0 lds
  buffer_load_dwordx4 v98, s[32:35], s50 offen offset:1024 lds
  buffer_load_dwordx4 v99, s[32:35], s50 offen offset:2048 lds
  buffer_load_dwordx4 v100, s[32:35], s50 offen offset:3072 lds
  s_waitcnt vmcnt(56)
  s_mov_b32 s50, 147456
  buffer_load_dwordx4 a[128:131], v105, s[28:31], s50 offen offset:0 nt
  buffer_load_dwordx4 a[132:135], v106, s[28:31], s50 offen offset:1024 nt
  buffer_load_dwordx4 a[136:139], v105, s[28:31], s50 offen offset:2048 nt
  buffer_load_dwordx4 a[140:143], v106, s[28:31], s50 offen offset:3072 nt
  s_waitcnt vmcnt(56)
  s_mov_b32 s50, 151552
  buffer_load_dwordx4 a[144:147], v105, s[28:31], s50 offen offset:0 nt
  buffer_load_dwordx4 a[148:151], v106, s[28:31], s50 offen offset:1024 nt
  buffer_load_dwordx4 a[152:155], v105, s[28:31], s50 offen offset:2048 nt
  buffer_load_dwordx4 a[156:159], v106, s[28:31], s50 offen offset:3072 nt
  s_waitcnt vmcnt(54)
  s_mov_b32 s50, 155648
  buffer_load_dwordx4 a[160:163], v105, s[28:31], s50 offen offset:0 nt
  buffer_load_dwordx4 a[164:167], v106, s[28:31], s50 offen offset:1024 nt
  buffer_load_dwordx4 a[168:171], v105, s[28:31], s50 offen offset:2048 nt
  buffer_load_dwordx4 a[172:175], v106, s[28:31], s50 offen offset:3072 nt
  s_waitcnt vmcnt(54)
  s_mov_b32 s50, 159744
  buffer_load_dwordx4 a[176:179], v105, s[28:31], s50 offen offset:0 nt
  buffer_load_dwordx4 a[180:183], v106, s[28:31], s50 offen offset:1024 nt
  buffer_load_dwordx4 a[184:187], v105, s[28:31], s50 offen offset:2048 nt
  buffer_load_dwordx4 a[188:191], v106, s[28:31], s50 offen offset:3072 nt
  s_waitcnt vmcnt(54)
  s_mov_b32 m0, 59392
  s_lshl_b32 s50, s87, 7
  buffer_load_dwordx4 v93, s[20:23], s50 offen offset:0 lds
  buffer_load_dwordx4 v94, s[20:23], s50 offen offset:1024 lds
  buffer_load_dwordx4 v95, s[20:23], s50 offen offset:2048 lds
  buffer_load_dwordx4 v96, s[20:23], s50 offen offset:3072 lds
  s_waitcnt vmcnt(54)
  s_mov_b32 m0, 63488
  s_add_u32 s50, s50, 40960
  buffer_load_dwordx4 v93, s[20:23], s50 offen offset:0 lds
  buffer_load_dwordx4 v94, s[20:23], s50 offen offset:1024 lds
  buffer_load_dwordx4 v95, s[20:23], s50 offen offset:2048 lds
  buffer_load_dwordx4 v96, s[20:23], s50 offen offset:3072 lds
  s_barrier
  s_waitcnt vmcnt(54)
  s_mov_b32 m0, 67584
  s_add_u32 s50, s50, 40960
  buffer_load_dwordx4 v93, s[20:23], s50 offen offset:0 lds
  buffer_load_dwordx4 v94, s[20:23], s50 offen offset:1024 lds
  buffer_load_dwordx4 v95, s[20:23], s50 offen offset:2048 lds
  buffer_load_dwordx4 v96, s[20:23], s50 offen offset:3072 lds
  s_waitcnt vmcnt(54)
  s_mov_b32 m0, 71680
  s_add_u32 s50, s50, 40960
  buffer_load_dwordx4 v93, s[20:23], s50 offen offset:0 lds
  buffer_load_dwordx4 v94, s[20:23], s50 offen offset:1024 lds
  buffer_load_dwordx4 v95, s[20:23], s50 offen offset:2048 lds
  buffer_load_dwordx4 v96, s[20:23], s50 offen offset:3072 lds
  s_mov_b32 m0, 75776
  s_add_u32 s50, s50, 40960
  buffer_load_dwordx4 v93, s[20:23], s50 offen offset:0 lds
  buffer_load_dwordx4 v94, s[20:23], s50 offen offset:1024 lds
  s_waitcnt vmcnt(56)
  s_mov_b32 m0, 77824
  s_lshl_b32 s50, s87, 19
  buffer_load_dwordx4 v97, s[32:35], s50 offen offset:0 lds
  buffer_load_dwordx4 v98, s[32:35], s50 offen offset:1024 lds
  buffer_load_dwordx4 v99, s[32:35], s50 offen offset:2048 lds
  buffer_load_dwordx4 v100, s[32:35], s50 offen offset:3072 lds
  s_waitcnt vmcnt(56)
  s_mov_b32 m0, 81920
  s_add_u32 s50, s50, 131072
  buffer_load_dwordx4 v97, s[32:35], s50 offen offset:0 lds
  buffer_load_dwordx4 v98, s[32:35], s50 offen offset:1024 lds
  buffer_load_dwordx4 v99, s[32:35], s50 offen offset:2048 lds
  buffer_load_dwordx4 v100, s[32:35], s50 offen offset:3072 lds
  s_waitcnt vmcnt(54)
  s_mov_b32 m0, 86016
  s_add_u32 s50, s50, 131072
  buffer_load_dwordx4 v97, s[32:35], s50 offen offset:0 lds
  buffer_load_dwordx4 v98, s[32:35], s50 offen offset:1024 lds
  buffer_load_dwordx4 v99, s[32:35], s50 offen offset:2048 lds
  buffer_load_dwordx4 v100, s[32:35], s50 offen offset:3072 lds
  s_waitcnt vmcnt(54)
  s_mov_b32 m0, 90112
  s_add_u32 s50, s50, 131072
  buffer_load_dwordx4 v97, s[32:35], s50 offen offset:0 lds
  buffer_load_dwordx4 v98, s[32:35], s50 offen offset:1024 lds
  buffer_load_dwordx4 v99, s[32:35], s50 offen offset:2048 lds
  buffer_load_dwordx4 v100, s[32:35], s50 offen offset:3072 lds
  s_waitcnt vmcnt(54)
  s_mov_b32 m0, 94208
  s_lshl_b32 s50, s88, 7
  buffer_load_dwordx4 v93, s[20:23], s50 offen offset:0 lds
  buffer_load_dwordx4 v94, s[20:23], s50 offen offset:1024 lds
  buffer_load_dwordx4 v95, s[20:23], s50 offen offset:2048 lds
  buffer_load_dwordx4 v96, s[20:23], s50 offen offset:3072 lds
  s_waitcnt vmcnt(54)
  s_mov_b32 m0, 98304
  s_add_u32 s50, s50, 40960
  buffer_load_dwordx4 v93, s[20:23], s50 offen offset:0 lds
  buffer_load_dwordx4 v94, s[20:23], s50 offen offset:1024 lds
  buffer_load_dwordx4 v95, s[20:23], s50 offen offset:2048 lds
  buffer_load_dwordx4 v96, s[20:23], s50 offen offset:3072 lds
  s_barrier
  s_waitcnt vmcnt(54)
  s_mov_b32 m0, 102400
  s_add_u32 s50, s50, 40960
  buffer_load_dwordx4 v93, s[20:23], s50 offen offset:0 lds
  buffer_load_dwordx4 v94, s[20:23], s50 offen offset:1024 lds
  buffer_load_dwordx4 v95, s[20:23], s50 offen offset:2048 lds
  buffer_load_dwordx4 v96, s[20:23], s50 offen offset:3072 lds
  s_waitcnt vmcnt(54)
  s_mov_b32 m0, 106496
  s_add_u32 s50, s50, 40960
  buffer_load_dwordx4 v93, s[20:23], s50 offen offset:0 lds
  buffer_load_dwordx4 v94, s[20:23], s50 offen offset:1024 lds
  buffer_load_dwordx4 v95, s[20:23], s50 offen offset:2048 lds
  buffer_load_dwordx4 v96, s[20:23], s50 offen offset:3072 lds
  s_mov_b32 m0, 110592
  s_add_u32 s50, s50, 40960
  buffer_load_dwordx4 v93, s[20:23], s50 offen offset:0 lds
  buffer_load_dwordx4 v94, s[20:23], s50 offen offset:1024 lds
  s_waitcnt vmcnt(56)
  s_mov_b32 m0, 112640
  s_lshl_b32 s50, s88, 19
  buffer_load_dwordx4 v97, s[32:35], s50 offen offset:0 lds
  buffer_load_dwordx4 v98, s[32:35], s50 offen offset:1024 lds
  buffer_load_dwordx4 v99, s[32:35], s50 offen offset:2048 lds
  buffer_load_dwordx4 v100, s[32:35], s50 offen offset:3072 lds
  s_waitcnt vmcnt(56)
  s_mov_b32 m0, 116736
  s_add_u32 s50, s50, 131072
  buffer_load_dwordx4 v97, s[32:35], s50 offen offset:0 lds
  buffer_load_dwordx4 v98, s[32:35], s50 offen offset:1024 lds
  buffer_load_dwordx4 v99, s[32:35], s50 offen offset:2048 lds
  buffer_load_dwordx4 v100, s[32:35], s50 offen offset:3072 lds
  s_waitcnt vmcnt(56)
  s_mov_b32 m0, 120832
  s_add_u32 s50, s50, 131072
  buffer_load_dwordx4 v97, s[32:35], s50 offen offset:0 lds
  buffer_load_dwordx4 v98, s[32:35], s50 offen offset:1024 lds
  buffer_load_dwordx4 v99, s[32:35], s50 offen offset:2048 lds
  buffer_load_dwordx4 v100, s[32:35], s50 offen offset:3072 lds
  s_waitcnt vmcnt(56)
  s_mov_b32 m0, 124928
  s_add_u32 s50, s50, 131072
  buffer_load_dwordx4 v97, s[32:35], s50 offen offset:0 lds
  buffer_load_dwordx4 v98, s[32:35], s50 offen offset:1024 lds
  buffer_load_dwordx4 v99, s[32:35], s50 offen offset:2048 lds
  buffer_load_dwordx4 v100, s[32:35], s50 offen offset:3072 lds
  s_waitcnt vmcnt(56)
  s_mov_b32 s50, 229376
  buffer_load_dwordx4 a[192:195], v101, s[24:27], s50 offen offset:0 nt
  buffer_load_dwordx4 a[196:199], v102, s[24:27], s50 offen offset:1024 nt
  buffer_load_dwordx4 a[200:203], v103, s[24:27], s50 offen offset:2048 nt
  buffer_load_dwordx4 a[204:207], v104, s[24:27], s50 offen offset:3072 nt
  s_waitcnt vmcnt(56)
  s_mov_b32 s50, 233472
  buffer_load_dwordx4 a[208:211], v101, s[24:27], s50 offen offset:0 nt
  buffer_load_dwordx4 a[212:215], v102, s[24:27], s50 offen offset:1024 nt
  buffer_load_dwordx4 a[216:219], v103, s[24:27], s50 offen offset:2048 nt
  buffer_load_dwordx4 a[220:223], v104, s[24:27], s50 offen offset:3072 nt
  s_waitcnt vmcnt(54)
  s_mov_b32 s50, 237568
  buffer_load_dwordx4 a[224:227], v101, s[24:27], s50 offen offset:0 nt
  buffer_load_dwordx4 a[228:231], v102, s[24:27], s50 offen offset:1024 nt
  buffer_load_dwordx4 a[232:235], v103, s[24:27], s50 offen offset:2048 nt
  buffer_load_dwordx4 a[236:239], v104, s[24:27], s50 offen offset:3072 nt
  s_waitcnt vmcnt(54)
  s_mov_b32 s50, 241664
  buffer_load_dwordx4 a[240:243], v101, s[24:27], s50 offen offset:0 nt
  buffer_load_dwordx4 a[244:247], v102, s[24:27], s50 offen offset:1024 nt
  buffer_load_dwordx4 a[248:251], v103, s[24:27], s50 offen offset:2048 nt
  buffer_load_dwordx4 a[252:255], v104, s[24:27], s50 offen offset:3072 nt
  s_waitcnt vmcnt(54)
  s_mov_b32 m0, 129024
  s_lshl_b32 s50, s89, 7
  buffer_load_dwordx4 v93, s[20:23], s50 offen offset:0 lds
  buffer_load_dwordx4 v94, s[20:23], s50 offen offset:1024 lds
  buffer_load_dwordx4 v95, s[20:23], s50 offen offset:2048 lds
  buffer_load_dwordx4 v96, s[20:23], s50 offen offset:3072 lds
  s_waitcnt vmcnt(54)
  s_mov_b32 m0, 133120
  s_add_u32 s50, s50, 40960
  buffer_load_dwordx4 v93, s[20:23], s50 offen offset:0 lds
  buffer_load_dwordx4 v94, s[20:23], s50 offen offset:1024 lds
  buffer_load_dwordx4 v95, s[20:23], s50 offen offset:2048 lds
  buffer_load_dwordx4 v96, s[20:23], s50 offen offset:3072 lds
  s_barrier
  s_waitcnt vmcnt(54)
  s_mov_b32 m0, 137216
  s_add_u32 s50, s50, 40960
  buffer_load_dwordx4 v93, s[20:23], s50 offen offset:0 lds
  buffer_load_dwordx4 v94, s[20:23], s50 offen offset:1024 lds
  buffer_load_dwordx4 v95, s[20:23], s50 offen offset:2048 lds
  buffer_load_dwordx4 v96, s[20:23], s50 offen offset:3072 lds
  s_waitcnt vmcnt(54)
  s_mov_b32 m0, 141312
  s_add_u32 s50, s50, 40960
  buffer_load_dwordx4 v93, s[20:23], s50 offen offset:0 lds
  buffer_load_dwordx4 v94, s[20:23], s50 offen offset:1024 lds
  buffer_load_dwordx4 v95, s[20:23], s50 offen offset:2048 lds
  buffer_load_dwordx4 v96, s[20:23], s50 offen offset:3072 lds
  s_mov_b32 m0, 145408
  s_add_u32 s50, s50, 40960
  buffer_load_dwordx4 v93, s[20:23], s50 offen offset:0 lds
  buffer_load_dwordx4 v94, s[20:23], s50 offen offset:1024 lds
  s_waitcnt vmcnt(56)
  s_mov_b32 m0, 147456
  s_lshl_b32 s50, s89, 19
  buffer_load_dwordx4 v97, s[32:35], s50 offen offset:0 lds
  buffer_load_dwordx4 v98, s[32:35], s50 offen offset:1024 lds
  buffer_load_dwordx4 v99, s[32:35], s50 offen offset:2048 lds
  buffer_load_dwordx4 v100, s[32:35], s50 offen offset:3072 lds
  s_waitcnt vmcnt(56)
  s_mov_b32 m0, 151552
  s_add_u32 s50, s50, 131072
  buffer_load_dwordx4 v97, s[32:35], s50 offen offset:0 lds
  buffer_load_dwordx4 v98, s[32:35], s50 offen offset:1024 lds
  buffer_load_dwordx4 v99, s[32:35], s50 offen offset:2048 lds
  buffer_load_dwordx4 v100, s[32:35], s50 offen offset:3072 lds
  s_waitcnt vmcnt(54)
  s_mov_b32 m0, 155648
  s_add_u32 s50, s50, 131072
  buffer_load_dwordx4 v97, s[32:35], s50 offen offset:0 lds
  buffer_load_dwordx4 v98, s[32:35], s50 offen offset:1024 lds
  buffer_load_dwordx4 v99, s[32:35], s50 offen offset:2048 lds
  buffer_load_dwordx4 v100, s[32:35], s50 offen offset:3072 lds
  s_waitcnt vmcnt(54)
  s_mov_b32 m0, 159744
  s_add_u32 s50, s50, 131072
  buffer_load_dwordx4 v97, s[32:35], s50 offen offset:0 lds
  buffer_load_dwordx4 v98, s[32:35], s50 offen offset:1024 lds
  buffer_load_dwordx4 v99, s[32:35], s50 offen offset:2048 lds
  buffer_load_dwordx4 v100, s[32:35], s50 offen offset:3072 lds
  s_waitcnt vmcnt(54)
  s_mov_b32 m0, 0
  s_mov_b32 s50, 0
  buffer_load_dwordx4 v101, s[24:27], s50 offen offset:0 nt lds
  buffer_load_dwordx4 v102, s[24:27], s50 offen offset:1024 nt lds
  buffer_load_dwordx4 v103, s[24:27], s50 offen offset:2048 nt lds
  buffer_load_dwordx4 v104, s[24:27], s50 offen offset:3072 nt lds
  s_waitcnt vmcnt(54)
  s_mov_b32 m0, 4096
  s_mov_b32 s50, 4096
  buffer_load_dwordx4 v101, s[24:27], s50 offen offset:0 nt lds
  buffer_load_dwordx4 v102, s[24:27], s50 offen offset:1024 nt lds
  buffer_load_dwordx4 v103, s[24:27], s50 offen offset:2048 nt lds
  buffer_load_dwordx4 v104, s[24:27], s50 offen offset:3072 nt lds
  s_barrier
  s_waitcnt vmcnt(54)
  s_mov_b32 m0, 8192
  s_mov_b32 s50, 8192
  buffer_load_dwordx4 v101, s[24:27], s50 offen offset:0 nt lds
  buffer_load_dwordx4 v102, s[24:27], s50 offen offset:1024 nt lds
  buffer_load_dwordx4 v103, s[24:27], s50 offen offset:2048 nt lds
  buffer_load_dwordx4 v104, s[24:27], s50 offen offset:3072 nt lds
  s_waitcnt vmcnt(54)
  s_mov_b32 m0, 12288
  s_mov_b32 s50, 12288
  buffer_load_dwordx4 v101, s[24:27], s50 offen offset:0 nt lds
  buffer_load_dwordx4 v102, s[24:27], s50 offen offset:1024 nt lds
  buffer_load_dwordx4 v103, s[24:27], s50 offen offset:2048 nt lds
  buffer_load_dwordx4 v104, s[24:27], s50 offen offset:3072 nt lds
  s_waitcnt vmcnt(54)
  s_waitcnt vmcnt(50)
  s_waitcnt vmcnt(46)
  s_waitcnt vmcnt(42)
  s_waitcnt vmcnt(38)
  s_waitcnt vmcnt(34)
  s_waitcnt vmcnt(28)
  s_waitcnt vmcnt(24)
  s_mov_b32 m0, 16384
  s_mov_b32 s50, 16384
  buffer_load_dwordx4 v101, s[24:27], s50 offen offset:0 nt lds
  buffer_load_dwordx4 v102, s[24:27], s50 offen offset:1024 nt lds
  buffer_load_dwordx4 v103, s[24:27], s50 offen offset:2048 nt lds
  buffer_load_dwordx4 v104, s[24:27], s50 offen offset:3072 nt lds
  s_waitcnt vmcnt(24)
  s_mov_b32 m0, 20480
  s_mov_b32 s50, 20480
  buffer_load_dwordx4 v101, s[24:27], s50 offen offset:0 nt lds
  buffer_load_dwordx4 v102, s[24:27], s50 offen offset:1024 nt lds
  buffer_load_dwordx4 v103, s[24:27], s50 offen offset:2048 nt lds
  buffer_load_dwordx4 v104, s[24:27], s50 offen offset:3072 nt lds
  s_waitcnt vmcnt(24)
  s_mov_b32 m0, 24576
  s_mov_b32 s50, 24576
  buffer_load_dwordx4 v101, s[24:27], s50 offen offset:0 nt lds
  buffer_load_dwordx4 v102, s[24:27], s50 offen offset:1024 nt lds
  buffer_load_dwordx4 v103, s[24:27], s50 offen offset:2048 nt lds
  buffer_load_dwordx4 v104, s[24:27], s50 offen offset:3072 nt lds
  s_barrier
  s_branch L_HJ_standalone__gqa_block_cached__near_ridge_kernel
L_Cw_standalone__gqa_block_cached__near_ridge_kernel:
  s_waitcnt lgkmcnt(0)
.p2align 3
L_C_standalone__gqa_block_cached__near_ridge_kernel:
  s_getpc_b64 s[44:45]
L_pc_standalone__gqa_block_cached__near_ridge_kernel:
  s_lshr_b32 s43, s2, 3
  s_mul_i32 s43, s43, 3
  s_add_u32 s43, s43, s40
  s_mul_i32 s43, s43, 768
  v_and_b32 v206, 63, v0
  v_mul_u32_u24 v206, 12, v206
  v_add_u32_e64 v206, s43, v206
  v_min_u32 v206, L_cend_standalone__gqa_block_cached__near_ridge_kernel-standalone__gqa_block_cached__near_ridge_kernel-8, v206
  s_sub_u32 s44, s44, L_pc_standalone__gqa_block_cached__near_ridge_kernel-standalone__gqa_block_cached__near_ridge_kernel
  s_subb_u32 s45, s45, 0
  v_mov_b32 v197, s45
  v_add_co_u32 v196, vcc, s44, v206
  s_nop 1
  v_addc_co_u32 v197, vcc, 0, v197, vcc
  global_load_dword v228, v[196:197], off
  s_lshr_b32 s43, s42, 2
  s_lshl_b32 s95, s43, 12
  s_mul_i32 s44, s3, 320
  s_mul_i32 s48, s41, 184320
  s_add_u32 s48, s48, s44
  s_add_u32 s36, s14, s48
  s_addc_u32 s37, s15, 0
  s_mov_b32 s38, 183360
  s_mov_b32 s39, 0x20000
  s_mul_i32 s48, s43, 163840
  s_add_u32 s48, s48, s44
  s_add_u32 s4, s12, s48
  s_addc_u32 s5, s13, 0
  s_mov_b32 s6, 4095040
  s_mov_b32 s7, 0x20000
  s_sub_u32 s48, s94, s3
  s_mul_i32 s48, s48, 36864
  s_add_u32 s8, s18, s48
  s_addc_u32 s9, s19, 0
  s_mov_b32 s10, 147456
  s_mov_b32 s11, 0x20000
  s_lshl_b32 s48, s41, 2
  s_add_u32 s48, s48, s3
  s_mul_i32 s48, s48, 368640
  s_add_u32 s48, s48, 16777216
  s_add_u32 s12, s18, s48
  s_addc_u32 s13, s19, 0
  s_mov_b32 s14, 368640
  s_mov_b32 s15, 0x20000
  s_lshl_b32 s48, s41, 15
  s_add_u32 s48, s48, 50331648
  s_add_u32 s16, s18, s48
  s_addc_u32 s17, s19, 0
  s_mov_b32 s18, 32768
  s_mov_b32 s19, 0x20000
  v_and_b32 v226, 63, v0
  s_add_u32 s43, s3, 1
  v_add_u32 v206, s43, v226
  v_and_b32 v206, 3, v206
  v_lshlrev_b32 v206, 10, v206
  s_lshl_b32 s43, s40, 7
  v_and_b32 v212, 4, v226
  v_lshl_add_u32 v206, v212, 7, v206
  v_add_u32_e64 v229, s43, v206
  s_mov_b64 exec, 0x8f
  buffer_load_dword v227, v229, s[16:19], s95 offen sc1
  s_mov_b64 exec, -1
  v_and_b32 v207, 15, v226
  v_lshrrev_b32_e64 v208, 4, v226
  v_bfe_u32 v209, v226, 2, 2
  v_and_b32_e64 v210, 3, v226
  v_bfe_u32 v211, v226, 4, 1
  v_lshlrev_b32_e64 v211, 1, v211
  s_mul_i32 s43, s40, 6144
  s_add_u32 s43, s43, 94208
  v_lshrrev_b32 v212, 1, v207
  v_lshlrev_b32 v213, 7, v207
  v_add_u32 v213, s43, v213
  v_add_u32 v206, 0, v208
  v_xor_b32_e64 v206, v206, v212
  v_lshl_add_u32 v124, v206, 4, v213
  v_add_u32 v206, 4, v208
  v_xor_b32 v206, v206, v212
  v_lshl_add_u32 v125, v206, 4, v213
  v_lshrrev_b32 v206, 1, v210
  v_lshlrev_b32 v213, 2, v209
  v_xor_b32 v206, v206, v213
  v_xor_b32 v206, v206, v211
  v_lshl_add_u32 v213, v208, 3, v209
  v_lshlrev_b32 v213, 8, v213
  v_and_b32 v212, 1, v210
  v_lshl_add_u32 v213, v212, 3, v213
  v_add_u32 v213, 112640, v213
  v_xor_b32_e64 v212, 0, v206
  v_lshl_add_u32 v126, v212, 4, v213
  v_xor_b32_e64 v212, 2, v206
  v_lshl_add_u32 v127, v212, 4, v213
  v_xor_b32_e64 v212, 4, v206
  v_lshl_add_u32 v128, v212, 4, v213
  v_xor_b32_e64 v212, 6, v206
  v_lshl_add_u32 v129, v212, 4, v213
  v_xor_b32_e64 v212, 8, v206
  v_lshl_add_u32 v130, v212, 4, v213
  v_xor_b32_e64 v212, 10, v206
  v_lshl_add_u32 v131, v212, 4, v213
  v_xor_b32_e64 v212, 12, v206
  v_lshl_add_u32 v132, v212, 4, v213
  v_xor_b32_e64 v212, 14, v206
  v_lshl_add_u32 v133, v212, 4, v213
  v_lshl_add_u32 v213, v208, 2, v209
  v_lshlrev_b32 v213, 8, v213
  v_and_b32 v212, 1, v210
  v_lshl_add_u32 v213, v212, 3, v213
  v_add_u32 v213, 65536, v213
  v_xor_b32_e64 v212, 0, v206
  v_lshl_add_u32 v218, v212, 4, v213
  v_xor_b32_e64 v212, 2, v206
  v_lshl_add_u32 v219, v212, 4, v213
  v_xor_b32_e64 v212, 4, v206
  v_lshl_add_u32 v220, v212, 4, v213
  v_xor_b32_e64 v212, 6, v206
  v_lshl_add_u32 v221, v212, 4, v213
  v_xor_b32_e64 v212, 8, v206
  v_lshl_add_u32 v222, v212, 4, v213
  v_xor_b32_e64 v212, 10, v206
  v_lshl_add_u32 v223, v212, 4, v213
  v_xor_b32_e64 v212, 12, v206
  v_lshl_add_u32 v224, v212, 4, v213
  v_xor_b32_e64 v212, 14, v206
  v_lshl_add_u32 v225, v212, 4, v213
  v_lshrrev_b32 v212, 5, v226
  v_add_u32 v212, v212, v211
  v_add_u32 v206, 0, v212
  v_xor_b32 v206, v206, v207
  v_lshlrev_b32_e64 v206, 4, v206
  v_lshl_add_u32 v214, v207, 8, v206
  v_add_u32 v206, 4, v212
  v_xor_b32 v206, v206, v207
  v_lshlrev_b32_e64 v206, 4, v206
  v_lshl_add_u32 v215, v207, 8, v206
  v_add_u32 v206, 8, v212
  v_xor_b32 v206, v206, v207
  v_lshlrev_b32_e64 v206, 4, v206
  v_lshl_add_u32 v216, v207, 8, v206
  v_add_u32 v206, 12, v212
  v_xor_b32 v206, v206, v207
  v_lshlrev_b32_e64 v206, 4, v206
  v_lshl_add_u32 v217, v207, 8, v206
  v_cmp_eq_u32 vcc, 0, v210
  v_mov_b32 v206, 0x3f803f80
  s_nop 0
  v_cndmask_b32 v206, 0, v206, vcc
  v_accvgpr_write_b32 a160, v206
  v_accvgpr_write_b32 a161, v206
  v_accvgpr_write_b32 a162, v206
  v_accvgpr_write_b32 a163, v206
  s_mov_b32 s54, 0x3e0293ee
  s_mov_b32 s55, 0x3e0293ee
  s_lshr_b32 s49, s42, 2
  s_lshl_b32 s46, s40, 3
  s_add_u32 s46, s46, s49
  s_sub_u32 s47, 7, s40
  s_lshl_b32 s47, s47, 3
  s_add_u32 s47, s47, s49
  v_lshlrev_b32 v213, 4, v226
  v_and_b32_e64 v206, 15, v226
  v_mul_u32_u24 v206, 1280, v206
  v_bfe_u32 v212, v226, 4, 1
  v_lshl_add_u32 v206, v212, 5, v206
  v_lshrrev_b32_e64 v212, 5, v226
  v_lshl_add_u32 v212, v212, 4, v206
  s_cmp_ge_u32 s46, 45
  s_cselect_b32 s46, s46, s46
  s_cselect_b32 s48, 0x1000000, 0
  s_lshl_b32 s43, s46, 10
  s_add_u32 s43, s43, s48
  v_add_u32 v231, s43, v213
  s_mul_i32 s43, s46, 52
  s_lshr_b32 s43, s43, 8
  s_mul_i32 s44, s43, 5
  s_sub_u32 s44, s46, s44
  s_lshl_b32 s44, s44, 6
  s_mul_i32 s45, s43, 20480
  s_add_u32 s44, s44, s45
  s_add_u32 s44, s44, s48
  v_add_u32_e64 v233, s44, v212
  s_mul_i32 s43, s43, 86
  s_lshr_b32 s43, s43, 8
  s_lshl_b32 s43, s43, 7
  v_mov_b32 v235, s43
  s_cmp_ge_u32 s47, 45
  s_cselect_b32 s47, s46, s47
  s_cselect_b32 s48, 0x1000000, 0
  s_lshl_b32 s43, s47, 10
  s_add_u32 s43, s43, s48
  v_add_u32 v232, s43, v213
  s_mul_i32 s43, s47, 52
  s_lshr_b32 s43, s43, 8
  s_mul_i32 s44, s43, 5
  s_sub_u32 s44, s47, s44
  s_lshl_b32 s44, s44, 6
  s_mul_i32 s45, s43, 20480
  s_add_u32 s44, s44, s45
  s_add_u32 s44, s44, s48
  v_add_u32 v234, s44, v212
  s_mul_i32 s43, s43, 86
  s_lshr_b32 s43, s43, 8
  s_lshl_b32 s43, s43, 7
  v_mov_b32 v236, s43
  v_and_b32 v206, 8, v226
  v_cmp_eq_u32 vcc, 0, v206
  s_nop 1
  v_cndmask_b32 v235, v236, v235, vcc
  s_lshl_b32 s43, s3, 10
  s_add_u32 s43, s43, 512
  v_and_b32_e64 v206, 7, v226
  v_lshl_add_u32 v235, v206, 12, v235
  v_add_u32_e64 v235, s43, v235
  s_mov_b64 exec, 0xffff
  buffer_load_dword v236, v235, s[16:19], 0 offen sc1
  s_mov_b64 exec, -1
  s_mul_i32 s43, s40, 12288
  s_mul_i32 s44, s40, 15360
  v_lshlrev_b32 v213, 4, v226
  v_add_u32_e64 v237, s43, v213
  v_add_u32 v238, 4096, v237
  v_add_u32 v239, 8192, v237
  v_add_u32 v240, s44, v213
  v_lshrrev_b32 v206, 2, v226
  v_mul_u32_u24 v206, 320, v206
  v_and_b32_e64 v212, 3, v226
  v_lshl_add_u32 v206, v212, 3, v206
  v_bfe_u32 v212, v226, 4, 1
  v_lshl_add_u32 v241, v212, 5, v206
  v_xor_b32_e64 v212, 1, v212
  v_lshl_add_u32 v242, v212, 5, v206
  v_mov_b32 v243, v241
  v_mov_b32 v244, v242
  s_add_u32 s22, s3, 1
  s_and_b32 s22, s22, 3
  s_mul_i32 s22, s22, 36864
  s_add_u32 s23, s3, 2
  s_and_b32 s23, s23, 3
  s_mul_i32 s23, s23, 36864
  s_add_u32 s24, s3, 3
  s_and_b32 s24, s24, 3
  s_mul_i32 s24, s24, 36864
  s_mul_i32 s34, s3, 36864
  s_lshr_b32 s28, s42, 2
  s_mul_i32 s28, s28, 46080
  s_mov_b32 s21, 0
  s_mov_b32 s20, 0
  s_mov_b32 s35, 0
  s_mov_b32 s29, 0
  s_mov_b32 s51, 0
  s_mov_b32 s92, 0
  s_mov_b32 s30, 0xfffef000
  s_mov_b32 s31, 0
  v_mov_b64 v[4:5], 0
  v_mov_b64 v[6:7], 0
  v_mov_b64 v[8:9], 0
  v_mov_b64 v[10:11], 0
  v_mov_b64 v[12:13], 0
  v_mov_b64 v[14:15], 0
  v_mov_b64 v[16:17], 0
  v_mov_b64 v[18:19], 0
  v_mov_b64 v[20:21], 0
  v_mov_b64 v[22:23], 0
  v_mov_b64 v[24:25], 0
  v_mov_b64 v[26:27], 0
  v_mov_b64 v[28:29], 0
  v_mov_b64 v[30:31], 0
  v_mov_b64 v[32:33], 0
  v_mov_b64 v[34:35], 0
  v_mov_b64 v[36:37], 0
  v_mov_b64 v[38:39], 0
  v_mov_b64 v[40:41], 0
  v_mov_b64 v[42:43], 0
  v_mov_b64 v[44:45], 0
  v_mov_b64 v[46:47], 0
  v_mov_b64 v[48:49], 0
  v_mov_b64 v[50:51], 0
  v_mov_b64 v[52:53], 0
  v_mov_b64 v[54:55], 0
  v_mov_b64 v[56:57], 0
  v_mov_b64 v[58:59], 0
  v_mov_b64 v[60:61], 0
  v_mov_b64 v[62:63], 0
  v_mov_b64 v[64:65], 0
  v_mov_b64 v[66:67], 0
  v_mov_b64 v[68:69], 0
  v_mov_b64 v[70:71], 0
  v_mov_b64 v[72:73], 0
  v_mov_b64 v[74:75], 0
  v_mov_b64 v[76:77], 0
  v_mov_b64 v[78:79], 0
  v_mov_b64 v[80:81], 0
  v_mov_b64 v[82:83], 0
  v_mov_b64 v[84:85], 0
  v_mov_b64 v[86:87], 0
  v_mov_b64 v[88:89], 0
  v_mov_b64 v[90:91], 0
  v_mov_b64 v[92:93], 0
  v_mov_b64 v[94:95], 0
  v_mov_b64 v[96:97], 0
  v_mov_b64 v[98:99], 0
  s_barrier
  ds_read_b128 a[64:67], v124 offset:0
  ds_read_b128 a[76:79], v125 offset:0
  ds_read_b128 a[68:71], v124 offset:2048
  ds_read_b128 a[80:83], v125 offset:2048
  ds_read_b128 a[72:75], v124 offset:4096
  ds_read_b128 a[84:87], v125 offset:4096
  ds_read_b64_tr_b16 a[0:1], v126 offset:0
  ds_read_b64_tr_b16 a[2:3], v126 offset:1024
  ds_read_b64_tr_b16 a[4:5], v126 offset:8192
  ds_read_b64_tr_b16 a[6:7], v126 offset:9216
  ds_read_b64_tr_b16 a[8:9], v127 offset:0
  ds_read_b64_tr_b16 a[10:11], v127 offset:1024
  ds_read_b64_tr_b16 a[12:13], v127 offset:8192
  ds_read_b64_tr_b16 a[14:15], v127 offset:9216
  ds_read_b64_tr_b16 a[16:17], v128 offset:0
  ds_read_b64_tr_b16 a[18:19], v128 offset:1024
  ds_read_b64_tr_b16 a[20:21], v128 offset:8192
  ds_read_b64_tr_b16 a[22:23], v128 offset:9216
  ds_read_b64_tr_b16 a[24:25], v129 offset:0
  ds_read_b64_tr_b16 a[26:27], v129 offset:1024
  ds_read_b64_tr_b16 a[28:29], v129 offset:8192
  ds_read_b64_tr_b16 a[30:31], v129 offset:9216
  ds_read_b64_tr_b16 a[32:33], v130 offset:0
  ds_read_b64_tr_b16 a[34:35], v130 offset:1024
.p2align 6
L_qloop_standalone__gqa_block_cached__near_ridge_kernel:
  s_waitcnt lgkmcnt(10)
  v_mfma_f32_16x16x32_bf16 v[4:7], a[0:3], a[64:67], v[4:7]
  ds_read_b64_tr_b16 a[36:37], v130 offset:8192
  ds_read_b64_tr_b16 a[38:39], v130 offset:9216
  v_mfma_f32_16x16x32_bf16 v[4:7], a[4:7], a[76:79], v[4:7]
  v_mfma_f32_16x16x32_bf16 v[8:11], a[0:3], a[68:71], v[8:11]
  v_mfma_f32_16x16x32_bf16 v[8:11], a[4:7], a[80:83], v[8:11]
  ds_read_b64_tr_b16 a[40:41], v131 offset:0
  ds_read_b64_tr_b16 a[42:43], v131 offset:1024
  v_mfma_f32_16x16x32_bf16 v[12:15], a[0:3], a[72:75], v[12:15]
  v_mfma_f32_16x16x32_bf16 v[12:15], a[4:7], a[84:87], v[12:15]
  v_mfma_f32_16x16x32_bf16 v[16:19], a[8:11], a[64:67], v[16:19]
  ds_read_b64_tr_b16 a[44:45], v131 offset:8192
  ds_read_b64_tr_b16 a[46:47], v131 offset:9216
  v_mfma_f32_16x16x32_bf16 v[16:19], a[12:15], a[76:79], v[16:19]
  v_mfma_f32_16x16x32_bf16 v[20:23], a[8:11], a[68:71], v[20:23]
  v_mfma_f32_16x16x32_bf16 v[20:23], a[12:15], a[80:83], v[20:23]
  ds_read_b64_tr_b16 a[48:49], v132 offset:0
  ds_read_b64_tr_b16 a[50:51], v132 offset:1024
  v_mfma_f32_16x16x32_bf16 v[24:27], a[8:11], a[72:75], v[24:27]
  v_mfma_f32_16x16x32_bf16 v[24:27], a[12:15], a[84:87], v[24:27]
  s_waitcnt lgkmcnt(10)
  v_mfma_f32_16x16x32_bf16 v[28:31], a[16:19], a[64:67], v[28:31]
  ds_read_b64_tr_b16 a[52:53], v132 offset:8192
  ds_read_b64_tr_b16 a[54:55], v132 offset:9216
  v_mfma_f32_16x16x32_bf16 v[28:31], a[20:23], a[76:79], v[28:31]
  v_mfma_f32_16x16x32_bf16 v[32:35], a[16:19], a[68:71], v[32:35]
  v_mfma_f32_16x16x32_bf16 v[32:35], a[20:23], a[80:83], v[32:35]
  ds_read_b64_tr_b16 a[56:57], v133 offset:0
  ds_read_b64_tr_b16 a[58:59], v133 offset:1024
  v_mfma_f32_16x16x32_bf16 v[36:39], a[16:19], a[72:75], v[36:39]
  v_mfma_f32_16x16x32_bf16 v[36:39], a[20:23], a[84:87], v[36:39]
  v_mfma_f32_16x16x32_bf16 v[40:43], a[24:27], a[64:67], v[40:43]
  ds_read_b64_tr_b16 a[60:61], v133 offset:8192
  ds_read_b64_tr_b16 a[62:63], v133 offset:9216
  v_mfma_f32_16x16x32_bf16 v[40:43], a[28:31], a[76:79], v[40:43]
  v_mfma_f32_16x16x32_bf16 v[44:47], a[24:27], a[68:71], v[44:47]
  v_mfma_f32_16x16x32_bf16 v[44:47], a[28:31], a[80:83], v[44:47]
  v_mfma_f32_16x16x32_bf16 v[48:51], a[24:27], a[72:75], v[48:51]
  v_mfma_f32_16x16x32_bf16 v[48:51], a[28:31], a[84:87], v[48:51]
  s_waitcnt lgkmcnt(8)
  v_mfma_f32_16x16x32_bf16 v[52:55], a[32:35], a[64:67], v[52:55]
  v_mfma_f32_16x16x32_bf16 v[52:55], a[36:39], a[76:79], v[52:55]
  v_mfma_f32_16x16x32_bf16 v[56:59], a[32:35], a[68:71], v[56:59]
  v_mfma_f32_16x16x32_bf16 v[56:59], a[36:39], a[80:83], v[56:59]
  v_mfma_f32_16x16x32_bf16 v[60:63], a[32:35], a[72:75], v[60:63]
  v_mfma_f32_16x16x32_bf16 v[60:63], a[36:39], a[84:87], v[60:63]
  v_mfma_f32_16x16x32_bf16 v[64:67], a[40:43], a[64:67], v[64:67]
  v_mfma_f32_16x16x32_bf16 v[64:67], a[44:47], a[76:79], v[64:67]
  v_mfma_f32_16x16x32_bf16 v[68:71], a[40:43], a[68:71], v[68:71]
  v_mfma_f32_16x16x32_bf16 v[68:71], a[44:47], a[80:83], v[68:71]
  v_mfma_f32_16x16x32_bf16 v[72:75], a[40:43], a[72:75], v[72:75]
  s_waitcnt lgkmcnt(0)
  s_barrier
  ds_read_b128 a[88:91], v124 offset:34816
  ds_read_b128 a[100:103], v125 offset:34816
  ds_read_b128 a[92:95], v124 offset:36864
  ds_read_b128 a[104:107], v125 offset:36864
  ds_read_b128 a[96:99], v124 offset:38912
  ds_read_b128 a[108:111], v125 offset:38912
  ds_read_b64_tr_b16 a[0:1], v126 offset:34816
  ds_read_b64_tr_b16 a[2:3], v126 offset:35840
  ds_read_b64_tr_b16 a[4:5], v126 offset:43008
  ds_read_b64_tr_b16 a[6:7], v126 offset:44032
  v_mfma_f32_16x16x32_bf16 v[72:75], a[44:47], a[84:87], v[72:75]
  ds_read_b64_tr_b16 a[8:9], v127 offset:34816
  v_mfma_f32_16x16x32_bf16 v[76:79], a[48:51], a[64:67], v[76:79]
  ds_read_b64_tr_b16 a[10:11], v127 offset:35840
  ds_read_b64_tr_b16 a[12:13], v127 offset:43008
  v_mfma_f32_16x16x32_bf16 v[76:79], a[52:55], a[76:79], v[76:79]
  ds_read_b64_tr_b16 a[14:15], v127 offset:44032
  ds_read_b64_tr_b16 a[16:17], v128 offset:34816
  v_mfma_f32_16x16x32_bf16 v[80:83], a[48:51], a[68:71], v[80:83]
  ds_read_b64_tr_b16 a[18:19], v128 offset:35840
  ds_read_b64_tr_b16 a[20:21], v128 offset:43008
  v_mfma_f32_16x16x32_bf16 v[80:83], a[52:55], a[80:83], v[80:83]
  ds_read_b64_tr_b16 a[22:23], v128 offset:44032
  ds_read_b64_tr_b16 a[24:25], v129 offset:34816
  v_mfma_f32_16x16x32_bf16 v[84:87], a[48:51], a[72:75], v[84:87]
  ds_read_b64_tr_b16 a[26:27], v129 offset:35840
  v_mfma_f32_16x16x32_bf16 v[84:87], a[52:55], a[84:87], v[84:87]
  v_mfma_f32_16x16x32_bf16 v[88:91], a[56:59], a[64:67], v[88:91]
  ds_read_b64_tr_b16 a[28:29], v129 offset:43008
  ds_read_b64_tr_b16 a[30:31], v129 offset:44032
  v_mfma_f32_16x16x32_bf16 v[88:91], a[60:63], a[76:79], v[88:91]
  v_mfma_f32_16x16x32_bf16 v[92:95], a[56:59], a[68:71], v[92:95]
  v_mfma_f32_16x16x32_bf16 v[92:95], a[60:63], a[80:83], v[92:95]
  ds_read_b64_tr_b16 a[32:33], v130 offset:34816
  ds_read_b64_tr_b16 a[34:35], v130 offset:35840
  v_mfma_f32_16x16x32_bf16 v[96:99], a[56:59], a[72:75], v[96:99]
  v_mfma_f32_16x16x32_bf16 v[96:99], a[60:63], a[84:87], v[96:99]
  s_waitcnt lgkmcnt(10)
  v_mfma_f32_16x16x32_bf16 v[4:7], a[0:3], a[88:91], v[4:7]
  ds_read_b64_tr_b16 a[36:37], v130 offset:43008
  ds_read_b64_tr_b16 a[38:39], v130 offset:44032
  v_mfma_f32_16x16x32_bf16 v[4:7], a[4:7], a[100:103], v[4:7]
  v_mfma_f32_16x16x32_bf16 v[8:11], a[0:3], a[92:95], v[8:11]
  v_mfma_f32_16x16x32_bf16 v[8:11], a[4:7], a[104:107], v[8:11]
  ds_read_b64_tr_b16 a[40:41], v131 offset:34816
  ds_read_b64_tr_b16 a[42:43], v131 offset:35840
  v_mfma_f32_16x16x32_bf16 v[12:15], a[0:3], a[96:99], v[12:15]
  v_mfma_f32_16x16x32_bf16 v[12:15], a[4:7], a[108:111], v[12:15]
  v_mfma_f32_16x16x32_bf16 v[16:19], a[8:11], a[88:91], v[16:19]
  ds_read_b64_tr_b16 a[44:45], v131 offset:43008
  ds_read_b64_tr_b16 a[46:47], v131 offset:44032
  v_mfma_f32_16x16x32_bf16 v[16:19], a[12:15], a[100:103], v[16:19]
  v_mfma_f32_16x16x32_bf16 v[20:23], a[8:11], a[92:95], v[20:23]
  v_mfma_f32_16x16x32_bf16 v[20:23], a[12:15], a[104:107], v[20:23]
  ds_read_b64_tr_b16 a[48:49], v132 offset:34816
  ds_read_b64_tr_b16 a[50:51], v132 offset:35840
  v_mfma_f32_16x16x32_bf16 v[24:27], a[8:11], a[96:99], v[24:27]
  v_mfma_f32_16x16x32_bf16 v[24:27], a[12:15], a[108:111], v[24:27]
  s_waitcnt lgkmcnt(10)
  v_mfma_f32_16x16x32_bf16 v[28:31], a[16:19], a[88:91], v[28:31]
  ds_read_b64_tr_b16 a[52:53], v132 offset:43008
  ds_read_b64_tr_b16 a[54:55], v132 offset:44032
  v_mfma_f32_16x16x32_bf16 v[28:31], a[20:23], a[100:103], v[28:31]
  v_mfma_f32_16x16x32_bf16 v[32:35], a[16:19], a[92:95], v[32:35]
  v_mfma_f32_16x16x32_bf16 v[32:35], a[20:23], a[104:107], v[32:35]
  ds_read_b64_tr_b16 a[56:57], v133 offset:34816
  ds_read_b64_tr_b16 a[58:59], v133 offset:35840
  v_mfma_f32_16x16x32_bf16 v[36:39], a[16:19], a[96:99], v[36:39]
  v_mfma_f32_16x16x32_bf16 v[36:39], a[20:23], a[108:111], v[36:39]
  v_mfma_f32_16x16x32_bf16 v[40:43], a[24:27], a[88:91], v[40:43]
  ds_read_b64_tr_b16 a[60:61], v133 offset:43008
  ds_read_b64_tr_b16 a[62:63], v133 offset:44032
  v_mfma_f32_16x16x32_bf16 v[40:43], a[28:31], a[100:103], v[40:43]
  v_add_u32 v124, s30, v124
  v_add_u32_e64 v125, s30, v125
  v_mfma_f32_16x16x32_bf16 v[44:47], a[24:27], a[92:95], v[44:47]
  v_add_u32 v126, s30, v126
  v_add_u32 v127, s30, v127
  v_mfma_f32_16x16x32_bf16 v[44:47], a[28:31], a[104:107], v[44:47]
  v_add_u32 v128, s30, v128
  v_add_u32 v129, s30, v129
  v_mfma_f32_16x16x32_bf16 v[48:51], a[24:27], a[96:99], v[48:51]
  v_add_u32 v130, s30, v130
  v_add_u32 v131, s30, v131
  v_mfma_f32_16x16x32_bf16 v[48:51], a[28:31], a[108:111], v[48:51]
  v_add_u32 v132, s30, v132
  s_waitcnt lgkmcnt(8)
  v_mfma_f32_16x16x32_bf16 v[52:55], a[32:35], a[88:91], v[52:55]
  v_add_u32 v133, s30, v133
  s_sub_u32 s30, 0, s30
  v_mfma_f32_16x16x32_bf16 v[52:55], a[36:39], a[100:103], v[52:55]
  v_mfma_f32_16x16x32_bf16 v[56:59], a[32:35], a[92:95], v[56:59]
  v_mfma_f32_16x16x32_bf16 v[56:59], a[36:39], a[104:107], v[56:59]
  v_mfma_f32_16x16x32_bf16 v[60:63], a[32:35], a[96:99], v[60:63]
  v_mfma_f32_16x16x32_bf16 v[60:63], a[36:39], a[108:111], v[60:63]
  v_mfma_f32_16x16x32_bf16 v[64:67], a[40:43], a[88:91], v[64:67]
  v_mfma_f32_16x16x32_bf16 v[64:67], a[44:47], a[100:103], v[64:67]
  v_mfma_f32_16x16x32_bf16 v[68:71], a[40:43], a[92:95], v[68:71]
  v_mfma_f32_16x16x32_bf16 v[68:71], a[44:47], a[104:107], v[68:71]
  v_mfma_f32_16x16x32_bf16 v[72:75], a[40:43], a[96:99], v[72:75]
  s_waitcnt lgkmcnt(0)
  s_barrier
  ds_read_b128 a[64:67], v124 offset:0
  ds_read_b128 a[76:79], v125 offset:0
  ds_read_b128 a[68:71], v124 offset:2048
  ds_read_b128 a[80:83], v125 offset:2048
  ds_read_b128 a[72:75], v124 offset:4096
  ds_read_b128 a[84:87], v125 offset:4096
  ds_read_b64_tr_b16 a[0:1], v126 offset:0
  ds_read_b64_tr_b16 a[2:3], v126 offset:1024
  ds_read_b64_tr_b16 a[4:5], v126 offset:8192
  ds_read_b64_tr_b16 a[6:7], v126 offset:9216
  v_mfma_f32_16x16x32_bf16 v[72:75], a[44:47], a[108:111], v[72:75]
  ds_read_b64_tr_b16 a[8:9], v127 offset:0
  v_mfma_f32_16x16x32_bf16 v[76:79], a[48:51], a[88:91], v[76:79]
  ds_read_b64_tr_b16 a[10:11], v127 offset:1024
  ds_read_b64_tr_b16 a[12:13], v127 offset:8192
  v_mfma_f32_16x16x32_bf16 v[76:79], a[52:55], a[100:103], v[76:79]
  ds_read_b64_tr_b16 a[14:15], v127 offset:9216
  ds_read_b64_tr_b16 a[16:17], v128 offset:0
  v_mfma_f32_16x16x32_bf16 v[80:83], a[48:51], a[92:95], v[80:83]
  ds_read_b64_tr_b16 a[18:19], v128 offset:1024
  ds_read_b64_tr_b16 a[20:21], v128 offset:8192
  v_mfma_f32_16x16x32_bf16 v[80:83], a[52:55], a[104:107], v[80:83]
  ds_read_b64_tr_b16 a[22:23], v128 offset:9216
  ds_read_b64_tr_b16 a[24:25], v129 offset:0
  v_mfma_f32_16x16x32_bf16 v[84:87], a[48:51], a[96:99], v[84:87]
  ds_read_b64_tr_b16 a[26:27], v129 offset:1024
  v_mfma_f32_16x16x32_bf16 v[84:87], a[52:55], a[108:111], v[84:87]
  v_mfma_f32_16x16x32_bf16 v[88:91], a[56:59], a[88:91], v[88:91]
  ds_read_b64_tr_b16 a[28:29], v129 offset:8192
  ds_read_b64_tr_b16 a[30:31], v129 offset:9216
  v_mfma_f32_16x16x32_bf16 v[88:91], a[60:63], a[100:103], v[88:91]
  v_mfma_f32_16x16x32_bf16 v[92:95], a[56:59], a[92:95], v[92:95]
  v_mfma_f32_16x16x32_bf16 v[92:95], a[60:63], a[104:107], v[92:95]
  ds_read_b64_tr_b16 a[32:33], v130 offset:0
  ds_read_b64_tr_b16 a[34:35], v130 offset:1024
  v_mfma_f32_16x16x32_bf16 v[96:99], a[56:59], a[96:99], v[96:99]
  s_add_u32 s31, s31, 1
  v_mfma_f32_16x16x32_bf16 v[96:99], a[60:63], a[108:111], v[96:99]
  s_cmp_lt_u32 s31, 4
  s_cbranch_scc1 L_qloop_standalone__gqa_block_cached__near_ridge_kernel
  s_waitcnt lgkmcnt(10)
  v_mfma_f32_16x16x32_bf16 v[4:7], a[0:3], a[64:67], v[4:7]
  ds_read_b64_tr_b16 a[36:37], v130 offset:8192
  ds_read_b64_tr_b16 a[38:39], v130 offset:9216
  v_mfma_f32_16x16x32_bf16 v[4:7], a[4:7], a[76:79], v[4:7]
  v_mfma_f32_16x16x32_bf16 v[8:11], a[0:3], a[68:71], v[8:11]
  v_mfma_f32_16x16x32_bf16 v[8:11], a[4:7], a[80:83], v[8:11]
  ds_read_b64_tr_b16 a[40:41], v131 offset:0
  ds_read_b64_tr_b16 a[42:43], v131 offset:1024
  v_mfma_f32_16x16x32_bf16 v[12:15], a[0:3], a[72:75], v[12:15]
  v_mfma_f32_16x16x32_bf16 v[12:15], a[4:7], a[84:87], v[12:15]
  v_mfma_f32_16x16x32_bf16 v[16:19], a[8:11], a[64:67], v[16:19]
  ds_read_b64_tr_b16 a[44:45], v131 offset:8192
  ds_read_b64_tr_b16 a[46:47], v131 offset:9216
  v_mfma_f32_16x16x32_bf16 v[16:19], a[12:15], a[76:79], v[16:19]
  v_mfma_f32_16x16x32_bf16 v[20:23], a[8:11], a[68:71], v[20:23]
  v_mfma_f32_16x16x32_bf16 v[20:23], a[12:15], a[80:83], v[20:23]
  ds_read_b64_tr_b16 a[48:49], v132 offset:0
  ds_read_b64_tr_b16 a[50:51], v132 offset:1024
  v_mfma_f32_16x16x32_bf16 v[24:27], a[8:11], a[72:75], v[24:27]
  v_mfma_f32_16x16x32_bf16 v[24:27], a[12:15], a[84:87], v[24:27]
  s_waitcnt lgkmcnt(10)
  v_mfma_f32_16x16x32_bf16 v[28:31], a[16:19], a[64:67], v[28:31]
  ds_read_b64_tr_b16 a[52:53], v132 offset:8192
  ds_read_b64_tr_b16 a[54:55], v132 offset:9216
  v_mfma_f32_16x16x32_bf16 v[28:31], a[20:23], a[76:79], v[28:31]
  v_mfma_f32_16x16x32_bf16 v[32:35], a[16:19], a[68:71], v[32:35]
  v_mfma_f32_16x16x32_bf16 v[32:35], a[20:23], a[80:83], v[32:35]
  ds_read_b64_tr_b16 a[56:57], v133 offset:0
  ds_read_b64_tr_b16 a[58:59], v133 offset:1024
  v_mfma_f32_16x16x32_bf16 v[36:39], a[16:19], a[72:75], v[36:39]
  v_mfma_f32_16x16x32_bf16 v[36:39], a[20:23], a[84:87], v[36:39]
  v_mfma_f32_16x16x32_bf16 v[40:43], a[24:27], a[64:67], v[40:43]
  ds_read_b64_tr_b16 a[60:61], v133 offset:8192
  ds_read_b64_tr_b16 a[62:63], v133 offset:9216
  v_mfma_f32_16x16x32_bf16 v[40:43], a[28:31], a[76:79], v[40:43]
  v_mfma_f32_16x16x32_bf16 v[44:47], a[24:27], a[68:71], v[44:47]
  v_mfma_f32_16x16x32_bf16 v[44:47], a[28:31], a[80:83], v[44:47]
  v_mfma_f32_16x16x32_bf16 v[48:51], a[24:27], a[72:75], v[48:51]
  v_mfma_f32_16x16x32_bf16 v[48:51], a[28:31], a[84:87], v[48:51]
  s_waitcnt lgkmcnt(8)
  v_mfma_f32_16x16x32_bf16 v[52:55], a[32:35], a[64:67], v[52:55]
  v_mfma_f32_16x16x32_bf16 v[52:55], a[36:39], a[76:79], v[52:55]
  v_mfma_f32_16x16x32_bf16 v[56:59], a[32:35], a[68:71], v[56:59]
  v_mfma_f32_16x16x32_bf16 v[56:59], a[36:39], a[80:83], v[56:59]
  v_mfma_f32_16x16x32_bf16 v[60:63], a[32:35], a[72:75], v[60:63]
  v_mfma_f32_16x16x32_bf16 v[60:63], a[36:39], a[84:87], v[60:63]
  v_mfma_f32_16x16x32_bf16 v[64:67], a[40:43], a[64:67], v[64:67]
  v_mfma_f32_16x16x32_bf16 v[64:67], a[44:47], a[76:79], v[64:67]
  v_mfma_f32_16x16x32_bf16 v[68:71], a[40:43], a[68:71], v[68:71]
  v_mfma_f32_16x16x32_bf16 v[68:71], a[44:47], a[80:83], v[68:71]
  v_mfma_f32_16x16x32_bf16 v[72:75], a[40:43], a[72:75], v[72:75]
  s_waitcnt lgkmcnt(0)
  s_barrier
  ds_read_b128 a[88:91], v124 offset:34816
  ds_read_b128 a[100:103], v125 offset:34816
  ds_read_b128 a[92:95], v124 offset:36864
  ds_read_b128 a[104:107], v125 offset:36864
  ds_read_b128 a[96:99], v124 offset:38912
  ds_read_b128 a[108:111], v125 offset:38912
  ds_read_b64_tr_b16 a[0:1], v126 offset:34816
  ds_read_b64_tr_b16 a[2:3], v126 offset:35840
  ds_read_b64_tr_b16 a[4:5], v126 offset:43008
  ds_read_b64_tr_b16 a[6:7], v126 offset:44032
  v_mfma_f32_16x16x32_bf16 v[72:75], a[44:47], a[84:87], v[72:75]
  ds_read_b64_tr_b16 a[8:9], v127 offset:34816
  v_mfma_f32_16x16x32_bf16 v[76:79], a[48:51], a[64:67], v[76:79]
  ds_read_b64_tr_b16 a[10:11], v127 offset:35840
  ds_read_b64_tr_b16 a[12:13], v127 offset:43008
  v_mfma_f32_16x16x32_bf16 v[76:79], a[52:55], a[76:79], v[76:79]
  ds_read_b64_tr_b16 a[14:15], v127 offset:44032
  ds_read_b64_tr_b16 a[16:17], v128 offset:34816
  v_mfma_f32_16x16x32_bf16 v[80:83], a[48:51], a[68:71], v[80:83]
  ds_read_b64_tr_b16 a[18:19], v128 offset:35840
  ds_read_b64_tr_b16 a[20:21], v128 offset:43008
  v_mfma_f32_16x16x32_bf16 v[80:83], a[52:55], a[80:83], v[80:83]
  ds_read_b64_tr_b16 a[22:23], v128 offset:44032
  ds_read_b64_tr_b16 a[24:25], v129 offset:34816
  v_mfma_f32_16x16x32_bf16 v[84:87], a[48:51], a[72:75], v[84:87]
  ds_read_b64_tr_b16 a[26:27], v129 offset:35840
  v_mfma_f32_16x16x32_bf16 v[84:87], a[52:55], a[84:87], v[84:87]
  v_mfma_f32_16x16x32_bf16 v[88:91], a[56:59], a[64:67], v[88:91]
  ds_read_b64_tr_b16 a[28:29], v129 offset:43008
  ds_read_b64_tr_b16 a[30:31], v129 offset:44032
  v_mfma_f32_16x16x32_bf16 v[88:91], a[60:63], a[76:79], v[88:91]
  v_mfma_f32_16x16x32_bf16 v[92:95], a[56:59], a[68:71], v[92:95]
  v_mfma_f32_16x16x32_bf16 v[92:95], a[60:63], a[80:83], v[92:95]
  ds_read_b64_tr_b16 a[32:33], v130 offset:34816
  ds_read_b64_tr_b16 a[34:35], v130 offset:35840
  v_mfma_f32_16x16x32_bf16 v[96:99], a[56:59], a[72:75], v[96:99]
  v_mfma_f32_16x16x32_bf16 v[96:99], a[60:63], a[84:87], v[96:99]
  s_waitcnt lgkmcnt(10)
  v_mfma_f32_16x16x32_bf16 v[4:7], a[0:3], a[88:91], v[4:7]
  ds_read_b64_tr_b16 a[36:37], v130 offset:43008
  ds_read_b64_tr_b16 a[38:39], v130 offset:44032
  v_mfma_f32_16x16x32_bf16 v[4:7], a[4:7], a[100:103], v[4:7]
  v_mfma_f32_16x16x32_bf16 v[8:11], a[0:3], a[92:95], v[8:11]
  v_mfma_f32_16x16x32_bf16 v[8:11], a[4:7], a[104:107], v[8:11]
  ds_read_b64_tr_b16 a[40:41], v131 offset:34816
  ds_read_b64_tr_b16 a[42:43], v131 offset:35840
  v_mfma_f32_16x16x32_bf16 v[12:15], a[0:3], a[96:99], v[12:15]
  v_mfma_f32_16x16x32_bf16 v[12:15], a[4:7], a[108:111], v[12:15]
  v_mfma_f32_16x16x32_bf16 v[16:19], a[8:11], a[88:91], v[16:19]
  ds_read_b64_tr_b16 a[44:45], v131 offset:43008
  ds_read_b64_tr_b16 a[46:47], v131 offset:44032
  v_mfma_f32_16x16x32_bf16 v[16:19], a[12:15], a[100:103], v[16:19]
  v_mfma_f32_16x16x32_bf16 v[20:23], a[8:11], a[92:95], v[20:23]
  v_mfma_f32_16x16x32_bf16 v[20:23], a[12:15], a[104:107], v[20:23]
  ds_read_b64_tr_b16 a[48:49], v132 offset:34816
  ds_read_b64_tr_b16 a[50:51], v132 offset:35840
  v_mfma_f32_16x16x32_bf16 v[24:27], a[8:11], a[96:99], v[24:27]
  v_mfma_f32_16x16x32_bf16 v[24:27], a[12:15], a[108:111], v[24:27]
  s_waitcnt lgkmcnt(10)
  v_mfma_f32_16x16x32_bf16 v[28:31], a[16:19], a[88:91], v[28:31]
  ds_read_b64_tr_b16 a[52:53], v132 offset:43008
  ds_read_b64_tr_b16 a[54:55], v132 offset:44032
  v_mfma_f32_16x16x32_bf16 v[28:31], a[20:23], a[100:103], v[28:31]
  v_mfma_f32_16x16x32_bf16 v[32:35], a[16:19], a[92:95], v[32:35]
  v_pk_mul_f32 v[4:5], v[4:5], s[54:55]
  v_pk_mul_f32 v[6:7], v[6:7], s[54:55]
  v_mfma_f32_16x16x32_bf16 v[32:35], a[20:23], a[104:107], v[32:35]
  ds_read_b64_tr_b16 a[56:57], v133 offset:34816
  ds_read_b64_tr_b16 a[58:59], v133 offset:35840
  v_mfma_f32_16x16x32_bf16 v[36:39], a[16:19], a[96:99], v[36:39]
  v_pk_mul_f32 v[16:17], v[16:17], s[54:55]
  v_pk_mul_f32 v[18:19], v[18:19], s[54:55]
  v_mfma_f32_16x16x32_bf16 v[36:39], a[20:23], a[108:111], v[36:39]
  v_cvt_pk_bf16_f32 v4, v4, v5
  v_cvt_pk_bf16_f32 v5, v6, v7
  v_mfma_f32_16x16x32_bf16 v[40:43], a[24:27], a[88:91], v[40:43]
  ds_read_b64_tr_b16 a[60:61], v133 offset:43008
  ds_read_b64_tr_b16 a[62:63], v133 offset:44032
  v_mfma_f32_16x16x32_bf16 v[40:43], a[28:31], a[100:103], v[40:43]
  v_cvt_pk_bf16_f32 v16, v16, v17
  v_cvt_pk_bf16_f32 v17, v18, v19
  v_mfma_f32_16x16x32_bf16 v[44:47], a[24:27], a[92:95], v[44:47]
  v_pk_mul_f32 v[8:9], v[8:9], s[54:55]
  v_pk_mul_f32 v[10:11], v[10:11], s[54:55]
  v_mfma_f32_16x16x32_bf16 v[44:47], a[28:31], a[104:107], v[44:47]
  v_pk_mul_f32 v[20:21], v[20:21], s[54:55]
  v_pk_mul_f32 v[22:23], v[22:23], s[54:55]
  v_mfma_f32_16x16x32_bf16 v[48:51], a[24:27], a[96:99], v[48:51]
  v_cvt_pk_bf16_f32 v8, v8, v9
  v_cvt_pk_bf16_f32 v9, v10, v11
  v_mfma_f32_16x16x32_bf16 v[48:51], a[28:31], a[108:111], v[48:51]
  v_cvt_pk_bf16_f32 v20, v20, v21
  s_waitcnt lgkmcnt(8)
  v_mfma_f32_16x16x32_bf16 v[52:55], a[32:35], a[88:91], v[52:55]
  v_cvt_pk_bf16_f32 v21, v22, v23
  v_pk_mul_f32 v[12:13], v[12:13], s[54:55]
  v_mfma_f32_16x16x32_bf16 v[52:55], a[36:39], a[100:103], v[52:55]
  v_pk_mul_f32 v[14:15], v[14:15], s[54:55]
  v_pk_mul_f32 v[24:25], v[24:25], s[54:55]
  v_mfma_f32_16x16x32_bf16 v[56:59], a[32:35], a[92:95], v[56:59]
  v_pk_mul_f32 v[26:27], v[26:27], s[54:55]
  v_cvt_pk_bf16_f32 v12, v12, v13
  v_mfma_f32_16x16x32_bf16 v[56:59], a[36:39], a[104:107], v[56:59]
  v_cvt_pk_bf16_f32 v13, v14, v15
  v_cvt_pk_bf16_f32 v24, v24, v25
  v_mfma_f32_16x16x32_bf16 v[60:63], a[32:35], a[96:99], v[60:63]
  v_cvt_pk_bf16_f32 v25, v26, v27
  v_permlane16_swap_b32 v4, v16
  v_mfma_f32_16x16x32_bf16 v[60:63], a[36:39], a[108:111], v[60:63]
  v_permlane16_swap_b32 v5, v17
  v_permlane16_swap_b32 v8, v20
  v_mfma_f32_16x16x32_bf16 v[64:67], a[40:43], a[88:91], v[64:67]
  v_permlane16_swap_b32 v9, v21
  v_permlane16_swap_b32 v12, v24
  v_mfma_f32_16x16x32_bf16 v[64:67], a[44:47], a[100:103], v[64:67]
  v_permlane16_swap_b32 v13, v25
  v_accvgpr_write_b32 a112, v4
  v_mfma_f32_16x16x32_bf16 v[68:71], a[40:43], a[92:95], v[68:71]
  v_accvgpr_write_b32 a113, v5
  v_accvgpr_write_b32 a114, v16
  v_mfma_f32_16x16x32_bf16 v[68:71], a[44:47], a[104:107], v[68:71]
  v_accvgpr_write_b32 a115, v17
  v_accvgpr_write_b32 a128, v8
  v_mfma_f32_16x16x32_bf16 v[72:75], a[40:43], a[96:99], v[72:75]
  s_waitcnt lgkmcnt(0)
  s_barrier
  ds_read_b128 a[0:3], v214 offset:0
  ds_read_b128 a[4:7], v214 offset:4096
  v_mfma_f32_16x16x32_bf16 v[72:75], a[44:47], a[108:111], v[72:75]
  ds_read_b128 a[8:11], v215 offset:0
  v_mfma_f32_16x16x32_bf16 v[76:79], a[48:51], a[88:91], v[76:79]
  ds_read_b128 a[12:15], v215 offset:4096
  ds_read_b128 a[16:19], v216 offset:0
  v_mfma_f32_16x16x32_bf16 v[76:79], a[52:55], a[100:103], v[76:79]
  ds_read_b128 a[20:23], v216 offset:4096
  v_accvgpr_write_b32 a129, v9
  v_mfma_f32_16x16x32_bf16 v[80:83], a[48:51], a[92:95], v[80:83]
  v_accvgpr_write_b32 a130, v20
  v_accvgpr_write_b32 a131, v21
  v_mfma_f32_16x16x32_bf16 v[80:83], a[52:55], a[104:107], v[80:83]
  v_accvgpr_write_b32 a144, v12
  v_accvgpr_write_b32 a145, v13
  v_mfma_f32_16x16x32_bf16 v[84:87], a[48:51], a[96:99], v[84:87]
  v_accvgpr_write_b32 a146, v24
  v_accvgpr_write_b32 a147, v25
  v_mfma_f32_16x16x32_bf16 v[84:87], a[52:55], a[108:111], v[84:87]
  ds_read_b128 a[24:27], v217 offset:0
  v_pk_mul_f32 v[28:29], v[28:29], s[54:55]
  v_mfma_f32_16x16x32_bf16 v[88:91], a[56:59], a[88:91], v[88:91]
  ds_read_b128 a[28:31], v217 offset:4096
  v_pk_mul_f32 v[30:31], v[30:31], s[54:55]
  v_mfma_f32_16x16x32_bf16 v[88:91], a[60:63], a[100:103], v[88:91]
  v_pk_mul_f32 v[40:41], v[40:41], s[54:55]
  v_pk_mul_f32 v[42:43], v[42:43], s[54:55]
  v_mfma_f32_16x16x32_bf16 v[92:95], a[56:59], a[92:95], v[92:95]
  v_cvt_pk_bf16_f32 v28, v28, v29
  v_cvt_pk_bf16_f32 v29, v30, v31
  v_mfma_f32_16x16x32_bf16 v[92:95], a[60:63], a[104:107], v[92:95]
  v_cvt_pk_bf16_f32 v40, v40, v41
  v_cvt_pk_bf16_f32 v41, v42, v43
  v_mfma_f32_16x16x32_bf16 v[96:99], a[56:59], a[96:99], v[96:99]
  v_pk_mul_f32 v[32:33], v[32:33], s[54:55]
  v_pk_mul_f32 v[34:35], v[34:35], s[54:55]
  v_mfma_f32_16x16x32_bf16 v[96:99], a[60:63], a[108:111], v[96:99]
  s_mov_b32 s31, 0
  s_waitcnt lgkmcnt(4)
  v_mfma_f32_16x16x32_bf16 v[100:103], a[0:3], a[112:115], 0
  v_pk_mul_f32 v[44:45], v[44:45], s[54:55]
  v_pk_mul_f32 v[46:47], v[46:47], s[54:55]
  v_mfma_f32_16x16x32_bf16 v[104:107], a[0:3], a[128:131], 0
  v_cvt_pk_bf16_f32 v32, v32, v33
  v_cvt_pk_bf16_f32 v33, v34, v35
  v_mfma_f32_16x16x32_bf16 v[108:111], a[0:3], a[144:147], 0
  v_cvt_pk_bf16_f32 v44, v44, v45
  v_cvt_pk_bf16_f32 v45, v46, v47
  v_mfma_f32_16x16x32_bf16 v[112:115], a[4:7], a[112:115], 0
  v_pk_mul_f32 v[36:37], v[36:37], s[54:55]
  v_pk_mul_f32 v[38:39], v[38:39], s[54:55]
  v_mfma_f32_16x16x32_bf16 v[116:119], a[4:7], a[128:131], 0
  v_pk_mul_f32 v[48:49], v[48:49], s[54:55]
  v_pk_mul_f32 v[50:51], v[50:51], s[54:55]
  v_cvt_pk_bf16_f32 v36, v36, v37
  v_cvt_pk_bf16_f32 v37, v38, v39
  v_cvt_pk_bf16_f32 v48, v48, v49
  v_cvt_pk_bf16_f32 v49, v50, v51
  v_permlane16_swap_b32 v28, v40
  v_permlane16_swap_b32 v29, v41
  v_permlane16_swap_b32 v32, v44
  v_permlane16_swap_b32 v33, v45
  v_permlane16_swap_b32 v36, v48
  v_permlane16_swap_b32 v37, v49
  v_accvgpr_write_b32 a116, v28
  v_accvgpr_write_b32 a117, v29
  v_accvgpr_write_b32 a118, v40
  v_accvgpr_write_b32 a119, v41
  v_accvgpr_write_b32 a132, v32
  v_accvgpr_write_b32 a133, v33
  v_accvgpr_write_b32 a134, v44
  v_accvgpr_write_b32 a135, v45
  v_accvgpr_write_b32 a148, v36
  v_accvgpr_write_b32 a149, v37
  v_accvgpr_write_b32 a150, v48
  v_accvgpr_write_b32 a151, v49
  v_mfma_f32_16x16x32_bf16 v[120:123], a[4:7], a[144:147], 0
  ds_read_b128 a[32:35], v214 offset:8192
  ds_read_b128 a[36:39], v215 offset:8192
  v_mfma_f32_16x16x32_bf16 v[100:103], a[8:11], a[116:119], v[100:103]
  v_pk_mul_f32 v[52:53], v[52:53], s[54:55]
  v_pk_mul_f32 v[54:55], v[54:55], s[54:55]
  v_mfma_f32_16x16x32_bf16 v[104:107], a[8:11], a[132:135], v[104:107]
  v_pk_mul_f32 v[64:65], v[64:65], s[54:55]
  v_pk_mul_f32 v[66:67], v[66:67], s[54:55]
  v_mfma_f32_16x16x32_bf16 v[108:111], a[8:11], a[148:151], v[108:111]
  v_cvt_pk_bf16_f32 v52, v52, v53
  v_cvt_pk_bf16_f32 v53, v54, v55
  v_mfma_f32_16x16x32_bf16 v[112:115], a[12:15], a[116:119], v[112:115]
  v_cvt_pk_bf16_f32 v64, v64, v65
  v_cvt_pk_bf16_f32 v65, v66, v67
  v_mfma_f32_16x16x32_bf16 v[116:119], a[12:15], a[132:135], v[116:119]
  v_pk_mul_f32 v[56:57], v[56:57], s[54:55]
  v_pk_mul_f32 v[58:59], v[58:59], s[54:55]
  v_pk_mul_f32 v[68:69], v[68:69], s[54:55]
  v_pk_mul_f32 v[70:71], v[70:71], s[54:55]
  v_cvt_pk_bf16_f32 v56, v56, v57
  v_cvt_pk_bf16_f32 v57, v58, v59
  v_cvt_pk_bf16_f32 v68, v68, v69
  v_cvt_pk_bf16_f32 v69, v70, v71
  v_pk_mul_f32 v[60:61], v[60:61], s[54:55]
  v_pk_mul_f32 v[62:63], v[62:63], s[54:55]
  v_pk_mul_f32 v[72:73], v[72:73], s[54:55]
  v_pk_mul_f32 v[74:75], v[74:75], s[54:55]
  v_cvt_pk_bf16_f32 v60, v60, v61
  v_cvt_pk_bf16_f32 v61, v62, v63
  v_cvt_pk_bf16_f32 v72, v72, v73
  v_cvt_pk_bf16_f32 v73, v74, v75
  v_permlane16_swap_b32 v52, v64
  v_permlane16_swap_b32 v53, v65
  v_permlane16_swap_b32 v56, v68
  v_permlane16_swap_b32 v57, v69
  v_permlane16_swap_b32 v60, v72
  v_permlane16_swap_b32 v61, v73
  v_accvgpr_write_b32 a120, v52
  v_accvgpr_write_b32 a121, v53
  v_accvgpr_write_b32 a122, v64
  v_accvgpr_write_b32 a123, v65
  v_accvgpr_write_b32 a136, v56
  v_accvgpr_write_b32 a137, v57
  v_accvgpr_write_b32 a138, v68
  v_accvgpr_write_b32 a139, v69
  v_accvgpr_write_b32 a152, v60
  v_accvgpr_write_b32 a153, v61
  v_accvgpr_write_b32 a154, v72
  v_accvgpr_write_b32 a155, v73
  v_mfma_f32_16x16x32_bf16 v[120:123], a[12:15], a[148:151], v[120:123]
  ds_read_b128 a[40:43], v216 offset:8192
  s_waitcnt lgkmcnt(3)
  v_mfma_f32_16x16x32_bf16 v[100:103], a[16:19], a[120:123], v[100:103]
  ds_read_b128 a[44:47], v217 offset:8192
  v_pk_mul_f32 v[76:77], v[76:77], s[54:55]
  v_mfma_f32_16x16x32_bf16 v[104:107], a[16:19], a[136:139], v[104:107]
  v_pk_mul_f32 v[78:79], v[78:79], s[54:55]
  v_pk_mul_f32 v[88:89], v[88:89], s[54:55]
  v_mfma_f32_16x16x32_bf16 v[108:111], a[16:19], a[152:155], v[108:111]
  v_pk_mul_f32 v[90:91], v[90:91], s[54:55]
  v_cvt_pk_bf16_f32 v76, v76, v77
  v_mfma_f32_16x16x32_bf16 v[112:115], a[20:23], a[120:123], v[112:115]
  v_cvt_pk_bf16_f32 v77, v78, v79
  v_cvt_pk_bf16_f32 v88, v88, v89
  v_mfma_f32_16x16x32_bf16 v[116:119], a[20:23], a[136:139], v[116:119]
  v_cvt_pk_bf16_f32 v89, v90, v91
  v_pk_mul_f32 v[80:81], v[80:81], s[54:55]
  v_pk_mul_f32 v[82:83], v[82:83], s[54:55]
  v_pk_mul_f32 v[92:93], v[92:93], s[54:55]
  v_pk_mul_f32 v[94:95], v[94:95], s[54:55]
  v_cvt_pk_bf16_f32 v80, v80, v81
  v_cvt_pk_bf16_f32 v81, v82, v83
  v_cvt_pk_bf16_f32 v92, v92, v93
  v_cvt_pk_bf16_f32 v93, v94, v95
  v_pk_mul_f32 v[84:85], v[84:85], s[54:55]
  v_pk_mul_f32 v[86:87], v[86:87], s[54:55]
  v_pk_mul_f32 v[96:97], v[96:97], s[54:55]
  v_pk_mul_f32 v[98:99], v[98:99], s[54:55]
  v_cvt_pk_bf16_f32 v84, v84, v85
  v_cvt_pk_bf16_f32 v85, v86, v87
  v_cvt_pk_bf16_f32 v96, v96, v97
  v_cvt_pk_bf16_f32 v97, v98, v99
  v_permlane16_swap_b32 v76, v88
  v_permlane16_swap_b32 v77, v89
  v_permlane16_swap_b32 v80, v92
  v_permlane16_swap_b32 v81, v93
  v_permlane16_swap_b32 v84, v96
  v_permlane16_swap_b32 v85, v97
  v_accvgpr_write_b32 a124, v76
  v_accvgpr_write_b32 a125, v77
  v_accvgpr_write_b32 a126, v88
  v_accvgpr_write_b32 a127, v89
  v_accvgpr_write_b32 a140, v80
  v_accvgpr_write_b32 a141, v81
  v_accvgpr_write_b32 a142, v92
  v_accvgpr_write_b32 a143, v93
  v_accvgpr_write_b32 a156, v84
  v_accvgpr_write_b32 a157, v85
  v_accvgpr_write_b32 a158, v96
  v_accvgpr_write_b32 a159, v97
  v_mfma_f32_16x16x32_bf16 v[120:123], a[20:23], a[152:155], v[120:123]
  ds_read_b128 a[48:51], v214 offset:12288
  ds_read_b128 a[52:55], v215 offset:12288
  v_mfma_f32_16x16x32_bf16 v[100:103], a[24:27], a[124:127], v[100:103]
  ds_read_b128 a[56:59], v216 offset:12288
  ds_read_b128 a[60:63], v217 offset:12288
  v_mfma_f32_16x16x32_bf16 v[104:107], a[24:27], a[140:143], v[104:107]
  v_mfma_f32_16x16x32_bf16 v[108:111], a[24:27], a[156:159], v[108:111]
  v_mfma_f32_16x16x32_bf16 v[112:115], a[28:31], a[124:127], v[112:115]
  v_mfma_f32_16x16x32_bf16 v[116:119], a[28:31], a[140:143], v[116:119]
  v_mfma_f32_16x16x32_bf16 v[120:123], a[28:31], a[156:159], v[120:123]
  s_nop 0
  v_max3_f32 v207, v100, v101, v102
  s_nop 3
  v_max3_f32 v207, v207, v103, v112
  v_max3_f32 v207, v207, v113, v114
  v_max_f32 v207, v207, v115
  v_mov_b32 v206, v207
  s_nop 1
  v_permlane16_swap_b32 v207, v206
  v_max_f32 v207, v207, v206
  v_mov_b32 v206, v207
  s_nop 1
  v_permlane32_swap_b32 v207, v206
  v_max_f32 v207, v207, v206
  v_ceil_f32 v207, v207
  v_add_f32 v207, 0x40e00000, v207
  v_sub_f32 v172, 0, v207
  v_sub_f32 v173, 0, v207
  v_sub_f32 v174, 0, v207
  v_sub_f32 v175, 0, v207
  v_max3_f32 v208, v104, v105, v106
  v_max3_f32 v208, v208, v107, v116
  v_max3_f32 v208, v208, v117, v118
  v_max_f32 v208, v208, v119
  v_mov_b32 v206, v208
  s_nop 1
  v_permlane16_swap_b32 v208, v206
  v_max_f32 v208, v208, v206
  v_mov_b32 v206, v208
  s_nop 1
  v_permlane32_swap_b32 v208, v206
  v_max_f32 v208, v208, v206
  v_ceil_f32 v208, v208
  v_add_f32 v208, 0x40e00000, v208
  v_sub_f32 v176, 0, v208
  v_sub_f32 v177, 0, v208
  v_sub_f32 v178, 0, v208
  v_sub_f32 v179, 0, v208
  v_max3_f32 v209, v108, v109, v110
  v_max3_f32 v209, v209, v111, v120
  v_max3_f32 v209, v209, v121, v122
  v_max_f32 v209, v209, v123
  v_mov_b32 v206, v209
  s_nop 1
  v_permlane16_swap_b32 v209, v206
  v_max_f32 v209, v209, v206
  v_mov_b32 v206, v209
  s_nop 1
  v_permlane32_swap_b32 v209, v206
  v_max_f32 v209, v209, v206
  v_ceil_f32 v209, v209
  v_add_f32 v209, 0x40e00000, v209
  v_sub_f32 v180, 0, v209
  v_sub_f32 v181, 0, v209
  v_sub_f32 v182, 0, v209
  v_sub_f32 v183, 0, v209
  v_sub_f32 v100, v100, v207
  v_sub_f32 v101, v101, v207
  v_sub_f32 v102, v102, v207
  v_sub_f32 v103, v103, v207
  v_sub_f32 v112, v112, v207
  v_sub_f32 v113, v113, v207
  v_sub_f32 v114, v114, v207
  v_sub_f32 v115, v115, v207
  v_sub_f32 v104, v104, v208
  v_sub_f32 v105, v105, v208
  v_sub_f32 v106, v106, v208
  v_sub_f32 v107, v107, v208
  v_sub_f32 v116, v116, v208
  v_sub_f32 v117, v117, v208
  v_sub_f32 v118, v118, v208
  v_sub_f32 v119, v119, v208
  v_sub_f32 v108, v108, v209
  v_sub_f32 v109, v109, v209
  v_sub_f32 v110, v110, v209
  v_sub_f32 v111, v111, v209
  v_sub_f32 v120, v120, v209
  v_sub_f32 v121, v121, v209
  v_sub_f32 v122, v122, v209
  v_sub_f32 v123, v123, v209
  s_waitcnt lgkmcnt(4)
  v_mfma_f32_16x16x32_bf16 v[124:127], a[32:35], a[112:115], v[172:175]
  v_exp_f32 v198, v100
  v_mfma_f32_16x16x32_bf16 v[124:127], a[36:39], a[116:119], v[124:127]
  v_exp_f32_e64 v199, v101
  v_mfma_f32_16x16x32_bf16 v[124:127], a[40:43], a[120:123], v[124:127]
  v_exp_f32_e64 v200, v102
  v_mfma_f32_16x16x32_bf16 v[124:127], a[44:47], a[124:127], v[124:127]
  v_exp_f32_e64 v201, v103
  v_mfma_f32_16x16x32_bf16 v[128:131], a[32:35], a[128:131], v[176:179]
  v_exp_f32_e64 v202, v112
  v_mfma_f32_16x16x32_bf16 v[128:131], a[36:39], a[132:135], v[128:131]
  v_exp_f32_e64 v203, v113
  v_mfma_f32_16x16x32_bf16 v[128:131], a[40:43], a[136:139], v[128:131]
  v_exp_f32_e64 v204, v114
  v_mfma_f32_16x16x32_bf16 v[128:131], a[44:47], a[140:143], v[128:131]
  v_exp_f32_e64 v205, v115
  v_mfma_f32_16x16x32_bf16 v[132:135], a[32:35], a[144:147], v[180:183]
  v_cvt_pk_bf16_f32 v148, v198, v199
  v_cvt_pk_bf16_f32 v149, v200, v201
  v_mfma_f32_16x16x32_bf16 v[132:135], a[36:39], a[148:151], v[132:135]
  v_exp_f32_e64 v198, v104
  v_mfma_f32_16x16x32_bf16 v[132:135], a[40:43], a[152:155], v[132:135]
  v_exp_f32_e64 v199, v105
  v_mfma_f32_16x16x32_bf16 v[132:135], a[44:47], a[156:159], v[132:135]
  v_cvt_pk_bf16_f32 v150, v202, v203
  s_waitcnt lgkmcnt(0)
  v_mfma_f32_16x16x32_bf16 v[136:139], a[48:51], a[112:115], v[172:175]
  s_barrier
  ds_read_b128 a[0:3], v214 offset:16384
  ds_read_b128 a[4:7], v215 offset:16384
  ds_read_b128 a[8:11], v216 offset:16384
  v_mfma_f32_16x16x32_bf16 v[136:139], a[52:55], a[116:119], v[136:139]
  ds_read_b128 a[12:15], v217 offset:16384
  v_cvt_pk_bf16_f32 v151, v204, v205
  v_mfma_f32_16x16x32_bf16 v[136:139], a[56:59], a[120:123], v[136:139]
  v_exp_f32_e64 v200, v106
  v_mfma_f32_16x16x32_bf16 v[136:139], a[60:63], a[124:127], v[136:139]
  v_exp_f32_e64 v201, v107
  v_mfma_f32_16x16x32_bf16 v[140:143], a[48:51], a[128:131], v[176:179]
  v_exp_f32_e64 v202, v116
  v_mfma_f32_16x16x32_bf16 v[140:143], a[52:55], a[132:135], v[140:143]
  v_exp_f32 v203, v117
  v_exp_f32 v204, v118
  v_mfma_f32_16x16x32_bf16 v[140:143], a[56:59], a[136:139], v[140:143]
  ds_read_b128 a[16:19], v214 offset:20480
  v_exp_f32_e64 v205, v119
  v_cvt_pk_bf16_f32 v152, v198, v199
  v_exp_f32_e64 v198, v108
  v_mfma_f32_16x16x32_bf16 v[140:143], a[60:63], a[140:143], v[140:143]
  v_exp_f32_e64 v199, v109
  v_cvt_pk_bf16_f32 v153, v200, v201
  v_exp_f32 v200, v110
  v_exp_f32 v201, v111
  v_mfma_f32_16x16x32_bf16 v[144:147], a[48:51], a[144:147], v[180:183]
  v_cvt_pk_bf16_f32 v154, v202, v203
  v_exp_f32 v202, v120
  v_exp_f32 v203, v121
  v_cvt_pk_bf16_f32 v155, v204, v205
  v_exp_f32 v204, v122
  v_exp_f32 v205, v123
  v_cvt_pk_bf16_f32 v156, v198, v199
  v_cvt_pk_bf16_f32 v157, v200, v201
  v_mfma_f32_16x16x32_bf16 v[144:147], a[52:55], a[148:151], v[144:147]
  v_cvt_pk_bf16_f32 v158, v202, v203
  v_cvt_pk_bf16_f32 v159, v204, v205
  ds_read_b128 a[20:23], v215 offset:20480
  v_or_b32_e64 v196, v148, v149
  v_or3_b32 v196, v196, v150, v151
  v_or3_b32 v196, v196, v152, v153
  v_or3_b32 v196, v196, v154, v155
  v_or3_b32 v196, v196, v156, v157
  v_or3_b32 v196, v196, v158, v159
  v_mfma_f32_16x16x32_bf16 v[144:147], a[56:59], a[152:155], v[144:147]
  v_and_b32 v196, 0x40004000, v196
  v_cmp_ne_u32 vcc, 0, v196
  v_mfma_f32_16x16x32_bf16 v[144:147], a[60:63], a[156:159], v[144:147]
  s_cbranch_vccnz L_ok_standalone__gqa_block_cached__near_ridge_kernel_p0s
L_ok_standalone__gqa_block_cached__near_ridge_kernel_p0:
  s_waitcnt lgkmcnt(2)
  v_mfma_f32_16x16x32_bf16 v[100:103], a[0:3], a[112:115], v[172:175]
  ds_read_b128 a[24:27], v216 offset:20480
  ds_read_b128 a[28:31], v217 offset:20480
  v_mfma_f32_16x16x32_bf16 v[100:103], a[4:7], a[116:119], v[100:103]
  ds_read_b64_tr_b16 a[32:33], v218 offset:0
  ds_read_b64_tr_b16 a[34:35], v218 offset:4096
  v_mfma_f32_16x16x32_bf16 v[100:103], a[8:11], a[120:123], v[100:103]
  ds_read_b64_tr_b16 a[36:37], v219 offset:0
  ds_read_b64_tr_b16 a[38:39], v219 offset:4096
  v_mfma_f32_16x16x32_bf16 v[100:103], a[12:15], a[124:127], v[100:103]
  v_exp_f32 v198, v124
  v_mfma_f32_16x16x32_bf16 v[104:107], a[0:3], a[128:131], v[176:179]
  v_exp_f32_e64 v199, v125
  v_mfma_f32_16x16x32_bf16 v[104:107], a[4:7], a[132:135], v[104:107]
  ds_read_b64_tr_b16 a[40:41], v220 offset:0
  ds_read_b64_tr_b16 a[42:43], v220 offset:4096
  v_mfma_f32_16x16x32_bf16 v[104:107], a[8:11], a[136:139], v[104:107]
  v_exp_f32_e64 v200, v126
  v_mfma_f32_16x16x32_bf16 v[104:107], a[12:15], a[140:143], v[104:107]
  ds_read_b64_tr_b16 a[44:45], v221 offset:0
  ds_read_b64_tr_b16 a[46:47], v221 offset:4096
  v_mfma_f32_16x16x32_bf16 v[108:111], a[0:3], a[144:147], v[180:183]
  v_exp_f32_e64 v201, v127
  v_mfma_f32_16x16x32_bf16 v[108:111], a[4:7], a[148:151], v[108:111]
  v_cvt_pk_bf16_f32 v160, v198, v199
  ds_read_b64_tr_b16 a[48:49], v222 offset:0
  v_mfma_f32_16x16x32_bf16 v[108:111], a[8:11], a[152:155], v[108:111]
  v_exp_f32_e64 v202, v136
  v_mfma_f32_16x16x32_bf16 v[108:111], a[12:15], a[156:159], v[108:111]
  ds_read_b64_tr_b16 a[50:51], v222 offset:4096
  s_waitcnt lgkmcnt(10)
  v_mfma_f32_16x16x32_bf16 v[112:115], a[16:19], a[112:115], v[172:175]
  v_exp_f32 v203, v137
  v_mfma_f32_16x16x32_bf16 v[112:115], a[20:23], a[116:119], v[112:115]
  v_cvt_pk_bf16_f32 v161, v200, v201
  ds_read_b64_tr_b16 a[52:53], v223 offset:0
  v_mfma_f32_16x16x32_bf16 v[112:115], a[24:27], a[120:123], v[112:115]
  v_exp_f32_e64 v204, v138
  v_mfma_f32_16x16x32_bf16 v[112:115], a[28:31], a[124:127], v[112:115]
  ds_read_b64_tr_b16 a[54:55], v223 offset:4096
  v_cvt_pk_bf16_f32 v162, v202, v203
  v_mfma_f32_16x16x32_bf16 v[116:119], a[16:19], a[128:131], v[176:179]
  v_exp_f32_e64 v205, v139
  v_mfma_f32_16x16x32_bf16 v[116:119], a[20:23], a[132:135], v[116:119]
  v_exp_f32_e64 v198, v128
  v_mfma_f32_16x16x32_bf16 v[116:119], a[24:27], a[136:139], v[116:119]
  ds_read_b64_tr_b16 a[56:57], v224 offset:0
  ds_read_b64_tr_b16 a[58:59], v224 offset:4096
  v_mfma_f32_16x16x32_bf16 v[116:119], a[28:31], a[140:143], v[116:119]
  v_exp_f32_e64 v199, v129
  v_mfma_f32_16x16x32_bf16 v[120:123], a[16:19], a[144:147], v[180:183]
  v_cvt_pk_bf16_f32 v163, v204, v205
  ds_read_b64_tr_b16 a[60:61], v225 offset:0
  v_mfma_f32_16x16x32_bf16 v[120:123], a[20:23], a[148:151], v[120:123]
  v_exp_f32_e64 v200, v130
  v_mfma_f32_16x16x32_bf16 v[120:123], a[24:27], a[152:155], v[120:123]
  ds_read_b64_tr_b16 a[62:63], v225 offset:4096
  v_cvt_pk_bf16_f32 v164, v198, v199
  v_mfma_f32_16x16x32_bf16 v[120:123], a[28:31], a[156:159], v[120:123]
  v_or_b32 v196, v160, v161
  s_waitcnt lgkmcnt(8)
  v_mfma_f32_16x16x32_bf16 v[4:7], a[32:35], v[148:151], 0
  v_exp_f32_e64 v201, v131
  v_mfma_f32_16x16x32_bf16 v[8:11], a[32:35], v[152:155], 0
  v_exp_f32_e64 v202, v140
  v_mfma_f32_16x16x32_bf16 v[12:15], a[32:35], v[156:159], 0
  v_exp_f32_e64 v203, v141
  v_mfma_f32_16x16x32_bf16 v[16:19], a[36:39], v[148:151], 0
  v_cvt_pk_bf16_f32 v165, v200, v201
  ds_read_b128 a[0:3], v214 offset:24576
  v_mfma_f32_16x16x32_bf16 v[20:23], a[36:39], v[152:155], 0
  v_exp_f32_e64 v204, v142
  v_mfma_f32_16x16x32_bf16 v[24:27], a[36:39], v[156:159], 0
  v_exp_f32_e64 v205, v143
  v_mfma_f32_16x16x32_bf16 v[28:31], a[40:43], v[148:151], 0
  v_cvt_pk_bf16_f32 v166, v202, v203
  ds_read_b128 a[4:7], v215 offset:24576
  v_mfma_f32_16x16x32_bf16 v[32:35], a[40:43], v[152:155], 0
  v_exp_f32_e64 v198, v132
  v_mfma_f32_16x16x32_bf16 v[36:39], a[40:43], v[156:159], 0
  v_exp_f32_e64 v199, v133
  v_mfma_f32_16x16x32_bf16 v[40:43], a[44:47], v[148:151], 0
  ds_read_b128 a[8:11], v216 offset:24576
  v_cvt_pk_bf16_f32 v167, v204, v205
  v_mfma_f32_16x16x32_bf16 v[44:47], a[44:47], v[152:155], 0
  v_exp_f32_e64 v200, v134
  v_mfma_f32_16x16x32_bf16 v[48:51], a[44:47], v[156:159], 0
  ds_read_b128 a[12:15], v217 offset:24576
  s_waitcnt lgkmcnt(4)
  v_mfma_f32_16x16x32_bf16 v[52:55], a[48:51], v[148:151], 0
  v_exp_f32 v201, v135
  v_mfma_f32_16x16x32_bf16 v[56:59], a[48:51], v[152:155], 0
  v_cvt_pk_bf16_f32 v168, v198, v199
  ds_read_b128 a[16:19], v214 offset:28672
  v_mfma_f32_16x16x32_bf16 v[60:63], a[48:51], v[156:159], 0
  v_exp_f32_e64 v202, v144
  v_mfma_f32_16x16x32_bf16 v[64:67], a[52:55], v[148:151], 0
  v_exp_f32_e64 v203, v145
  v_mfma_f32_16x16x32_bf16 v[68:71], a[52:55], v[152:155], 0
  v_cvt_pk_bf16_f32 v169, v200, v201
  v_cvt_pk_bf16_f32 v170, v202, v203
  v_mfma_f32_16x16x32_bf16 v[72:75], a[52:55], v[156:159], 0
  v_exp_f32_e64 v204, v146
  v_mfma_f32_16x16x32_bf16 v[76:79], a[56:59], v[148:151], 0
  v_exp_f32_e64 v205, v147
  v_mfma_f32_16x16x32_bf16 v[80:83], a[56:59], v[152:155], 0
  v_cvt_pk_bf16_f32 v171, v204, v205
  ds_read_b128 a[20:23], v215 offset:28672
  v_mfma_f32_16x16x32_bf16 v[84:87], a[56:59], v[156:159], 0
  v_or3_b32 v196, v196, v162, v163
  v_or3_b32 v196, v196, v164, v165
  v_mfma_f32_16x16x32_bf16 v[88:91], a[60:63], v[148:151], 0
  v_or3_b32 v196, v196, v166, v167
  v_or3_b32 v196, v196, v168, v169
  v_mfma_f32_16x16x32_bf16 v[92:95], a[60:63], v[152:155], 0
  v_or3_b32 v196, v196, v170, v171
  v_and_b32 v196, 0x40004000, v196
  v_mfma_f32_16x16x32_bf16 v[96:99], a[60:63], v[156:159], 0
  v_cmp_ne_u32 vcc, 0, v196
  ds_read_b128 a[24:27], v216 offset:28672
  v_mfma_f32_16x16x32_bf16 v[184:187], a[160:163], v[148:151], 0
  ds_read_b128 a[28:31], v217 offset:28672
  ds_read_b64_tr_b16 a[32:33], v218 offset:8192
  v_mfma_f32_16x16x32_bf16 v[188:191], a[160:163], v[152:155], 0
  ds_read_b64_tr_b16 a[34:35], v218 offset:12288
  v_mfma_f32_16x16x32_bf16 v[192:195], a[160:163], v[156:159], 0
  s_cbranch_vccnz L_ok_standalone__gqa_block_cached__near_ridge_kernel_p1s
L_ok_standalone__gqa_block_cached__near_ridge_kernel_p1:
.p2align 6
L_aloop_standalone__gqa_block_cached__near_ridge_kernel:
  s_waitcnt lgkmcnt(6)
  v_mfma_f32_16x16x32_bf16 v[124:127], a[0:3], a[112:115], v[172:175]
  ds_read_b64_tr_b16 a[36:37], v219 offset:8192
  ds_read_b64_tr_b16 a[38:39], v219 offset:12288
  v_mfma_f32_16x16x32_bf16 v[124:127], a[4:7], a[116:119], v[124:127]
  v_exp_f32 v198, v100
  v_mfma_f32_16x16x32_bf16 v[124:127], a[8:11], a[120:123], v[124:127]
  v_exp_f32_e64 v199, v101
  v_mfma_f32_16x16x32_bf16 v[124:127], a[12:15], a[124:127], v[124:127]
  ds_read_b64_tr_b16 a[40:41], v220 offset:8192
  ds_read_b64_tr_b16 a[42:43], v220 offset:12288
  v_mfma_f32_16x16x32_bf16 v[128:131], a[0:3], a[128:131], v[176:179]
  v_exp_f32_e64 v200, v102
  v_mfma_f32_16x16x32_bf16 v[128:131], a[4:7], a[132:135], v[128:131]
  v_exp_f32_e64 v201, v103
  v_mfma_f32_16x16x32_bf16 v[128:131], a[8:11], a[136:139], v[128:131]
  ds_read_b64_tr_b16 a[44:45], v221 offset:8192
  ds_read_b64_tr_b16 a[46:47], v221 offset:12288
  v_mfma_f32_16x16x32_bf16 v[128:131], a[12:15], a[140:143], v[128:131]
  v_cvt_pk_bf16_f32 v148, v198, v199
  v_cvt_pk_bf16_f32 v149, v200, v201
  v_mfma_f32_16x16x32_bf16 v[132:135], a[0:3], a[144:147], v[180:183]
  v_exp_f32_e64 v202, v112
  v_mfma_f32_16x16x32_bf16 v[132:135], a[4:7], a[148:151], v[132:135]
  ds_read_b64_tr_b16 a[48:49], v222 offset:8192
  ds_read_b64_tr_b16 a[50:51], v222 offset:12288
  v_mfma_f32_16x16x32_bf16 v[132:135], a[8:11], a[152:155], v[132:135]
  v_exp_f32_e64 v203, v113
  v_mfma_f32_16x16x32_bf16 v[132:135], a[12:15], a[156:159], v[132:135]
  v_cvt_pk_bf16_f32 v150, v202, v203
  s_waitcnt lgkmcnt(10)
  v_mfma_f32_16x16x32_bf16 v[136:139], a[16:19], a[112:115], v[172:175]
  v_exp_f32 v204, v114
  v_mfma_f32_16x16x32_bf16 v[136:139], a[20:23], a[116:119], v[136:139]
  ds_read_b64_tr_b16 a[52:53], v223 offset:8192
  ds_read_b64_tr_b16 a[54:55], v223 offset:12288
  v_mfma_f32_16x16x32_bf16 v[136:139], a[24:27], a[120:123], v[136:139]
  v_exp_f32_e64 v205, v115
  v_mfma_f32_16x16x32_bf16 v[136:139], a[28:31], a[124:127], v[136:139]
  v_exp_f32_e64 v198, v104
  v_mfma_f32_16x16x32_bf16 v[140:143], a[16:19], a[128:131], v[176:179]
  ds_read_b64_tr_b16 a[56:57], v224 offset:8192
  ds_read_b64_tr_b16 a[58:59], v224 offset:12288
  v_mfma_f32_16x16x32_bf16 v[140:143], a[20:23], a[132:135], v[140:143]
  v_exp_f32_e64 v199, v105
  v_mfma_f32_16x16x32_bf16 v[140:143], a[24:27], a[136:139], v[140:143]
  v_cvt_pk_bf16_f32 v151, v204, v205
  ds_read_b64_tr_b16 a[60:61], v225 offset:8192
  v_mfma_f32_16x16x32_bf16 v[140:143], a[28:31], a[140:143], v[140:143]
  v_exp_f32_e64 v200, v106
  v_mfma_f32_16x16x32_bf16 v[144:147], a[16:19], a[144:147], v[180:183]
  ds_read_b64_tr_b16 a[62:63], v225 offset:12288
  v_cvt_pk_bf16_f32 v152, v198, v199
  v_mfma_f32_16x16x32_bf16 v[144:147], a[20:23], a[148:151], v[144:147]
  v_exp_f32_e64 v201, v107
  v_mfma_f32_16x16x32_bf16 v[144:147], a[24:27], a[152:155], v[144:147]
  v_exp_f32_e64 v202, v116
  v_mfma_f32_16x16x32_bf16 v[144:147], a[28:31], a[156:159], v[144:147]
  v_cvt_pk_bf16_f32 v153, v200, v201
  s_waitcnt lgkmcnt(8)
  v_mfma_f32_16x16x32_bf16 v[4:7], a[32:35], v[160:163], v[4:7]
  v_exp_f32 v203, v117
  v_mfma_f32_16x16x32_bf16 v[8:11], a[32:35], v[164:167], v[8:11]
  v_exp_f32_e64 v204, v118
  v_mfma_f32_16x16x32_bf16 v[12:15], a[32:35], v[168:171], v[12:15]
  v_exp_f32_e64 v205, v119
  v_mfma_f32_16x16x32_bf16 v[16:19], a[36:39], v[160:163], v[16:19]
  v_cvt_pk_bf16_f32 v154, v202, v203
  v_cvt_pk_bf16_f32 v155, v204, v205
  v_mfma_f32_16x16x32_bf16 v[20:23], a[36:39], v[164:167], v[20:23]
  v_exp_f32_e64 v198, v108
  v_mfma_f32_16x16x32_bf16 v[24:27], a[36:39], v[168:171], v[24:27]
  v_exp_f32_e64 v199, v109
  v_mfma_f32_16x16x32_bf16 v[28:31], a[40:43], v[160:163], v[28:31]
  v_exp_f32_e64 v200, v110
  v_mfma_f32_16x16x32_bf16 v[32:35], a[40:43], v[164:167], v[32:35]
  v_exp_f32_e64 v201, v111
  v_mfma_f32_16x16x32_bf16 v[36:39], a[40:43], v[168:171], v[36:39]
  v_cvt_pk_bf16_f32 v156, v198, v199
  v_cvt_pk_bf16_f32 v157, v200, v201
  v_mfma_f32_16x16x32_bf16 v[40:43], a[44:47], v[160:163], v[40:43]
  v_exp_f32_e64 v202, v120
  v_mfma_f32_16x16x32_bf16 v[44:47], a[44:47], v[164:167], v[44:47]
  v_exp_f32_e64 v203, v121
  v_mfma_f32_16x16x32_bf16 v[48:51], a[44:47], v[168:171], v[48:51]
  v_cvt_pk_bf16_f32 v158, v202, v203
  s_waitcnt lgkmcnt(0)
  v_mfma_f32_16x16x32_bf16 v[52:55], a[48:51], v[160:163], v[52:55]
  s_barrier
  ds_read_b128 a[0:3], v214 offset:32768
  ds_read_b128 a[4:7], v215 offset:32768
  v_mfma_f32_16x16x32_bf16 v[56:59], a[48:51], v[164:167], v[56:59]
  ds_read_b128 a[8:11], v216 offset:32768
  ds_read_b128 a[12:15], v217 offset:32768
  v_mfma_f32_16x16x32_bf16 v[60:63], a[48:51], v[168:171], v[60:63]
  ds_read_b128 a[16:19], v214 offset:36864
  v_or_b32_e64 v196, v148, v149
  v_mfma_f32_16x16x32_bf16 v[64:67], a[52:55], v[160:163], v[64:67]
  v_exp_f32_e64 v204, v122
  v_mfma_f32_16x16x32_bf16 v[68:71], a[52:55], v[164:167], v[68:71]
  v_exp_f32_e64 v205, v123
  v_mfma_f32_16x16x32_bf16 v[72:75], a[52:55], v[168:171], v[72:75]
  v_cvt_pk_bf16_f32 v159, v204, v205
  ds_read_b128 a[20:23], v215 offset:36864
  v_mfma_f32_16x16x32_bf16 v[76:79], a[56:59], v[160:163], v[76:79]
  v_or3_b32 v196, v196, v150, v151
  v_or3_b32 v196, v196, v152, v153
  v_mfma_f32_16x16x32_bf16 v[80:83], a[56:59], v[164:167], v[80:83]
  v_or3_b32 v196, v196, v154, v155
  v_or3_b32 v196, v196, v156, v157
  v_mfma_f32_16x16x32_bf16 v[84:87], a[56:59], v[168:171], v[84:87]
  v_or3_b32 v196, v196, v158, v159
  v_and_b32 v196, 0x40004000, v196
  v_mfma_f32_16x16x32_bf16 v[88:91], a[60:63], v[160:163], v[88:91]
  v_cmp_ne_u32 vcc, 0, v196
  ds_read_b128 a[24:27], v216 offset:36864
  v_mfma_f32_16x16x32_bf16 v[92:95], a[60:63], v[164:167], v[92:95]
  ds_read_b128 a[28:31], v217 offset:36864
  v_mfma_f32_16x16x32_bf16 v[96:99], a[60:63], v[168:171], v[96:99]
  v_mfma_f32_16x16x32_bf16 v[184:187], a[160:163], v[160:163], v[184:187]
  ds_read_b64_tr_b16 a[32:33], v218 offset:16384
  ds_read_b64_tr_b16 a[34:35], v218 offset:20480
  v_mfma_f32_16x16x32_bf16 v[188:191], a[160:163], v[164:167], v[188:191]
  v_mfma_f32_16x16x32_bf16 v[192:195], a[160:163], v[168:171], v[192:195]
  s_cbranch_vccnz L_ok_standalone__gqa_block_cached__near_ridge_kernel_0s
L_ok_standalone__gqa_block_cached__near_ridge_kernel_0:
  s_waitcnt lgkmcnt(6)
  v_mfma_f32_16x16x32_bf16 v[100:103], a[0:3], a[112:115], v[172:175]
  ds_read_b64_tr_b16 a[36:37], v219 offset:16384
  ds_read_b64_tr_b16 a[38:39], v219 offset:20480
  v_mfma_f32_16x16x32_bf16 v[100:103], a[4:7], a[116:119], v[100:103]
  v_exp_f32 v198, v124
  v_mfma_f32_16x16x32_bf16 v[100:103], a[8:11], a[120:123], v[100:103]
  v_exp_f32_e64 v199, v125
  v_mfma_f32_16x16x32_bf16 v[100:103], a[12:15], a[124:127], v[100:103]
  ds_read_b64_tr_b16 a[40:41], v220 offset:16384
  ds_read_b64_tr_b16 a[42:43], v220 offset:20480
  v_mfma_f32_16x16x32_bf16 v[104:107], a[0:3], a[128:131], v[176:179]
  v_exp_f32_e64 v200, v126
  v_mfma_f32_16x16x32_bf16 v[104:107], a[4:7], a[132:135], v[104:107]
  v_exp_f32_e64 v201, v127
  v_mfma_f32_16x16x32_bf16 v[104:107], a[8:11], a[136:139], v[104:107]
  ds_read_b64_tr_b16 a[44:45], v221 offset:16384
  ds_read_b64_tr_b16 a[46:47], v221 offset:20480
  v_mfma_f32_16x16x32_bf16 v[104:107], a[12:15], a[140:143], v[104:107]
  v_cvt_pk_bf16_f32 v160, v198, v199
  v_cvt_pk_bf16_f32 v161, v200, v201
  v_mfma_f32_16x16x32_bf16 v[108:111], a[0:3], a[144:147], v[180:183]
  v_exp_f32_e64 v202, v136
  v_mfma_f32_16x16x32_bf16 v[108:111], a[4:7], a[148:151], v[108:111]
  ds_read_b64_tr_b16 a[48:49], v222 offset:16384
  ds_read_b64_tr_b16 a[50:51], v222 offset:20480
  v_mfma_f32_16x16x32_bf16 v[108:111], a[8:11], a[152:155], v[108:111]
  v_exp_f32_e64 v203, v137
  v_mfma_f32_16x16x32_bf16 v[108:111], a[12:15], a[156:159], v[108:111]
  v_cvt_pk_bf16_f32 v162, v202, v203
  s_waitcnt lgkmcnt(10)
  v_mfma_f32_16x16x32_bf16 v[112:115], a[16:19], a[112:115], v[172:175]
  v_exp_f32 v204, v138
  v_mfma_f32_16x16x32_bf16 v[112:115], a[20:23], a[116:119], v[112:115]
  ds_read_b64_tr_b16 a[52:53], v223 offset:16384
  ds_read_b64_tr_b16 a[54:55], v223 offset:20480
  v_mfma_f32_16x16x32_bf16 v[112:115], a[24:27], a[120:123], v[112:115]
  v_exp_f32_e64 v205, v139
  v_mfma_f32_16x16x32_bf16 v[112:115], a[28:31], a[124:127], v[112:115]
  v_exp_f32_e64 v198, v128
  v_mfma_f32_16x16x32_bf16 v[116:119], a[16:19], a[128:131], v[176:179]
  ds_read_b64_tr_b16 a[56:57], v224 offset:16384
  ds_read_b64_tr_b16 a[58:59], v224 offset:20480
  v_mfma_f32_16x16x32_bf16 v[116:119], a[20:23], a[132:135], v[116:119]
  v_exp_f32_e64 v199, v129
  v_mfma_f32_16x16x32_bf16 v[116:119], a[24:27], a[136:139], v[116:119]
  v_cvt_pk_bf16_f32 v163, v204, v205
  ds_read_b64_tr_b16 a[60:61], v225 offset:16384
  v_mfma_f32_16x16x32_bf16 v[116:119], a[28:31], a[140:143], v[116:119]
  v_exp_f32_e64 v200, v130
  v_mfma_f32_16x16x32_bf16 v[120:123], a[16:19], a[144:147], v[180:183]
  ds_read_b64_tr_b16 a[62:63], v225 offset:20480
  v_cvt_pk_bf16_f32 v164, v198, v199
  v_mfma_f32_16x16x32_bf16 v[120:123], a[20:23], a[148:151], v[120:123]
  v_exp_f32_e64 v201, v131
  v_mfma_f32_16x16x32_bf16 v[120:123], a[24:27], a[152:155], v[120:123]
  v_exp_f32_e64 v202, v140
  v_mfma_f32_16x16x32_bf16 v[120:123], a[28:31], a[156:159], v[120:123]
  v_cvt_pk_bf16_f32 v165, v200, v201
  s_waitcnt lgkmcnt(8)
  v_mfma_f32_16x16x32_bf16 v[4:7], a[32:35], v[148:151], v[4:7]
  v_exp_f32 v203, v141
  v_mfma_f32_16x16x32_bf16 v[8:11], a[32:35], v[152:155], v[8:11]
  ds_read_b128 a[0:3], v214 offset:40960
  v_cvt_pk_bf16_f32 v166, v202, v203
  v_mfma_f32_16x16x32_bf16 v[12:15], a[32:35], v[156:159], v[12:15]
  v_exp_f32_e64 v204, v142
  v_mfma_f32_16x16x32_bf16 v[16:19], a[36:39], v[148:151], v[16:19]
  v_exp_f32_e64 v205, v143
  v_mfma_f32_16x16x32_bf16 v[20:23], a[36:39], v[152:155], v[20:23]
  ds_read_b128 a[4:7], v215 offset:40960
  v_cvt_pk_bf16_f32 v167, v204, v205
  v_mfma_f32_16x16x32_bf16 v[24:27], a[36:39], v[156:159], v[24:27]
  v_exp_f32_e64 v198, v132
  v_mfma_f32_16x16x32_bf16 v[28:31], a[40:43], v[148:151], v[28:31]
  v_exp_f32_e64 v199, v133
  v_mfma_f32_16x16x32_bf16 v[32:35], a[40:43], v[152:155], v[32:35]
  ds_read_b128 a[8:11], v216 offset:40960
  v_cvt_pk_bf16_f32 v168, v198, v199
  v_mfma_f32_16x16x32_bf16 v[36:39], a[40:43], v[156:159], v[36:39]
  v_exp_f32_e64 v200, v134
  v_mfma_f32_16x16x32_bf16 v[40:43], a[44:47], v[148:151], v[40:43]
  v_exp_f32_e64 v201, v135
  v_mfma_f32_16x16x32_bf16 v[44:47], a[44:47], v[152:155], v[44:47]
  ds_read_b128 a[12:15], v217 offset:40960
  v_cvt_pk_bf16_f32 v169, v200, v201
  v_mfma_f32_16x16x32_bf16 v[48:51], a[44:47], v[156:159], v[48:51]
  v_or_b32 v196, v160, v161
  s_waitcnt lgkmcnt(4)
  v_mfma_f32_16x16x32_bf16 v[52:55], a[48:51], v[148:151], v[52:55]
  v_exp_f32_e64 v202, v144
  v_mfma_f32_16x16x32_bf16 v[56:59], a[48:51], v[152:155], v[56:59]
  ds_read_b128 a[16:19], v214 offset:45056
  v_or3_b32 v196, v196, v162, v163
  v_mfma_f32_16x16x32_bf16 v[60:63], a[48:51], v[156:159], v[60:63]
  v_exp_f32_e64 v203, v145
  v_mfma_f32_16x16x32_bf16 v[64:67], a[52:55], v[148:151], v[64:67]
  v_exp_f32_e64 v204, v146
  v_mfma_f32_16x16x32_bf16 v[68:71], a[52:55], v[152:155], v[68:71]
  v_exp_f32_e64 v205, v147
  v_mfma_f32_16x16x32_bf16 v[72:75], a[52:55], v[156:159], v[72:75]
  v_cvt_pk_bf16_f32 v170, v202, v203
  v_cvt_pk_bf16_f32 v171, v204, v205
  v_mfma_f32_16x16x32_bf16 v[76:79], a[56:59], v[148:151], v[76:79]
  ds_read_b128 a[20:23], v215 offset:45056
  v_or3_b32 v196, v196, v164, v165
  v_mfma_f32_16x16x32_bf16 v[80:83], a[56:59], v[152:155], v[80:83]
  v_or3_b32 v196, v196, v166, v167
  v_or3_b32 v196, v196, v168, v169
  v_mfma_f32_16x16x32_bf16 v[84:87], a[56:59], v[156:159], v[84:87]
  v_or3_b32 v196, v196, v170, v171
  v_and_b32 v196, 0x40004000, v196
  v_mfma_f32_16x16x32_bf16 v[88:91], a[60:63], v[148:151], v[88:91]
  v_cmp_ne_u32 vcc, 0, v196
  ds_read_b128 a[24:27], v216 offset:45056
  v_mfma_f32_16x16x32_bf16 v[92:95], a[60:63], v[152:155], v[92:95]
  ds_read_b128 a[28:31], v217 offset:45056
  v_mfma_f32_16x16x32_bf16 v[96:99], a[60:63], v[156:159], v[96:99]
  v_mfma_f32_16x16x32_bf16 v[184:187], a[160:163], v[148:151], v[184:187]
  ds_read_b64_tr_b16 a[32:33], v218 offset:24576
  ds_read_b64_tr_b16 a[34:35], v218 offset:28672
  v_mfma_f32_16x16x32_bf16 v[188:191], a[160:163], v[152:155], v[188:191]
  v_mfma_f32_16x16x32_bf16 v[192:195], a[160:163], v[156:159], v[192:195]
  s_cbranch_vccnz L_ok_standalone__gqa_block_cached__near_ridge_kernel_1s
L_ok_standalone__gqa_block_cached__near_ridge_kernel_1:
  s_waitcnt lgkmcnt(6)
  v_mfma_f32_16x16x32_bf16 v[124:127], a[0:3], a[112:115], v[172:175]
  ds_read_b64_tr_b16 a[36:37], v219 offset:24576
  ds_read_b64_tr_b16 a[38:39], v219 offset:28672
  v_mfma_f32_16x16x32_bf16 v[124:127], a[4:7], a[116:119], v[124:127]
  v_exp_f32 v198, v100
  v_mfma_f32_16x16x32_bf16 v[124:127], a[8:11], a[120:123], v[124:127]
  v_exp_f32_e64 v199, v101
  v_mfma_f32_16x16x32_bf16 v[124:127], a[12:15], a[124:127], v[124:127]
  ds_read_b64_tr_b16 a[40:41], v220 offset:24576
  ds_read_b64_tr_b16 a[42:43], v220 offset:28672
  v_mfma_f32_16x16x32_bf16 v[128:131], a[0:3], a[128:131], v[176:179]
  v_exp_f32_e64 v200, v102
  v_mfma_f32_16x16x32_bf16 v[128:131], a[4:7], a[132:135], v[128:131]
  v_exp_f32_e64 v201, v103
  v_mfma_f32_16x16x32_bf16 v[128:131], a[8:11], a[136:139], v[128:131]
  ds_read_b64_tr_b16 a[44:45], v221 offset:24576
  ds_read_b64_tr_b16 a[46:47], v221 offset:28672
  v_mfma_f32_16x16x32_bf16 v[128:131], a[12:15], a[140:143], v[128:131]
  v_cvt_pk_bf16_f32 v148, v198, v199
  v_cvt_pk_bf16_f32 v149, v200, v201
  v_mfma_f32_16x16x32_bf16 v[132:135], a[0:3], a[144:147], v[180:183]
  v_exp_f32_e64 v202, v112
  v_mfma_f32_16x16x32_bf16 v[132:135], a[4:7], a[148:151], v[132:135]
  ds_read_b64_tr_b16 a[48:49], v222 offset:24576
  ds_read_b64_tr_b16 a[50:51], v222 offset:28672
  v_mfma_f32_16x16x32_bf16 v[132:135], a[8:11], a[152:155], v[132:135]
  v_exp_f32_e64 v203, v113
  v_mfma_f32_16x16x32_bf16 v[132:135], a[12:15], a[156:159], v[132:135]
  v_cvt_pk_bf16_f32 v150, v202, v203
  s_waitcnt lgkmcnt(10)
  v_mfma_f32_16x16x32_bf16 v[136:139], a[16:19], a[112:115], v[172:175]
  v_exp_f32 v204, v114
  v_mfma_f32_16x16x32_bf16 v[136:139], a[20:23], a[116:119], v[136:139]
  ds_read_b64_tr_b16 a[52:53], v223 offset:24576
  ds_read_b64_tr_b16 a[54:55], v223 offset:28672
  v_mfma_f32_16x16x32_bf16 v[136:139], a[24:27], a[120:123], v[136:139]
  v_exp_f32_e64 v205, v115
  v_mfma_f32_16x16x32_bf16 v[136:139], a[28:31], a[124:127], v[136:139]
  v_exp_f32_e64 v198, v104
  v_mfma_f32_16x16x32_bf16 v[140:143], a[16:19], a[128:131], v[176:179]
  ds_read_b64_tr_b16 a[56:57], v224 offset:24576
  ds_read_b64_tr_b16 a[58:59], v224 offset:28672
  v_mfma_f32_16x16x32_bf16 v[140:143], a[20:23], a[132:135], v[140:143]
  v_exp_f32_e64 v199, v105
  v_mfma_f32_16x16x32_bf16 v[140:143], a[24:27], a[136:139], v[140:143]
  v_cvt_pk_bf16_f32 v151, v204, v205
  ds_read_b64_tr_b16 a[60:61], v225 offset:24576
  v_mfma_f32_16x16x32_bf16 v[140:143], a[28:31], a[140:143], v[140:143]
  v_exp_f32_e64 v200, v106
  v_mfma_f32_16x16x32_bf16 v[144:147], a[16:19], a[144:147], v[180:183]
  ds_read_b64_tr_b16 a[62:63], v225 offset:28672
  v_cvt_pk_bf16_f32 v152, v198, v199
  v_mfma_f32_16x16x32_bf16 v[144:147], a[20:23], a[148:151], v[144:147]
  v_exp_f32_e64 v201, v107
  v_mfma_f32_16x16x32_bf16 v[144:147], a[24:27], a[152:155], v[144:147]
  v_exp_f32_e64 v202, v116
  v_mfma_f32_16x16x32_bf16 v[144:147], a[28:31], a[156:159], v[144:147]
  v_cvt_pk_bf16_f32 v153, v200, v201
  s_waitcnt lgkmcnt(8)
  v_mfma_f32_16x16x32_bf16 v[4:7], a[32:35], v[160:163], v[4:7]
  v_exp_f32 v203, v117
  v_mfma_f32_16x16x32_bf16 v[8:11], a[32:35], v[164:167], v[8:11]
  v_exp_f32_e64 v204, v118
  v_mfma_f32_16x16x32_bf16 v[12:15], a[32:35], v[168:171], v[12:15]
  v_exp_f32_e64 v205, v119
  v_mfma_f32_16x16x32_bf16 v[16:19], a[36:39], v[160:163], v[16:19]
  v_cvt_pk_bf16_f32 v154, v202, v203
  v_cvt_pk_bf16_f32 v155, v204, v205
  v_mfma_f32_16x16x32_bf16 v[20:23], a[36:39], v[164:167], v[20:23]
  v_exp_f32_e64 v198, v108
  v_mfma_f32_16x16x32_bf16 v[24:27], a[36:39], v[168:171], v[24:27]
  v_exp_f32_e64 v199, v109
  v_mfma_f32_16x16x32_bf16 v[28:31], a[40:43], v[160:163], v[28:31]
  v_exp_f32_e64 v200, v110
  v_mfma_f32_16x16x32_bf16 v[32:35], a[40:43], v[164:167], v[32:35]
  v_exp_f32_e64 v201, v111
  v_mfma_f32_16x16x32_bf16 v[36:39], a[40:43], v[168:171], v[36:39]
  v_cvt_pk_bf16_f32 v156, v198, v199
  v_cvt_pk_bf16_f32 v157, v200, v201
  v_mfma_f32_16x16x32_bf16 v[40:43], a[44:47], v[160:163], v[40:43]
  v_exp_f32_e64 v202, v120
  v_mfma_f32_16x16x32_bf16 v[44:47], a[44:47], v[164:167], v[44:47]
  v_exp_f32_e64 v203, v121
  v_mfma_f32_16x16x32_bf16 v[48:51], a[44:47], v[168:171], v[48:51]
  v_cvt_pk_bf16_f32 v158, v202, v203
  s_waitcnt lgkmcnt(0)
  v_mfma_f32_16x16x32_bf16 v[52:55], a[48:51], v[160:163], v[52:55]
  s_barrier
  ds_read_b128 a[0:3], v214 offset:49152
  ds_read_b128 a[4:7], v215 offset:49152
  v_mfma_f32_16x16x32_bf16 v[56:59], a[48:51], v[164:167], v[56:59]
  ds_read_b128 a[8:11], v216 offset:49152
  ds_read_b128 a[12:15], v217 offset:49152
  v_mfma_f32_16x16x32_bf16 v[60:63], a[48:51], v[168:171], v[60:63]
  ds_read_b128 a[16:19], v214 offset:53248
  v_or_b32_e64 v196, v148, v149
  v_mfma_f32_16x16x32_bf16 v[64:67], a[52:55], v[160:163], v[64:67]
  v_exp_f32_e64 v204, v122
  v_mfma_f32_16x16x32_bf16 v[68:71], a[52:55], v[164:167], v[68:71]
  v_exp_f32_e64 v205, v123
  v_mfma_f32_16x16x32_bf16 v[72:75], a[52:55], v[168:171], v[72:75]
  v_cvt_pk_bf16_f32 v159, v204, v205
  ds_read_b128 a[20:23], v215 offset:53248
  v_mfma_f32_16x16x32_bf16 v[76:79], a[56:59], v[160:163], v[76:79]
  v_or3_b32 v196, v196, v150, v151
  v_or3_b32 v196, v196, v152, v153
  v_mfma_f32_16x16x32_bf16 v[80:83], a[56:59], v[164:167], v[80:83]
  v_or3_b32 v196, v196, v154, v155
  v_or3_b32 v196, v196, v156, v157
  v_mfma_f32_16x16x32_bf16 v[84:87], a[56:59], v[168:171], v[84:87]
  v_or3_b32 v196, v196, v158, v159
  v_and_b32 v196, 0x40004000, v196
  v_mfma_f32_16x16x32_bf16 v[88:91], a[60:63], v[160:163], v[88:91]
  v_cmp_ne_u32 vcc, 0, v196
  ds_read_b128 a[24:27], v216 offset:53248
  v_mfma_f32_16x16x32_bf16 v[92:95], a[60:63], v[164:167], v[92:95]
  ds_read_b128 a[28:31], v217 offset:53248
  v_mfma_f32_16x16x32_bf16 v[96:99], a[60:63], v[168:171], v[96:99]
  v_mfma_f32_16x16x32_bf16 v[184:187], a[160:163], v[160:163], v[184:187]
  ds_read_b64_tr_b16 a[32:33], v218 offset:32768
  ds_read_b64_tr_b16 a[34:35], v218 offset:36864
  v_mfma_f32_16x16x32_bf16 v[188:191], a[160:163], v[164:167], v[188:191]
  v_mfma_f32_16x16x32_bf16 v[192:195], a[160:163], v[168:171], v[192:195]
  s_cbranch_vccnz L_ok_standalone__gqa_block_cached__near_ridge_kernel_2s
L_ok_standalone__gqa_block_cached__near_ridge_kernel_2:
  s_waitcnt lgkmcnt(6)
  v_mfma_f32_16x16x32_bf16 v[100:103], a[0:3], a[112:115], v[172:175]
  ds_read_b64_tr_b16 a[36:37], v219 offset:32768
  ds_read_b64_tr_b16 a[38:39], v219 offset:36864
  v_mfma_f32_16x16x32_bf16 v[100:103], a[4:7], a[116:119], v[100:103]
  v_exp_f32 v198, v124
  v_mfma_f32_16x16x32_bf16 v[100:103], a[8:11], a[120:123], v[100:103]
  v_exp_f32_e64 v199, v125
  v_mfma_f32_16x16x32_bf16 v[100:103], a[12:15], a[124:127], v[100:103]
  ds_read_b64_tr_b16 a[40:41], v220 offset:32768
  ds_read_b64_tr_b16 a[42:43], v220 offset:36864
  v_mfma_f32_16x16x32_bf16 v[104:107], a[0:3], a[128:131], v[176:179]
  v_exp_f32_e64 v200, v126
  v_mfma_f32_16x16x32_bf16 v[104:107], a[4:7], a[132:135], v[104:107]
  v_exp_f32_e64 v201, v127
  v_mfma_f32_16x16x32_bf16 v[104:107], a[8:11], a[136:139], v[104:107]
  ds_read_b64_tr_b16 a[44:45], v221 offset:32768
  ds_read_b64_tr_b16 a[46:47], v221 offset:36864
  v_mfma_f32_16x16x32_bf16 v[104:107], a[12:15], a[140:143], v[104:107]
  v_cvt_pk_bf16_f32 v160, v198, v199
  v_cvt_pk_bf16_f32 v161, v200, v201
  v_mfma_f32_16x16x32_bf16 v[108:111], a[0:3], a[144:147], v[180:183]
  v_exp_f32_e64 v202, v136
  v_mfma_f32_16x16x32_bf16 v[108:111], a[4:7], a[148:151], v[108:111]
  ds_read_b64_tr_b16 a[48:49], v222 offset:32768
  ds_read_b64_tr_b16 a[50:51], v222 offset:36864
  v_mfma_f32_16x16x32_bf16 v[108:111], a[8:11], a[152:155], v[108:111]
  v_exp_f32_e64 v203, v137
  v_mfma_f32_16x16x32_bf16 v[108:111], a[12:15], a[156:159], v[108:111]
  v_cvt_pk_bf16_f32 v162, v202, v203
  s_waitcnt lgkmcnt(10)
  v_mfma_f32_16x16x32_bf16 v[112:115], a[16:19], a[112:115], v[172:175]
  v_exp_f32 v204, v138
  v_mfma_f32_16x16x32_bf16 v[112:115], a[20:23], a[116:119], v[112:115]
  ds_read_b64_tr_b16 a[52:53], v223 offset:32768
  ds_read_b64_tr_b16 a[54:55], v223 offset:36864
  v_mfma_f32_16x16x32_bf16 v[112:115], a[24:27], a[120:123], v[112:115]
  v_exp_f32_e64 v205, v139
  v_mfma_f32_16x16x32_bf16 v[112:115], a[28:31], a[124:127], v[112:115]
  v_exp_f32_e64 v198, v128
  v_mfma_f32_16x16x32_bf16 v[116:119], a[16:19], a[128:131], v[176:179]
  ds_read_b64_tr_b16 a[56:57], v224 offset:32768
  ds_read_b64_tr_b16 a[58:59], v224 offset:36864
  v_mfma_f32_16x16x32_bf16 v[116:119], a[20:23], a[132:135], v[116:119]
  v_exp_f32_e64 v199, v129
  v_mfma_f32_16x16x32_bf16 v[116:119], a[24:27], a[136:139], v[116:119]
  v_cvt_pk_bf16_f32 v163, v204, v205
  ds_read_b64_tr_b16 a[60:61], v225 offset:32768
  v_mfma_f32_16x16x32_bf16 v[116:119], a[28:31], a[140:143], v[116:119]
  v_exp_f32_e64 v200, v130
  v_mfma_f32_16x16x32_bf16 v[120:123], a[16:19], a[144:147], v[180:183]
  ds_read_b64_tr_b16 a[62:63], v225 offset:36864
  v_cvt_pk_bf16_f32 v164, v198, v199
  v_mfma_f32_16x16x32_bf16 v[120:123], a[20:23], a[148:151], v[120:123]
  v_exp_f32_e64 v201, v131
  v_mfma_f32_16x16x32_bf16 v[120:123], a[24:27], a[152:155], v[120:123]
  v_exp_f32_e64 v202, v140
  v_mfma_f32_16x16x32_bf16 v[120:123], a[28:31], a[156:159], v[120:123]
  v_cvt_pk_bf16_f32 v165, v200, v201
  s_waitcnt lgkmcnt(8)
  v_mfma_f32_16x16x32_bf16 v[4:7], a[32:35], v[148:151], v[4:7]
  v_exp_f32 v203, v141
  v_mfma_f32_16x16x32_bf16 v[8:11], a[32:35], v[152:155], v[8:11]
  ds_read_b128 a[0:3], v214 offset:57344
  v_cvt_pk_bf16_f32 v166, v202, v203
  v_mfma_f32_16x16x32_bf16 v[12:15], a[32:35], v[156:159], v[12:15]
  v_exp_f32_e64 v204, v142
  v_mfma_f32_16x16x32_bf16 v[16:19], a[36:39], v[148:151], v[16:19]
  v_exp_f32_e64 v205, v143
  v_mfma_f32_16x16x32_bf16 v[20:23], a[36:39], v[152:155], v[20:23]
  ds_read_b128 a[4:7], v215 offset:57344
  v_cvt_pk_bf16_f32 v167, v204, v205
  v_mfma_f32_16x16x32_bf16 v[24:27], a[36:39], v[156:159], v[24:27]
  v_exp_f32_e64 v198, v132
  v_mfma_f32_16x16x32_bf16 v[28:31], a[40:43], v[148:151], v[28:31]
  v_exp_f32_e64 v199, v133
  v_mfma_f32_16x16x32_bf16 v[32:35], a[40:43], v[152:155], v[32:35]
  ds_read_b128 a[8:11], v216 offset:57344
  v_cvt_pk_bf16_f32 v168, v198, v199
  v_mfma_f32_16x16x32_bf16 v[36:39], a[40:43], v[156:159], v[36:39]
  v_exp_f32_e64 v200, v134
  v_mfma_f32_16x16x32_bf16 v[40:43], a[44:47], v[148:151], v[40:43]
  v_exp_f32_e64 v201, v135
  v_mfma_f32_16x16x32_bf16 v[44:47], a[44:47], v[152:155], v[44:47]
  ds_read_b128 a[12:15], v217 offset:57344
  v_cvt_pk_bf16_f32 v169, v200, v201
  v_mfma_f32_16x16x32_bf16 v[48:51], a[44:47], v[156:159], v[48:51]
  v_or_b32 v196, v160, v161
  s_waitcnt lgkmcnt(4)
  v_mfma_f32_16x16x32_bf16 v[52:55], a[48:51], v[148:151], v[52:55]
  v_exp_f32_e64 v202, v144
  v_mfma_f32_16x16x32_bf16 v[56:59], a[48:51], v[152:155], v[56:59]
  ds_read_b128 a[16:19], v214 offset:61440
  v_or3_b32 v196, v196, v162, v163
  v_mfma_f32_16x16x32_bf16 v[60:63], a[48:51], v[156:159], v[60:63]
  v_exp_f32_e64 v203, v145
  v_mfma_f32_16x16x32_bf16 v[64:67], a[52:55], v[148:151], v[64:67]
  v_exp_f32_e64 v204, v146
  v_mfma_f32_16x16x32_bf16 v[68:71], a[52:55], v[152:155], v[68:71]
  v_exp_f32_e64 v205, v147
  v_mfma_f32_16x16x32_bf16 v[72:75], a[52:55], v[156:159], v[72:75]
  v_cvt_pk_bf16_f32 v170, v202, v203
  v_cvt_pk_bf16_f32 v171, v204, v205
  v_mfma_f32_16x16x32_bf16 v[76:79], a[56:59], v[148:151], v[76:79]
  ds_read_b128 a[20:23], v215 offset:61440
  v_or3_b32 v196, v196, v164, v165
  v_mfma_f32_16x16x32_bf16 v[80:83], a[56:59], v[152:155], v[80:83]
  v_or3_b32 v196, v196, v166, v167
  v_or3_b32 v196, v196, v168, v169
  v_mfma_f32_16x16x32_bf16 v[84:87], a[56:59], v[156:159], v[84:87]
  v_or3_b32 v196, v196, v170, v171
  v_and_b32 v196, 0x40004000, v196
  v_mfma_f32_16x16x32_bf16 v[88:91], a[60:63], v[148:151], v[88:91]
  v_cmp_ne_u32 vcc, 0, v196
  ds_read_b128 a[24:27], v216 offset:61440
  v_mfma_f32_16x16x32_bf16 v[92:95], a[60:63], v[152:155], v[92:95]
  ds_read_b128 a[28:31], v217 offset:61440
  v_mfma_f32_16x16x32_bf16 v[96:99], a[60:63], v[156:159], v[96:99]
  v_mfma_f32_16x16x32_bf16 v[184:187], a[160:163], v[148:151], v[184:187]
  ds_read_b64_tr_b16 a[32:33], v218 offset:40960
  ds_read_b64_tr_b16 a[34:35], v218 offset:45056
  v_mfma_f32_16x16x32_bf16 v[188:191], a[160:163], v[152:155], v[188:191]
  v_mfma_f32_16x16x32_bf16 v[192:195], a[160:163], v[156:159], v[192:195]
  s_cbranch_vccnz L_ok_standalone__gqa_block_cached__near_ridge_kernel_3s
L_ok_standalone__gqa_block_cached__near_ridge_kernel_3:
  s_waitcnt lgkmcnt(6)
  v_mfma_f32_16x16x32_bf16 v[124:127], a[0:3], a[112:115], v[172:175]
  ds_read_b64_tr_b16 a[36:37], v219 offset:40960
  ds_read_b64_tr_b16 a[38:39], v219 offset:45056
  v_mfma_f32_16x16x32_bf16 v[124:127], a[4:7], a[116:119], v[124:127]
  v_exp_f32 v198, v100
  v_mfma_f32_16x16x32_bf16 v[124:127], a[8:11], a[120:123], v[124:127]
  v_exp_f32_e64 v199, v101
  v_mfma_f32_16x16x32_bf16 v[124:127], a[12:15], a[124:127], v[124:127]
  ds_read_b64_tr_b16 a[40:41], v220 offset:40960
  ds_read_b64_tr_b16 a[42:43], v220 offset:45056
  v_mfma_f32_16x16x32_bf16 v[128:131], a[0:3], a[128:131], v[176:179]
  v_exp_f32_e64 v200, v102
  v_mfma_f32_16x16x32_bf16 v[128:131], a[4:7], a[132:135], v[128:131]
  v_exp_f32_e64 v201, v103
  v_mfma_f32_16x16x32_bf16 v[128:131], a[8:11], a[136:139], v[128:131]
  ds_read_b64_tr_b16 a[44:45], v221 offset:40960
  ds_read_b64_tr_b16 a[46:47], v221 offset:45056
  v_mfma_f32_16x16x32_bf16 v[128:131], a[12:15], a[140:143], v[128:131]
  v_cvt_pk_bf16_f32 v148, v198, v199
  v_cvt_pk_bf16_f32 v149, v200, v201
  v_mfma_f32_16x16x32_bf16 v[132:135], a[0:3], a[144:147], v[180:183]
  v_exp_f32_e64 v202, v112
  v_mfma_f32_16x16x32_bf16 v[132:135], a[4:7], a[148:151], v[132:135]
  ds_read_b64_tr_b16 a[48:49], v222 offset:40960
  ds_read_b64_tr_b16 a[50:51], v222 offset:45056
  v_mfma_f32_16x16x32_bf16 v[132:135], a[8:11], a[152:155], v[132:135]
  v_exp_f32_e64 v203, v113
  v_mfma_f32_16x16x32_bf16 v[132:135], a[12:15], a[156:159], v[132:135]
  v_cvt_pk_bf16_f32 v150, v202, v203
  s_waitcnt lgkmcnt(10)
  v_mfma_f32_16x16x32_bf16 v[136:139], a[16:19], a[112:115], v[172:175]
  v_exp_f32 v204, v114
  v_mfma_f32_16x16x32_bf16 v[136:139], a[20:23], a[116:119], v[136:139]
  ds_read_b64_tr_b16 a[52:53], v223 offset:40960
  ds_read_b64_tr_b16 a[54:55], v223 offset:45056
  v_mfma_f32_16x16x32_bf16 v[136:139], a[24:27], a[120:123], v[136:139]
  v_exp_f32_e64 v205, v115
  v_mfma_f32_16x16x32_bf16 v[136:139], a[28:31], a[124:127], v[136:139]
  v_exp_f32_e64 v198, v104
  v_mfma_f32_16x16x32_bf16 v[140:143], a[16:19], a[128:131], v[176:179]
  ds_read_b64_tr_b16 a[56:57], v224 offset:40960
  ds_read_b64_tr_b16 a[58:59], v224 offset:45056
  v_mfma_f32_16x16x32_bf16 v[140:143], a[20:23], a[132:135], v[140:143]
  v_exp_f32_e64 v199, v105
  v_mfma_f32_16x16x32_bf16 v[140:143], a[24:27], a[136:139], v[140:143]
  v_cvt_pk_bf16_f32 v151, v204, v205
  ds_read_b64_tr_b16 a[60:61], v225 offset:40960
  v_mfma_f32_16x16x32_bf16 v[140:143], a[28:31], a[140:143], v[140:143]
  v_exp_f32_e64 v200, v106
  v_mfma_f32_16x16x32_bf16 v[144:147], a[16:19], a[144:147], v[180:183]
  ds_read_b64_tr_b16 a[62:63], v225 offset:45056
  v_cvt_pk_bf16_f32 v152, v198, v199
  v_mfma_f32_16x16x32_bf16 v[144:147], a[20:23], a[148:151], v[144:147]
  v_exp_f32_e64 v201, v107
  v_mfma_f32_16x16x32_bf16 v[144:147], a[24:27], a[152:155], v[144:147]
  v_exp_f32_e64 v202, v116
  v_mfma_f32_16x16x32_bf16 v[144:147], a[28:31], a[156:159], v[144:147]
  v_cvt_pk_bf16_f32 v153, v200, v201
  s_waitcnt lgkmcnt(8)
  v_mfma_f32_16x16x32_bf16 v[4:7], a[32:35], v[160:163], v[4:7]
  v_exp_f32 v203, v117
  v_mfma_f32_16x16x32_bf16 v[8:11], a[32:35], v[164:167], v[8:11]
  v_exp_f32_e64 v204, v118
  v_mfma_f32_16x16x32_bf16 v[12:15], a[32:35], v[168:171], v[12:15]
  v_exp_f32_e64 v205, v119
  v_mfma_f32_16x16x32_bf16 v[16:19], a[36:39], v[160:163], v[16:19]
  v_cvt_pk_bf16_f32 v154, v202, v203
  v_cvt_pk_bf16_f32 v155, v204, v205
  v_mfma_f32_16x16x32_bf16 v[20:23], a[36:39], v[164:167], v[20:23]
  v_exp_f32_e64 v198, v108
  v_mfma_f32_16x16x32_bf16 v[24:27], a[36:39], v[168:171], v[24:27]
  v_exp_f32_e64 v199, v109
  v_mfma_f32_16x16x32_bf16 v[28:31], a[40:43], v[160:163], v[28:31]
  v_exp_f32_e64 v200, v110
  v_mfma_f32_16x16x32_bf16 v[32:35], a[40:43], v[164:167], v[32:35]
  v_exp_f32_e64 v201, v111
  v_mfma_f32_16x16x32_bf16 v[36:39], a[40:43], v[168:171], v[36:39]
  v_cvt_pk_bf16_f32 v156, v198, v199
  v_cvt_pk_bf16_f32 v157, v200, v201
  v_mfma_f32_16x16x32_bf16 v[40:43], a[44:47], v[160:163], v[40:43]
  v_exp_f32_e64 v202, v120
  v_mfma_f32_16x16x32_bf16 v[44:47], a[44:47], v[164:167], v[44:47]
  v_exp_f32_e64 v203, v121
  v_mfma_f32_16x16x32_bf16 v[48:51], a[44:47], v[168:171], v[48:51]
  v_cvt_pk_bf16_f32 v158, v202, v203
  s_waitcnt lgkmcnt(0)
  v_mfma_f32_16x16x32_bf16 v[52:55], a[48:51], v[160:163], v[52:55]
  s_barrier
  ds_read_b128 a[0:3], v214 offset:0
  ds_read_b128 a[4:7], v215 offset:0
  v_mfma_f32_16x16x32_bf16 v[56:59], a[48:51], v[164:167], v[56:59]
  ds_read_b128 a[8:11], v216 offset:0
  ds_read_b128 a[12:15], v217 offset:0
  v_mfma_f32_16x16x32_bf16 v[60:63], a[48:51], v[168:171], v[60:63]
  ds_read_b128 a[16:19], v214 offset:4096
  v_or_b32_e64 v196, v148, v149
  v_mfma_f32_16x16x32_bf16 v[64:67], a[52:55], v[160:163], v[64:67]
  v_exp_f32_e64 v204, v122
  v_mfma_f32_16x16x32_bf16 v[68:71], a[52:55], v[164:167], v[68:71]
  v_exp_f32_e64 v205, v123
  v_mfma_f32_16x16x32_bf16 v[72:75], a[52:55], v[168:171], v[72:75]
  v_cvt_pk_bf16_f32 v159, v204, v205
  ds_read_b128 a[20:23], v215 offset:4096
  v_mfma_f32_16x16x32_bf16 v[76:79], a[56:59], v[160:163], v[76:79]
  v_or3_b32 v196, v196, v150, v151
  v_or3_b32 v196, v196, v152, v153
  v_mfma_f32_16x16x32_bf16 v[80:83], a[56:59], v[164:167], v[80:83]
  v_or3_b32 v196, v196, v154, v155
  v_or3_b32 v196, v196, v156, v157
  v_mfma_f32_16x16x32_bf16 v[84:87], a[56:59], v[168:171], v[84:87]
  v_or3_b32 v196, v196, v158, v159
  v_and_b32 v196, 0x40004000, v196
  v_mfma_f32_16x16x32_bf16 v[88:91], a[60:63], v[160:163], v[88:91]
  v_cmp_ne_u32 vcc, 0, v196
  ds_read_b128 a[24:27], v216 offset:4096
  v_mfma_f32_16x16x32_bf16 v[92:95], a[60:63], v[164:167], v[92:95]
  ds_read_b128 a[28:31], v217 offset:4096
  v_mfma_f32_16x16x32_bf16 v[96:99], a[60:63], v[168:171], v[96:99]
  v_mfma_f32_16x16x32_bf16 v[184:187], a[160:163], v[160:163], v[184:187]
  ds_read_b64_tr_b16 a[32:33], v218 offset:49152
  s_add_u32 s31, s31, 1
  v_mfma_f32_16x16x32_bf16 v[188:191], a[160:163], v[164:167], v[188:191]
  ds_read_b64_tr_b16 a[34:35], v218 offset:53248
  s_cmp_eq_u32 s31, 4
  v_mfma_f32_16x16x32_bf16 v[192:195], a[160:163], v[168:171], v[192:195]
  s_cbranch_vccnz L_ok_standalone__gqa_block_cached__near_ridge_kernel_4s
L_ok_standalone__gqa_block_cached__near_ridge_kernel_4:
  s_cbranch_scc1 L_tail_standalone__gqa_block_cached__near_ridge_kernel
  s_waitcnt lgkmcnt(6)
  v_mfma_f32_16x16x32_bf16 v[100:103], a[0:3], a[112:115], v[172:175]
  ds_read_b64_tr_b16 a[36:37], v219 offset:49152
  ds_read_b64_tr_b16 a[38:39], v219 offset:53248
  v_mfma_f32_16x16x32_bf16 v[100:103], a[4:7], a[116:119], v[100:103]
  v_exp_f32_e64 v198, v124
  v_mfma_f32_16x16x32_bf16 v[100:103], a[8:11], a[120:123], v[100:103]
  v_exp_f32_e64 v199, v125
  v_mfma_f32_16x16x32_bf16 v[100:103], a[12:15], a[124:127], v[100:103]
  ds_read_b64_tr_b16 a[40:41], v220 offset:49152
  ds_read_b64_tr_b16 a[42:43], v220 offset:53248
  v_mfma_f32_16x16x32_bf16 v[104:107], a[0:3], a[128:131], v[176:179]
  v_exp_f32_e64 v200, v126
  v_mfma_f32_16x16x32_bf16 v[104:107], a[4:7], a[132:135], v[104:107]
  v_exp_f32_e64 v201, v127
  v_mfma_f32_16x16x32_bf16 v[104:107], a[8:11], a[136:139], v[104:107]
  ds_read_b64_tr_b16 a[44:45], v221 offset:49152
  ds_read_b64_tr_b16 a[46:47], v221 offset:53248
  v_mfma_f32_16x16x32_bf16 v[104:107], a[12:15], a[140:143], v[104:107]
  v_cvt_pk_bf16_f32 v160, v198, v199
  v_cvt_pk_bf16_f32 v161, v200, v201
  v_mfma_f32_16x16x32_bf16 v[108:111], a[0:3], a[144:147], v[180:183]
  v_exp_f32_e64 v202, v136
  v_mfma_f32_16x16x32_bf16 v[108:111], a[4:7], a[148:151], v[108:111]
  ds_read_b64_tr_b16 a[48:49], v222 offset:49152
  ds_read_b64_tr_b16 a[50:51], v222 offset:53248
  v_mfma_f32_16x16x32_bf16 v[108:111], a[8:11], a[152:155], v[108:111]
  v_exp_f32_e64 v203, v137
  v_mfma_f32_16x16x32_bf16 v[108:111], a[12:15], a[156:159], v[108:111]
  v_cvt_pk_bf16_f32 v162, v202, v203
  s_waitcnt lgkmcnt(10)
  v_mfma_f32_16x16x32_bf16 v[112:115], a[16:19], a[112:115], v[172:175]
  v_exp_f32 v204, v138
  v_mfma_f32_16x16x32_bf16 v[112:115], a[20:23], a[116:119], v[112:115]
  ds_read_b64_tr_b16 a[52:53], v223 offset:49152
  ds_read_b64_tr_b16 a[54:55], v223 offset:53248
  v_mfma_f32_16x16x32_bf16 v[112:115], a[24:27], a[120:123], v[112:115]
  v_exp_f32_e64 v205, v139
  v_mfma_f32_16x16x32_bf16 v[112:115], a[28:31], a[124:127], v[112:115]
  v_exp_f32_e64 v198, v128
  v_mfma_f32_16x16x32_bf16 v[116:119], a[16:19], a[128:131], v[176:179]
  ds_read_b64_tr_b16 a[56:57], v224 offset:49152
  ds_read_b64_tr_b16 a[58:59], v224 offset:53248
  v_mfma_f32_16x16x32_bf16 v[116:119], a[20:23], a[132:135], v[116:119]
  v_exp_f32_e64 v199, v129
  v_mfma_f32_16x16x32_bf16 v[116:119], a[24:27], a[136:139], v[116:119]
  v_cvt_pk_bf16_f32 v163, v204, v205
  ds_read_b64_tr_b16 a[60:61], v225 offset:49152
  v_mfma_f32_16x16x32_bf16 v[116:119], a[28:31], a[140:143], v[116:119]
  v_exp_f32_e64 v200, v130
  v_mfma_f32_16x16x32_bf16 v[120:123], a[16:19], a[144:147], v[180:183]
  ds_read_b64_tr_b16 a[62:63], v225 offset:53248
  v_cvt_pk_bf16_f32 v164, v198, v199
  v_mfma_f32_16x16x32_bf16 v[120:123], a[20:23], a[148:151], v[120:123]
  v_exp_f32_e64 v201, v131
  v_mfma_f32_16x16x32_bf16 v[120:123], a[24:27], a[152:155], v[120:123]
  v_exp_f32_e64 v202, v140
  v_mfma_f32_16x16x32_bf16 v[120:123], a[28:31], a[156:159], v[120:123]
  v_cvt_pk_bf16_f32 v165, v200, v201
  s_waitcnt lgkmcnt(8)
  v_mfma_f32_16x16x32_bf16 v[4:7], a[32:35], v[148:151], v[4:7]
  v_exp_f32 v203, v141
  v_mfma_f32_16x16x32_bf16 v[8:11], a[32:35], v[152:155], v[8:11]
  ds_read_b128 a[0:3], v214 offset:8192
  v_cvt_pk_bf16_f32 v166, v202, v203
  v_mfma_f32_16x16x32_bf16 v[12:15], a[32:35], v[156:159], v[12:15]
  v_exp_f32_e64 v204, v142
  v_mfma_f32_16x16x32_bf16 v[16:19], a[36:39], v[148:151], v[16:19]
  v_exp_f32_e64 v205, v143
  v_mfma_f32_16x16x32_bf16 v[20:23], a[36:39], v[152:155], v[20:23]
  ds_read_b128 a[4:7], v215 offset:8192
  v_cvt_pk_bf16_f32 v167, v204, v205
  v_mfma_f32_16x16x32_bf16 v[24:27], a[36:39], v[156:159], v[24:27]
  v_exp_f32_e64 v198, v132
  v_mfma_f32_16x16x32_bf16 v[28:31], a[40:43], v[148:151], v[28:31]
  v_exp_f32_e64 v199, v133
  v_mfma_f32_16x16x32_bf16 v[32:35], a[40:43], v[152:155], v[32:35]
  ds_read_b128 a[8:11], v216 offset:8192
  v_cvt_pk_bf16_f32 v168, v198, v199
  v_mfma_f32_16x16x32_bf16 v[36:39], a[40:43], v[156:159], v[36:39]
  v_exp_f32_e64 v200, v134
  v_mfma_f32_16x16x32_bf16 v[40:43], a[44:47], v[148:151], v[40:43]
  v_exp_f32_e64 v201, v135
  v_mfma_f32_16x16x32_bf16 v[44:47], a[44:47], v[152:155], v[44:47]
  ds_read_b128 a[12:15], v217 offset:8192
  v_cvt_pk_bf16_f32 v169, v200, v201
  v_mfma_f32_16x16x32_bf16 v[48:51], a[44:47], v[156:159], v[48:51]
  v_or_b32 v196, v160, v161
  s_waitcnt lgkmcnt(4)
  v_mfma_f32_16x16x32_bf16 v[52:55], a[48:51], v[148:151], v[52:55]
  v_exp_f32_e64 v202, v144
  v_mfma_f32_16x16x32_bf16 v[56:59], a[48:51], v[152:155], v[56:59]
  ds_read_b128 a[16:19], v214 offset:12288
  v_or3_b32 v196, v196, v162, v163
  v_mfma_f32_16x16x32_bf16 v[60:63], a[48:51], v[156:159], v[60:63]
  v_exp_f32_e64 v203, v145
  v_mfma_f32_16x16x32_bf16 v[64:67], a[52:55], v[148:151], v[64:67]
  v_exp_f32_e64 v204, v146
  v_mfma_f32_16x16x32_bf16 v[68:71], a[52:55], v[152:155], v[68:71]
  v_exp_f32_e64 v205, v147
  v_mfma_f32_16x16x32_bf16 v[72:75], a[52:55], v[156:159], v[72:75]
  v_cvt_pk_bf16_f32 v170, v202, v203
  v_cvt_pk_bf16_f32 v171, v204, v205
  v_mfma_f32_16x16x32_bf16 v[76:79], a[56:59], v[148:151], v[76:79]
  ds_read_b128 a[20:23], v215 offset:12288
  v_or3_b32 v196, v196, v164, v165
  v_mfma_f32_16x16x32_bf16 v[80:83], a[56:59], v[152:155], v[80:83]
  v_or3_b32 v196, v196, v166, v167
  v_or3_b32 v196, v196, v168, v169
  v_mfma_f32_16x16x32_bf16 v[84:87], a[56:59], v[156:159], v[84:87]
  v_or3_b32 v196, v196, v170, v171
  v_and_b32 v196, 0x40004000, v196
  v_mfma_f32_16x16x32_bf16 v[88:91], a[60:63], v[148:151], v[88:91]
  v_cmp_ne_u32 vcc, 0, v196
  ds_read_b128 a[24:27], v216 offset:12288
  v_mfma_f32_16x16x32_bf16 v[92:95], a[60:63], v[152:155], v[92:95]
  ds_read_b128 a[28:31], v217 offset:12288
  v_mfma_f32_16x16x32_bf16 v[96:99], a[60:63], v[156:159], v[96:99]
  v_mfma_f32_16x16x32_bf16 v[184:187], a[160:163], v[148:151], v[184:187]
  ds_read_b64_tr_b16 a[32:33], v218 offset:57344
  ds_read_b64_tr_b16 a[34:35], v218 offset:61440
  v_mfma_f32_16x16x32_bf16 v[188:191], a[160:163], v[152:155], v[188:191]
  v_mfma_f32_16x16x32_bf16 v[192:195], a[160:163], v[156:159], v[192:195]
  s_cbranch_vccnz L_ok_standalone__gqa_block_cached__near_ridge_kernel_5s
L_ok_standalone__gqa_block_cached__near_ridge_kernel_5:
  s_waitcnt lgkmcnt(6)
  v_mfma_f32_16x16x32_bf16 v[124:127], a[0:3], a[112:115], v[172:175]
  ds_read_b64_tr_b16 a[36:37], v219 offset:57344
  ds_read_b64_tr_b16 a[38:39], v219 offset:61440
  v_mfma_f32_16x16x32_bf16 v[124:127], a[4:7], a[116:119], v[124:127]
  v_exp_f32 v198, v100
  v_mfma_f32_16x16x32_bf16 v[124:127], a[8:11], a[120:123], v[124:127]
  v_exp_f32_e64 v199, v101
  v_mfma_f32_16x16x32_bf16 v[124:127], a[12:15], a[124:127], v[124:127]
  ds_read_b64_tr_b16 a[40:41], v220 offset:57344
  ds_read_b64_tr_b16 a[42:43], v220 offset:61440
  v_mfma_f32_16x16x32_bf16 v[128:131], a[0:3], a[128:131], v[176:179]
  v_exp_f32_e64 v200, v102
  v_mfma_f32_16x16x32_bf16 v[128:131], a[4:7], a[132:135], v[128:131]
  v_exp_f32_e64 v201, v103
  v_mfma_f32_16x16x32_bf16 v[128:131], a[8:11], a[136:139], v[128:131]
  ds_read_b64_tr_b16 a[44:45], v221 offset:57344
  ds_read_b64_tr_b16 a[46:47], v221 offset:61440
  v_mfma_f32_16x16x32_bf16 v[128:131], a[12:15], a[140:143], v[128:131]
  v_cvt_pk_bf16_f32 v148, v198, v199
  v_cvt_pk_bf16_f32 v149, v200, v201
  v_mfma_f32_16x16x32_bf16 v[132:135], a[0:3], a[144:147], v[180:183]
  v_exp_f32_e64 v202, v112
  v_mfma_f32_16x16x32_bf16 v[132:135], a[4:7], a[148:151], v[132:135]
  ds_read_b64_tr_b16 a[48:49], v222 offset:57344
  ds_read_b64_tr_b16 a[50:51], v222 offset:61440
  v_mfma_f32_16x16x32_bf16 v[132:135], a[8:11], a[152:155], v[132:135]
  v_exp_f32_e64 v203, v113
  v_mfma_f32_16x16x32_bf16 v[132:135], a[12:15], a[156:159], v[132:135]
  v_cvt_pk_bf16_f32 v150, v202, v203
  s_waitcnt lgkmcnt(10)
  v_mfma_f32_16x16x32_bf16 v[136:139], a[16:19], a[112:115], v[172:175]
  v_exp_f32 v204, v114
  v_mfma_f32_16x16x32_bf16 v[136:139], a[20:23], a[116:119], v[136:139]
  ds_read_b64_tr_b16 a[52:53], v223 offset:57344
  ds_read_b64_tr_b16 a[54:55], v223 offset:61440
  v_mfma_f32_16x16x32_bf16 v[136:139], a[24:27], a[120:123], v[136:139]
  v_exp_f32_e64 v205, v115
  v_mfma_f32_16x16x32_bf16 v[136:139], a[28:31], a[124:127], v[136:139]
  v_exp_f32_e64 v198, v104
  v_mfma_f32_16x16x32_bf16 v[140:143], a[16:19], a[128:131], v[176:179]
  ds_read_b64_tr_b16 a[56:57], v224 offset:57344
  ds_read_b64_tr_b16 a[58:59], v224 offset:61440
  v_mfma_f32_16x16x32_bf16 v[140:143], a[20:23], a[132:135], v[140:143]
  v_exp_f32_e64 v199, v105
  v_mfma_f32_16x16x32_bf16 v[140:143], a[24:27], a[136:139], v[140:143]
  v_cvt_pk_bf16_f32 v151, v204, v205
  ds_read_b64_tr_b16 a[60:61], v225 offset:57344
  v_mfma_f32_16x16x32_bf16 v[140:143], a[28:31], a[140:143], v[140:143]
  v_exp_f32_e64 v200, v106
  v_mfma_f32_16x16x32_bf16 v[144:147], a[16:19], a[144:147], v[180:183]
  ds_read_b64_tr_b16 a[62:63], v225 offset:61440
  v_cvt_pk_bf16_f32 v152, v198, v199
  v_mfma_f32_16x16x32_bf16 v[144:147], a[20:23], a[148:151], v[144:147]
  v_exp_f32_e64 v201, v107
  v_mfma_f32_16x16x32_bf16 v[144:147], a[24:27], a[152:155], v[144:147]
  v_exp_f32_e64 v202, v116
  v_mfma_f32_16x16x32_bf16 v[144:147], a[28:31], a[156:159], v[144:147]
  v_cvt_pk_bf16_f32 v153, v200, v201
  s_waitcnt lgkmcnt(8)
  v_mfma_f32_16x16x32_bf16 v[4:7], a[32:35], v[160:163], v[4:7]
  v_exp_f32 v203, v117
  v_mfma_f32_16x16x32_bf16 v[8:11], a[32:35], v[164:167], v[8:11]
  v_exp_f32_e64 v204, v118
  v_mfma_f32_16x16x32_bf16 v[12:15], a[32:35], v[168:171], v[12:15]
  v_exp_f32_e64 v205, v119
  v_mfma_f32_16x16x32_bf16 v[16:19], a[36:39], v[160:163], v[16:19]
  v_cvt_pk_bf16_f32 v154, v202, v203
  v_cvt_pk_bf16_f32 v155, v204, v205
  v_mfma_f32_16x16x32_bf16 v[20:23], a[36:39], v[164:167], v[20:23]
  v_exp_f32_e64 v198, v108
  v_mfma_f32_16x16x32_bf16 v[24:27], a[36:39], v[168:171], v[24:27]
  v_exp_f32_e64 v199, v109
  v_mfma_f32_16x16x32_bf16 v[28:31], a[40:43], v[160:163], v[28:31]
  v_exp_f32_e64 v200, v110
  v_mfma_f32_16x16x32_bf16 v[32:35], a[40:43], v[164:167], v[32:35]
  v_exp_f32_e64 v201, v111
  v_mfma_f32_16x16x32_bf16 v[36:39], a[40:43], v[168:171], v[36:39]
  v_cvt_pk_bf16_f32 v156, v198, v199
  v_cvt_pk_bf16_f32 v157, v200, v201
  v_mfma_f32_16x16x32_bf16 v[40:43], a[44:47], v[160:163], v[40:43]
  v_exp_f32_e64 v202, v120
  v_mfma_f32_16x16x32_bf16 v[44:47], a[44:47], v[164:167], v[44:47]
  v_exp_f32_e64 v203, v121
  v_mfma_f32_16x16x32_bf16 v[48:51], a[44:47], v[168:171], v[48:51]
  v_cvt_pk_bf16_f32 v158, v202, v203
  s_waitcnt lgkmcnt(0)
  v_mfma_f32_16x16x32_bf16 v[52:55], a[48:51], v[160:163], v[52:55]
  s_barrier
  ds_read_b128 a[0:3], v214 offset:16384
  ds_read_b128 a[4:7], v215 offset:16384
  v_mfma_f32_16x16x32_bf16 v[56:59], a[48:51], v[164:167], v[56:59]
  ds_read_b128 a[8:11], v216 offset:16384
  ds_read_b128 a[12:15], v217 offset:16384
  v_mfma_f32_16x16x32_bf16 v[60:63], a[48:51], v[168:171], v[60:63]
  ds_read_b128 a[16:19], v214 offset:20480
  v_or_b32_e64 v196, v148, v149
  v_mfma_f32_16x16x32_bf16 v[64:67], a[52:55], v[160:163], v[64:67]
  v_exp_f32_e64 v204, v122
  v_mfma_f32_16x16x32_bf16 v[68:71], a[52:55], v[164:167], v[68:71]
  v_exp_f32_e64 v205, v123
  v_mfma_f32_16x16x32_bf16 v[72:75], a[52:55], v[168:171], v[72:75]
  v_cvt_pk_bf16_f32 v159, v204, v205
  ds_read_b128 a[20:23], v215 offset:20480
  v_mfma_f32_16x16x32_bf16 v[76:79], a[56:59], v[160:163], v[76:79]
  v_or3_b32 v196, v196, v150, v151
  v_or3_b32 v196, v196, v152, v153
  v_mfma_f32_16x16x32_bf16 v[80:83], a[56:59], v[164:167], v[80:83]
  v_or3_b32 v196, v196, v154, v155
  v_or3_b32 v196, v196, v156, v157
  v_mfma_f32_16x16x32_bf16 v[84:87], a[56:59], v[168:171], v[84:87]
  v_or3_b32 v196, v196, v158, v159
  v_and_b32 v196, 0x40004000, v196
  v_mfma_f32_16x16x32_bf16 v[88:91], a[60:63], v[160:163], v[88:91]
  v_cmp_ne_u32 vcc, 0, v196
  ds_read_b128 a[24:27], v216 offset:20480
  v_mfma_f32_16x16x32_bf16 v[92:95], a[60:63], v[164:167], v[92:95]
  ds_read_b128 a[28:31], v217 offset:20480
  v_mfma_f32_16x16x32_bf16 v[96:99], a[60:63], v[168:171], v[96:99]
  v_mfma_f32_16x16x32_bf16 v[184:187], a[160:163], v[160:163], v[184:187]
  ds_read_b64_tr_b16 a[32:33], v218 offset:0
  ds_read_b64_tr_b16 a[34:35], v218 offset:4096
  v_mfma_f32_16x16x32_bf16 v[188:191], a[160:163], v[164:167], v[188:191]
  v_mfma_f32_16x16x32_bf16 v[192:195], a[160:163], v[168:171], v[192:195]
  s_cbranch_vccnz L_ok_standalone__gqa_block_cached__near_ridge_kernel_6s
L_ok_standalone__gqa_block_cached__near_ridge_kernel_6:
  s_waitcnt lgkmcnt(6)
  v_mfma_f32_16x16x32_bf16 v[100:103], a[0:3], a[112:115], v[172:175]
  ds_read_b64_tr_b16 a[36:37], v219 offset:0
  ds_read_b64_tr_b16 a[38:39], v219 offset:4096
  v_mfma_f32_16x16x32_bf16 v[100:103], a[4:7], a[116:119], v[100:103]
  v_exp_f32 v198, v124
  v_mfma_f32_16x16x32_bf16 v[100:103], a[8:11], a[120:123], v[100:103]
  v_exp_f32_e64 v199, v125
  v_mfma_f32_16x16x32_bf16 v[100:103], a[12:15], a[124:127], v[100:103]
  ds_read_b64_tr_b16 a[40:41], v220 offset:0
  ds_read_b64_tr_b16 a[42:43], v220 offset:4096
  v_mfma_f32_16x16x32_bf16 v[104:107], a[0:3], a[128:131], v[176:179]
  v_exp_f32_e64 v200, v126
  v_mfma_f32_16x16x32_bf16 v[104:107], a[4:7], a[132:135], v[104:107]
  v_exp_f32_e64 v201, v127
  v_mfma_f32_16x16x32_bf16 v[104:107], a[8:11], a[136:139], v[104:107]
  ds_read_b64_tr_b16 a[44:45], v221 offset:0
  ds_read_b64_tr_b16 a[46:47], v221 offset:4096
  v_mfma_f32_16x16x32_bf16 v[104:107], a[12:15], a[140:143], v[104:107]
  v_cvt_pk_bf16_f32 v160, v198, v199
  v_cvt_pk_bf16_f32 v161, v200, v201
  v_mfma_f32_16x16x32_bf16 v[108:111], a[0:3], a[144:147], v[180:183]
  v_exp_f32_e64 v202, v136
  v_mfma_f32_16x16x32_bf16 v[108:111], a[4:7], a[148:151], v[108:111]
  ds_read_b64_tr_b16 a[48:49], v222 offset:0
  ds_read_b64_tr_b16 a[50:51], v222 offset:4096
  v_mfma_f32_16x16x32_bf16 v[108:111], a[8:11], a[152:155], v[108:111]
  v_exp_f32_e64 v203, v137
  v_mfma_f32_16x16x32_bf16 v[108:111], a[12:15], a[156:159], v[108:111]
  v_cvt_pk_bf16_f32 v162, v202, v203
  s_waitcnt lgkmcnt(10)
  v_mfma_f32_16x16x32_bf16 v[112:115], a[16:19], a[112:115], v[172:175]
  v_exp_f32 v204, v138
  v_mfma_f32_16x16x32_bf16 v[112:115], a[20:23], a[116:119], v[112:115]
  ds_read_b64_tr_b16 a[52:53], v223 offset:0
  ds_read_b64_tr_b16 a[54:55], v223 offset:4096
  v_mfma_f32_16x16x32_bf16 v[112:115], a[24:27], a[120:123], v[112:115]
  v_exp_f32_e64 v205, v139
  v_mfma_f32_16x16x32_bf16 v[112:115], a[28:31], a[124:127], v[112:115]
  v_exp_f32_e64 v198, v128
  v_mfma_f32_16x16x32_bf16 v[116:119], a[16:19], a[128:131], v[176:179]
  ds_read_b64_tr_b16 a[56:57], v224 offset:0
  ds_read_b64_tr_b16 a[58:59], v224 offset:4096
  v_mfma_f32_16x16x32_bf16 v[116:119], a[20:23], a[132:135], v[116:119]
  v_exp_f32_e64 v199, v129
  v_mfma_f32_16x16x32_bf16 v[116:119], a[24:27], a[136:139], v[116:119]
  v_cvt_pk_bf16_f32 v163, v204, v205
  ds_read_b64_tr_b16 a[60:61], v225 offset:0
  v_mfma_f32_16x16x32_bf16 v[116:119], a[28:31], a[140:143], v[116:119]
  v_exp_f32_e64 v200, v130
  v_mfma_f32_16x16x32_bf16 v[120:123], a[16:19], a[144:147], v[180:183]
  ds_read_b64_tr_b16 a[62:63], v225 offset:4096
  v_cvt_pk_bf16_f32 v164, v198, v199
  v_mfma_f32_16x16x32_bf16 v[120:123], a[20:23], a[148:151], v[120:123]
  v_exp_f32_e64 v201, v131
  v_mfma_f32_16x16x32_bf16 v[120:123], a[24:27], a[152:155], v[120:123]
  v_exp_f32_e64 v202, v140
  v_mfma_f32_16x16x32_bf16 v[120:123], a[28:31], a[156:159], v[120:123]
  v_cvt_pk_bf16_f32 v165, v200, v201
  s_waitcnt lgkmcnt(8)
  v_mfma_f32_16x16x32_bf16 v[4:7], a[32:35], v[148:151], v[4:7]
  v_exp_f32 v203, v141
  v_mfma_f32_16x16x32_bf16 v[8:11], a[32:35], v[152:155], v[8:11]
  ds_read_b128 a[0:3], v214 offset:24576
  v_cvt_pk_bf16_f32 v166, v202, v203
  v_mfma_f32_16x16x32_bf16 v[12:15], a[32:35], v[156:159], v[12:15]
  v_exp_f32_e64 v204, v142
  v_mfma_f32_16x16x32_bf16 v[16:19], a[36:39], v[148:151], v[16:19]
  v_exp_f32_e64 v205, v143
  v_mfma_f32_16x16x32_bf16 v[20:23], a[36:39], v[152:155], v[20:23]
  ds_read_b128 a[4:7], v215 offset:24576
  v_cvt_pk_bf16_f32 v167, v204, v205
  v_mfma_f32_16x16x32_bf16 v[24:27], a[36:39], v[156:159], v[24:27]
  v_exp_f32_e64 v198, v132
  v_mfma_f32_16x16x32_bf16 v[28:31], a[40:43], v[148:151], v[28:31]
  v_exp_f32_e64 v199, v133
  v_mfma_f32_16x16x32_bf16 v[32:35], a[40:43], v[152:155], v[32:35]
  ds_read_b128 a[8:11], v216 offset:24576
  v_cvt_pk_bf16_f32 v168, v198, v199
  v_mfma_f32_16x16x32_bf16 v[36:39], a[40:43], v[156:159], v[36:39]
  v_exp_f32_e64 v200, v134
  v_mfma_f32_16x16x32_bf16 v[40:43], a[44:47], v[148:151], v[40:43]
  v_exp_f32_e64 v201, v135
  v_mfma_f32_16x16x32_bf16 v[44:47], a[44:47], v[152:155], v[44:47]
  ds_read_b128 a[12:15], v217 offset:24576
  v_cvt_pk_bf16_f32 v169, v200, v201
  v_mfma_f32_16x16x32_bf16 v[48:51], a[44:47], v[156:159], v[48:51]
  v_or_b32 v196, v160, v161
  s_waitcnt lgkmcnt(4)
  v_mfma_f32_16x16x32_bf16 v[52:55], a[48:51], v[148:151], v[52:55]
  v_exp_f32_e64 v202, v144
  v_mfma_f32_16x16x32_bf16 v[56:59], a[48:51], v[152:155], v[56:59]
  ds_read_b128 a[16:19], v214 offset:28672
  v_or3_b32 v196, v196, v162, v163
  v_mfma_f32_16x16x32_bf16 v[60:63], a[48:51], v[156:159], v[60:63]
  v_exp_f32_e64 v203, v145
  v_mfma_f32_16x16x32_bf16 v[64:67], a[52:55], v[148:151], v[64:67]
  v_exp_f32_e64 v204, v146
  v_mfma_f32_16x16x32_bf16 v[68:71], a[52:55], v[152:155], v[68:71]
  v_exp_f32_e64 v205, v147
  v_mfma_f32_16x16x32_bf16 v[72:75], a[52:55], v[156:159], v[72:75]
  v_cvt_pk_bf16_f32 v170, v202, v203
  v_cvt_pk_bf16_f32 v171, v204, v205
  v_mfma_f32_16x16x32_bf16 v[76:79], a[56:59], v[148:151], v[76:79]
  ds_read_b128 a[20:23], v215 offset:28672
  v_or3_b32 v196, v196, v164, v165
  v_mfma_f32_16x16x32_bf16 v[80:83], a[56:59], v[152:155], v[80:83]
  v_or3_b32 v196, v196, v166, v167
  v_or3_b32 v196, v196, v168, v169
  v_mfma_f32_16x16x32_bf16 v[84:87], a[56:59], v[156:159], v[84:87]
  v_or3_b32 v196, v196, v170, v171
  v_and_b32 v196, 0x40004000, v196
  v_mfma_f32_16x16x32_bf16 v[88:91], a[60:63], v[148:151], v[88:91]
  v_cmp_ne_u32 vcc, 0, v196
  ds_read_b128 a[24:27], v216 offset:28672
  v_mfma_f32_16x16x32_bf16 v[92:95], a[60:63], v[152:155], v[92:95]
  ds_read_b128 a[28:31], v217 offset:28672
  v_mfma_f32_16x16x32_bf16 v[96:99], a[60:63], v[156:159], v[96:99]
  v_mfma_f32_16x16x32_bf16 v[184:187], a[160:163], v[148:151], v[184:187]
  ds_read_b64_tr_b16 a[32:33], v218 offset:8192
  ds_read_b64_tr_b16 a[34:35], v218 offset:12288
  v_mfma_f32_16x16x32_bf16 v[188:191], a[160:163], v[152:155], v[188:191]
  v_mfma_f32_16x16x32_bf16 v[192:195], a[160:163], v[156:159], v[192:195]
  s_cbranch_vccnz L_ok_standalone__gqa_block_cached__near_ridge_kernel_7s
L_ok_standalone__gqa_block_cached__near_ridge_kernel_7:
  s_branch L_aloop_standalone__gqa_block_cached__near_ridge_kernel
L_tail_standalone__gqa_block_cached__near_ridge_kernel:
  s_waitcnt lgkmcnt(1)
  ds_read_b64_tr_b16 a[32:33], v218 offset:49152
  s_waitcnt lgkmcnt(1)
  ds_read_b64_tr_b16 a[34:35], v218 offset:53248
  ds_read_b64_tr_b16 a[36:37], v219 offset:49152
  ds_read_b64_tr_b16 a[38:39], v219 offset:53248
  ds_read_b64_tr_b16 a[40:41], v220 offset:49152
  ds_read_b64_tr_b16 a[42:43], v220 offset:53248
  ds_read_b64_tr_b16 a[44:45], v221 offset:49152
  ds_read_b64_tr_b16 a[46:47], v221 offset:53248
  ds_read_b64_tr_b16 a[48:49], v222 offset:49152
  ds_read_b64_tr_b16 a[50:51], v222 offset:53248
  ds_read_b64_tr_b16 a[52:53], v223 offset:49152
  ds_read_b64_tr_b16 a[54:55], v223 offset:53248
  ds_read_b64_tr_b16 a[56:57], v224 offset:49152
  ds_read_b64_tr_b16 a[58:59], v224 offset:53248
  ds_read_b64_tr_b16 a[60:61], v225 offset:49152
  ds_read_b64_tr_b16 a[62:63], v225 offset:53248
  s_waitcnt lgkmcnt(12)
  v_mfma_f32_16x16x32_bf16 v[4:7], a[32:35], v[148:151], v[4:7]
  v_exp_f32_e64 v198, v124
  v_mfma_f32_16x16x32_bf16 v[8:11], a[32:35], v[152:155], v[8:11]
  v_exp_f32_e64 v199, v125
  v_mfma_f32_16x16x32_bf16 v[12:15], a[32:35], v[156:159], v[12:15]
  v_exp_f32_e64 v200, v126
  v_mfma_f32_16x16x32_bf16 v[16:19], a[36:39], v[148:151], v[16:19]
  ds_read_b64_tr_b16 a[0:1], v218 offset:57344
  ds_read_b64_tr_b16 a[2:3], v218 offset:61440
  v_mfma_f32_16x16x32_bf16 v[20:23], a[36:39], v[152:155], v[20:23]
  v_exp_f32_e64 v201, v127
  v_mfma_f32_16x16x32_bf16 v[24:27], a[36:39], v[156:159], v[24:27]
  v_cvt_pk_bf16_f32 v160, v198, v199
  s_waitcnt lgkmcnt(10)
  v_mfma_f32_16x16x32_bf16 v[28:31], a[40:43], v[148:151], v[28:31]
  s_andn2_b32 exec_lo, 7, s20
  s_mov_b32 exec_hi, 0
  buffer_load_dword v228, v229, s[16:19], s95 offen sc1
  s_mov_b64 exec, -1
  v_mfma_f32_16x16x32_bf16 v[32:35], a[40:43], v[152:155], v[32:35]
  v_exp_f32_e64 v202, v136
  v_mfma_f32_16x16x32_bf16 v[36:39], a[40:43], v[156:159], v[36:39]
  v_exp_f32_e64 v203, v137
  v_mfma_f32_16x16x32_bf16 v[40:43], a[44:47], v[148:151], v[40:43]
  v_exp_f32_e64 v204, v138
  v_mfma_f32_16x16x32_bf16 v[44:47], a[44:47], v[152:155], v[44:47]
  v_exp_f32_e64 v205, v139
  v_mfma_f32_16x16x32_bf16 v[48:51], a[44:47], v[156:159], v[48:51]
  ds_read_b64_tr_b16 a[4:5], v219 offset:57344
  s_waitcnt lgkmcnt(7)
  v_mfma_f32_16x16x32_bf16 v[52:55], a[48:51], v[148:151], v[52:55]
  ds_read_b64_tr_b16 a[6:7], v219 offset:61440
  v_cvt_pk_bf16_f32 v161, v200, v201
  v_mfma_f32_16x16x32_bf16 v[56:59], a[48:51], v[152:155], v[56:59]
  v_exp_f32 v198, v128
  v_mfma_f32_16x16x32_bf16 v[60:63], a[48:51], v[156:159], v[60:63]
  v_exp_f32_e64 v199, v129
  v_mfma_f32_16x16x32_bf16 v[64:67], a[52:55], v[148:151], v[64:67]
  v_exp_f32_e64 v200, v130
  v_mfma_f32_16x16x32_bf16 v[68:71], a[52:55], v[152:155], v[68:71]
  v_exp_f32_e64 v201, v131
  v_mfma_f32_16x16x32_bf16 v[72:75], a[52:55], v[156:159], v[72:75]
  v_cvt_pk_bf16_f32 v162, v202, v203
  s_waitcnt lgkmcnt(4)
  v_mfma_f32_16x16x32_bf16 v[76:79], a[56:59], v[148:151], v[76:79]
  ds_read_b64_tr_b16 a[8:9], v220 offset:57344
  ds_read_b64_tr_b16 a[10:11], v220 offset:61440
  v_exp_f32 v202, v140
  v_exp_f32_e64 v203, v141
  v_cvt_pk_bf16_f32 v163, v204, v205
  v_mfma_f32_16x16x32_bf16 v[80:83], a[56:59], v[152:155], v[80:83]
  v_exp_f32_e64 v204, v142
  v_mfma_f32_16x16x32_bf16 v[84:87], a[56:59], v[156:159], v[84:87]
  v_exp_f32_e64 v205, v143
  v_cvt_pk_bf16_f32 v164, v198, v199
  v_exp_f32_e64 v198, v132
  v_mfma_f32_16x16x32_bf16 v[88:91], a[60:63], v[148:151], v[88:91]
  ds_read_b64_tr_b16 a[12:13], v221 offset:57344
  ds_read_b64_tr_b16 a[14:15], v221 offset:61440
  v_exp_f32_e64 v199, v133
  v_cvt_pk_bf16_f32 v165, v200, v201
  v_mfma_f32_16x16x32_bf16 v[92:95], a[60:63], v[152:155], v[92:95]
  v_exp_f32 v200, v134
  v_exp_f32 v201, v135
  v_cvt_pk_bf16_f32 v166, v202, v203
  v_exp_f32 v202, v144
  v_exp_f32 v203, v145
  v_mfma_f32_16x16x32_bf16 v[96:99], a[60:63], v[156:159], v[96:99]
  v_cvt_pk_bf16_f32 v167, v204, v205
  v_exp_f32 v204, v146
  v_exp_f32 v205, v147
  v_cvt_pk_bf16_f32 v168, v198, v199
  v_cvt_pk_bf16_f32 v169, v200, v201
  v_cvt_pk_bf16_f32 v170, v202, v203
  v_mfma_f32_16x16x32_bf16 v[184:187], a[160:163], v[148:151], v[184:187]
  v_cvt_pk_bf16_f32 v171, v204, v205
  ds_read_b64_tr_b16 a[16:17], v222 offset:57344
  ds_read_b64_tr_b16 a[18:19], v222 offset:61440
  v_or_b32_e64 v196, v160, v161
  v_or3_b32 v196, v196, v162, v163
  v_or3_b32 v196, v196, v164, v165
  v_or3_b32 v196, v196, v166, v167
  v_or3_b32 v196, v196, v168, v169
  v_or3_b32 v196, v196, v170, v171
  v_mfma_f32_16x16x32_bf16 v[188:191], a[160:163], v[152:155], v[188:191]
  v_and_b32 v196, 0x40004000, v196
  v_cmp_ne_u32 vcc, 0, v196
  v_mfma_f32_16x16x32_bf16 v[192:195], a[160:163], v[156:159], v[192:195]
  ds_read_b64_tr_b16 a[20:21], v223 offset:57344
  s_cbranch_vccnz L_ok_standalone__gqa_block_cached__near_ridge_kernel_p31s
L_ok_standalone__gqa_block_cached__near_ridge_kernel_p31:
  v_mfma_f32_16x16x32_bf16 v[184:187], a[160:163], v[160:163], v[184:187]
  ds_read_b64_tr_b16 a[22:23], v223 offset:61440
  ds_read_b64_tr_b16 a[24:25], v224 offset:57344
  v_mfma_f32_16x16x32_bf16 v[188:191], a[160:163], v[164:167], v[188:191]
  ds_read_b64_tr_b16 a[26:27], v224 offset:61440
  ds_read_b64_tr_b16 a[28:29], v225 offset:57344
  v_mfma_f32_16x16x32_bf16 v[192:195], a[160:163], v[168:171], v[192:195]
  ds_read_b64_tr_b16 a[30:31], v225 offset:61440
  s_waitcnt lgkmcnt(12)
  v_mfma_f32_16x16x32_bf16 v[4:7], a[0:3], v[160:163], v[4:7]
  v_mfma_f32_16x16x32_bf16 v[8:11], a[0:3], v[164:167], v[8:11]
  v_mfma_f32_16x16x32_bf16 v[12:15], a[0:3], v[168:171], v[12:15]
  v_rcp_f32 v184, v184
  v_mfma_f32_16x16x32_bf16 v[16:19], a[4:7], v[160:163], v[16:19]
  v_rcp_f32_e64 v188, v188
  v_mfma_f32_16x16x32_bf16 v[20:23], a[4:7], v[164:167], v[20:23]
  v_rcp_f32_e64 v192, v192
  v_mfma_f32_16x16x32_bf16 v[24:27], a[4:7], v[168:171], v[24:27]
  s_waitcnt lgkmcnt(8)
  v_mfma_f32_16x16x32_bf16 v[28:31], a[8:11], v[160:163], v[28:31]
  v_mfma_f32_16x16x32_bf16 v[32:35], a[8:11], v[164:167], v[32:35]
  v_mfma_f32_16x16x32_bf16 v[36:39], a[8:11], v[168:171], v[36:39]
  v_pk_mul_f32 v[4:5], v[4:5], v[184:185] op_sel_hi:[1,0]
  v_pk_mul_f32 v[6:7], v[6:7], v[184:185] op_sel_hi:[1,0]
  v_mfma_f32_16x16x32_bf16 v[40:43], a[12:15], v[160:163], v[40:43]
  v_pk_mul_f32 v[16:17], v[16:17], v[184:185] op_sel_hi:[1,0]
  v_pk_mul_f32 v[18:19], v[18:19], v[184:185] op_sel_hi:[1,0]
  v_mfma_f32_16x16x32_bf16 v[44:47], a[12:15], v[164:167], v[44:47]
  v_pk_mul_f32 v[8:9], v[8:9], v[188:189] op_sel_hi:[1,0]
  v_pk_mul_f32 v[10:11], v[10:11], v[188:189] op_sel_hi:[1,0]
  v_mfma_f32_16x16x32_bf16 v[48:51], a[12:15], v[168:171], v[48:51]
  v_pk_mul_f32 v[20:21], v[20:21], v[188:189] op_sel_hi:[1,0]
  s_waitcnt lgkmcnt(4)
  v_mfma_f32_16x16x32_bf16 v[52:55], a[16:19], v[160:163], v[52:55]
  v_pk_mul_f32 v[22:23], v[22:23], v[188:189] op_sel_hi:[1,0]
  v_pk_mul_f32 v[12:13], v[12:13], v[192:193] op_sel_hi:[1,0]
  v_mfma_f32_16x16x32_bf16 v[56:59], a[16:19], v[164:167], v[56:59]
  v_pk_mul_f32 v[14:15], v[14:15], v[192:193] op_sel_hi:[1,0]
  v_pk_mul_f32 v[24:25], v[24:25], v[192:193] op_sel_hi:[1,0]
  v_mfma_f32_16x16x32_bf16 v[60:63], a[16:19], v[168:171], v[60:63]
  v_pk_mul_f32 v[26:27], v[26:27], v[192:193] op_sel_hi:[1,0]
  v_cvt_pk_bf16_f32 v4, v4, v5
  v_mfma_f32_16x16x32_bf16 v[64:67], a[20:23], v[160:163], v[64:67]
  v_cvt_pk_bf16_f32 v5, v6, v7
  v_cvt_pk_bf16_f32 v6, v16, v17
  v_mfma_f32_16x16x32_bf16 v[68:71], a[20:23], v[164:167], v[68:71]
  v_cvt_pk_bf16_f32 v7, v18, v19
  buffer_store_dwordx4 v[4:7], v237, s[8:11], s34 offen offset:0 sc1
  v_mfma_f32_16x16x32_bf16 v[72:75], a[20:23], v[168:171], v[72:75]
  v_cvt_pk_bf16_f32 v8, v8, v9
  s_waitcnt lgkmcnt(0)
  v_mfma_f32_16x16x32_bf16 v[76:79], a[24:27], v[160:163], v[76:79]
  v_cvt_pk_bf16_f32 v9, v10, v11
  v_cvt_pk_bf16_f32 v10, v20, v21
  v_mfma_f32_16x16x32_bf16 v[80:83], a[24:27], v[164:167], v[80:83]
  v_cvt_pk_bf16_f32 v11, v22, v23
  buffer_store_dwordx4 v[8:11], v238, s[8:11], s34 offen offset:0 sc1
  v_mfma_f32_16x16x32_bf16 v[84:87], a[24:27], v[168:171], v[84:87]
  v_cvt_pk_bf16_f32 v12, v12, v13
  v_cvt_pk_bf16_f32 v13, v14, v15
  v_mfma_f32_16x16x32_bf16 v[88:91], a[28:31], v[160:163], v[88:91]
  v_cvt_pk_bf16_f32 v14, v24, v25
  v_cvt_pk_bf16_f32 v15, v26, v27
  v_mfma_f32_16x16x32_bf16 v[92:95], a[28:31], v[164:167], v[92:95]
  buffer_store_dwordx4 v[12:15], v239, s[8:11], s34 offen offset:0 sc1
  v_pk_mul_f32 v[28:29], v[28:29], v[184:185] op_sel_hi:[1,0]
  v_mfma_f32_16x16x32_bf16 v[96:99], a[28:31], v[168:171], v[96:99]
  v_pk_mul_f32 v[30:31], v[30:31], v[184:185] op_sel_hi:[1,0]
  v_pk_mul_f32 v[40:41], v[40:41], v[184:185] op_sel_hi:[1,0]
  v_pk_mul_f32 v[42:43], v[42:43], v[184:185] op_sel_hi:[1,0]
  v_pk_mul_f32 v[32:33], v[32:33], v[188:189] op_sel_hi:[1,0]
  v_pk_mul_f32 v[34:35], v[34:35], v[188:189] op_sel_hi:[1,0]
  v_pk_mul_f32 v[44:45], v[44:45], v[188:189] op_sel_hi:[1,0]
  v_pk_mul_f32 v[46:47], v[46:47], v[188:189] op_sel_hi:[1,0]
  v_pk_mul_f32 v[36:37], v[36:37], v[192:193] op_sel_hi:[1,0]
  v_pk_mul_f32 v[38:39], v[38:39], v[192:193] op_sel_hi:[1,0]
  v_pk_mul_f32 v[48:49], v[48:49], v[192:193] op_sel_hi:[1,0]
  v_pk_mul_f32 v[50:51], v[50:51], v[192:193] op_sel_hi:[1,0]
  v_cvt_pk_bf16_f32 v16, v28, v29
  v_cvt_pk_bf16_f32 v17, v30, v31
  v_cvt_pk_bf16_f32 v18, v40, v41
  v_cvt_pk_bf16_f32 v19, v42, v43
  buffer_store_dwordx4 v[16:19], v237, s[8:11], s34 offen offset:1024 sc1
  v_cvt_pk_bf16_f32 v20, v32, v33
  v_cvt_pk_bf16_f32 v21, v34, v35
  v_cvt_pk_bf16_f32 v22, v44, v45
  v_cvt_pk_bf16_f32 v23, v46, v47
  buffer_store_dwordx4 v[20:23], v238, s[8:11], s34 offen offset:1024 sc1
  v_cvt_pk_bf16_f32 v24, v36, v37
  v_cvt_pk_bf16_f32 v25, v38, v39
  v_cvt_pk_bf16_f32 v26, v48, v49
  v_cvt_pk_bf16_f32 v27, v50, v51
  buffer_store_dwordx4 v[24:27], v239, s[8:11], s34 offen offset:1024 sc1
  v_pk_mul_f32 v[52:53], v[52:53], v[184:185] op_sel_hi:[1,0]
  v_pk_mul_f32 v[54:55], v[54:55], v[184:185] op_sel_hi:[1,0]
  v_pk_mul_f32 v[64:65], v[64:65], v[184:185] op_sel_hi:[1,0]
  v_pk_mul_f32 v[66:67], v[66:67], v[184:185] op_sel_hi:[1,0]
  v_pk_mul_f32 v[56:57], v[56:57], v[188:189] op_sel_hi:[1,0]
  v_pk_mul_f32 v[58:59], v[58:59], v[188:189] op_sel_hi:[1,0]
  v_pk_mul_f32 v[68:69], v[68:69], v[188:189] op_sel_hi:[1,0]
  v_pk_mul_f32 v[70:71], v[70:71], v[188:189] op_sel_hi:[1,0]
  v_pk_mul_f32 v[60:61], v[60:61], v[192:193] op_sel_hi:[1,0]
  v_pk_mul_f32 v[62:63], v[62:63], v[192:193] op_sel_hi:[1,0]
  v_pk_mul_f32 v[72:73], v[72:73], v[192:193] op_sel_hi:[1,0]
  v_pk_mul_f32 v[74:75], v[74:75], v[192:193] op_sel_hi:[1,0]
  v_cvt_pk_bf16_f32 v28, v52, v53
  v_cvt_pk_bf16_f32 v29, v54, v55
  v_cvt_pk_bf16_f32 v30, v64, v65
  v_cvt_pk_bf16_f32 v31, v66, v67
  buffer_store_dwordx4 v[28:31], v237, s[8:11], s34 offen offset:2048 sc1
  v_cvt_pk_bf16_f32 v32, v56, v57
  v_cvt_pk_bf16_f32 v33, v58, v59
  v_cvt_pk_bf16_f32 v34, v68, v69
  v_cvt_pk_bf16_f32 v35, v70, v71
  buffer_store_dwordx4 v[32:35], v238, s[8:11], s34 offen offset:2048 sc1
  v_cvt_pk_bf16_f32 v36, v60, v61
  v_cvt_pk_bf16_f32 v37, v62, v63
  v_cvt_pk_bf16_f32 v38, v72, v73
  v_cvt_pk_bf16_f32 v39, v74, v75
  buffer_store_dwordx4 v[36:39], v239, s[8:11], s34 offen offset:2048 sc1
  v_pk_mul_f32 v[76:77], v[76:77], v[184:185] op_sel_hi:[1,0]
  v_pk_mul_f32 v[78:79], v[78:79], v[184:185] op_sel_hi:[1,0]
  v_pk_mul_f32 v[88:89], v[88:89], v[184:185] op_sel_hi:[1,0]
  v_pk_mul_f32 v[90:91], v[90:91], v[184:185] op_sel_hi:[1,0]
  v_pk_mul_f32 v[80:81], v[80:81], v[188:189] op_sel_hi:[1,0]
  v_pk_mul_f32 v[82:83], v[82:83], v[188:189] op_sel_hi:[1,0]
  v_pk_mul_f32 v[92:93], v[92:93], v[188:189] op_sel_hi:[1,0]
  v_pk_mul_f32 v[94:95], v[94:95], v[188:189] op_sel_hi:[1,0]
  v_pk_mul_f32 v[84:85], v[84:85], v[192:193] op_sel_hi:[1,0]
  v_pk_mul_f32 v[86:87], v[86:87], v[192:193] op_sel_hi:[1,0]
  v_pk_mul_f32 v[96:97], v[96:97], v[192:193] op_sel_hi:[1,0]
  v_pk_mul_f32 v[98:99], v[98:99], v[192:193] op_sel_hi:[1,0]
  v_cvt_pk_bf16_f32 v40, v76, v77
  v_cvt_pk_bf16_f32 v41, v78, v79
  v_cvt_pk_bf16_f32 v42, v88, v89
  v_cvt_pk_bf16_f32 v43, v90, v91
  buffer_store_dwordx4 v[40:43], v237, s[8:11], s34 offen offset:3072 sc1
  v_cvt_pk_bf16_f32 v44, v80, v81
  v_cvt_pk_bf16_f32 v45, v82, v83
  v_cvt_pk_bf16_f32 v46, v92, v93
  v_cvt_pk_bf16_f32 v47, v94, v95
  buffer_store_dwordx4 v[44:47], v238, s[8:11], s34 offen offset:3072 sc1
  v_cvt_pk_bf16_f32 v48, v84, v85
  v_cvt_pk_bf16_f32 v49, v86, v87
  v_cvt_pk_bf16_f32 v50, v96, v97
  v_cvt_pk_bf16_f32 v51, v98, v99
  buffer_store_dwordx4 v[48:51], v239, s[8:11], s34 offen offset:3072 sc1
  s_waitcnt vmcnt(12)
  v_cmp_ne_u32 vcc, v227, v228
  v_add_u32 v230, 1, v227
  s_and_b32 s25, vcc_lo, 7
  s_mov_b32 s48, 0
  s_call_b64 s[32:33], L_svc_standalone__gqa_block_cached__near_ridge_kernel
  s_barrier
  ds_read_b64_tr_b16 a[32:33], v241 offset:0
  ds_read_b64_tr_b16 a[34:35], v241 offset:5120
  ds_read_b64_tr_b16 a[36:37], v241 offset:10240
  ds_read_b64_tr_b16 a[38:39], v241 offset:15360
  ds_read_b64_tr_b16 a[40:41], v241 offset:20480
  ds_read_b64_tr_b16 a[42:43], v241 offset:25600
  ds_read_b64_tr_b16 a[44:45], v241 offset:30720
  ds_read_b64_tr_b16 a[46:47], v241 offset:35840
  ds_read_b64_tr_b16 a[48:49], v242 offset:0
  ds_read_b64_tr_b16 a[50:51], v242 offset:5120
  ds_read_b64_tr_b16 a[52:53], v242 offset:10240
  ds_read_b64_tr_b16 a[54:55], v242 offset:15360
  s_waitcnt lgkmcnt(10)
  v_mfma_f32_16x16x32_bf16 v[52:55], a[32:35], v[4:7], 0
  ds_read_b64_tr_b16 a[56:57], v242 offset:20480
  ds_read_b64_tr_b16 a[58:59], v242 offset:25600
  s_waitcnt lgkmcnt(10)
  v_mfma_f32_16x16x32_bf16 v[52:55], a[36:39], v[16:19], v[52:55]
  ds_read_b64_tr_b16 a[60:61], v242 offset:30720
  s_waitcnt lgkmcnt(9)
  v_mfma_f32_16x16x32_bf16 v[52:55], a[40:43], v[28:31], v[52:55]
  ds_read_b64_tr_b16 a[62:63], v242 offset:35840
  s_waitcnt lgkmcnt(8)
  v_mfma_f32_16x16x32_bf16 v[52:55], a[44:47], v[40:43], v[52:55]
  ds_read_b64_tr_b16 a[0:1], v241 offset:64
  ds_read_b64_tr_b16 a[2:3], v241 offset:5184
  v_mfma_f32_16x16x32_bf16 v[56:59], a[32:35], v[8:11], 0
  ds_read_b64_tr_b16 a[4:5], v241 offset:10304
  ds_read_b64_tr_b16 a[6:7], v241 offset:15424
  v_mfma_f32_16x16x32_bf16 v[56:59], a[36:39], v[20:23], v[56:59]
  ds_read_b64_tr_b16 a[8:9], v241 offset:20544
  ds_read_b64_tr_b16 a[10:11], v241 offset:25664
  v_mfma_f32_16x16x32_bf16 v[56:59], a[40:43], v[32:35], v[56:59]
  ds_read_b64_tr_b16 a[12:13], v241 offset:30784
  ds_read_b64_tr_b16 a[14:15], v241 offset:35904
  v_mfma_f32_16x16x32_bf16 v[56:59], a[44:47], v[44:47], v[56:59]
  v_mfma_f32_16x16x32_bf16 v[60:63], a[32:35], v[12:15], 0
  v_mfma_f32_16x16x32_bf16 v[60:63], a[36:39], v[24:27], v[60:63]
  ds_read_b64_tr_b16 a[16:17], v242 offset:64
  ds_read_b64_tr_b16 a[18:19], v242 offset:5184
  v_mfma_f32_16x16x32_bf16 v[60:63], a[40:43], v[36:39], v[60:63]
  v_mfma_f32_16x16x32_bf16 v[60:63], a[44:47], v[48:51], v[60:63]
  s_getreg_b32 s43, hwreg(HW_REG_IB_STS)
  s_and_b32 s43, s43, 0xc0000f
  s_waitcnt lgkmcnt(10)
  v_mfma_f32_16x16x32_bf16 v[64:67], a[48:51], v[4:7], 0
  s_or_b32 s43, s43, s92
  s_cbranch_scc0 L_hso12_standalone__gqa_block_cached__near_ridge_kernel
L_hro12_standalone__gqa_block_cached__near_ridge_kernel:
  v_mfma_f32_16x16x32_bf16 v[64:67], a[52:55], v[16:19], v[64:67]
  ds_read_b64_tr_b16 a[20:21], v242 offset:10304
  ds_read_b64_tr_b16 a[22:23], v242 offset:15424
  v_mfma_f32_16x16x32_bf16 v[64:67], a[56:59], v[28:31], v[64:67]
  v_mfma_f32_16x16x32_bf16 v[64:67], a[60:63], v[40:43], v[64:67]
  ds_read_b64_tr_b16 a[24:25], v242 offset:20544
  ds_read_b64_tr_b16 a[26:27], v242 offset:25664
  v_mfma_f32_16x16x32_bf16 v[68:71], a[48:51], v[8:11], 0
  v_mfma_f32_16x16x32_bf16 v[68:71], a[52:55], v[20:23], v[68:71]
  v_mfma_f32_16x16x32_bf16 v[68:71], a[56:59], v[32:35], v[68:71]
  ds_read_b64_tr_b16 a[28:29], v242 offset:30784
  ds_read_b64_tr_b16 a[30:31], v242 offset:35904
  v_mfma_f32_16x16x32_bf16 v[68:71], a[60:63], v[44:47], v[68:71]
  v_mfma_f32_16x16x32_bf16 v[72:75], a[48:51], v[12:15], 0
  v_mfma_f32_16x16x32_bf16 v[72:75], a[52:55], v[24:27], v[72:75]
  ds_read_b64_tr_b16 a[32:33], v241 offset:128
  ds_read_b64_tr_b16 a[34:35], v241 offset:5248
  v_mfma_f32_16x16x32_bf16 v[72:75], a[56:59], v[36:39], v[72:75]
  v_mfma_f32_16x16x32_bf16 v[72:75], a[60:63], v[48:51], v[72:75]
  s_waitcnt lgkmcnt(10)
  v_mfma_f32_16x16x32_bf16 v[76:79], a[0:3], v[4:7], 0
  ds_read_b64_tr_b16 a[36:37], v241 offset:10368
  ds_read_b64_tr_b16 a[38:39], v241 offset:15488
  v_mfma_f32_16x16x32_bf16 v[76:79], a[4:7], v[16:19], v[76:79]
  v_mfma_f32_16x16x32_bf16 v[76:79], a[8:11], v[28:31], v[76:79]
  v_mfma_f32_16x16x32_bf16 v[76:79], a[12:15], v[40:43], v[76:79]
  ds_read_b64_tr_b16 a[40:41], v241 offset:20608
  ds_read_b64_tr_b16 a[42:43], v241 offset:25728
  v_mfma_f32_16x16x32_bf16 v[80:83], a[0:3], v[8:11], 0
  v_mfma_f32_16x16x32_bf16 v[80:83], a[4:7], v[20:23], v[80:83]
  s_getreg_b32 s43, hwreg(HW_REG_IB_STS)
  s_and_b32 s43, s43, 0xc0000f
  v_mfma_f32_16x16x32_bf16 v[80:83], a[8:11], v[32:35], v[80:83]
  s_or_b32 s43, s43, s92
  s_cbranch_scc0 L_hso30_standalone__gqa_block_cached__near_ridge_kernel
L_hro30_standalone__gqa_block_cached__near_ridge_kernel:
  v_mfma_f32_16x16x32_bf16 v[80:83], a[12:15], v[44:47], v[80:83]
  ds_read_b64_tr_b16 a[44:45], v241 offset:30848
  ds_read_b64_tr_b16 a[46:47], v241 offset:35968
  v_mfma_f32_16x16x32_bf16 v[84:87], a[0:3], v[12:15], 0
  v_mfma_f32_16x16x32_bf16 v[84:87], a[4:7], v[24:27], v[84:87]
  ds_read_b64_tr_b16 a[48:49], v242 offset:128
  ds_read_b64_tr_b16 a[50:51], v242 offset:5248
  v_mfma_f32_16x16x32_bf16 v[84:87], a[8:11], v[36:39], v[84:87]
  v_mfma_f32_16x16x32_bf16 v[84:87], a[12:15], v[48:51], v[84:87]
  s_waitcnt lgkmcnt(10)
  v_mfma_f32_16x16x32_bf16 v[88:91], a[16:19], v[4:7], 0
  ds_read_b64_tr_b16 a[52:53], v242 offset:10368
  ds_read_b64_tr_b16 a[54:55], v242 offset:15488
  v_mfma_f32_16x16x32_bf16 v[88:91], a[20:23], v[16:19], v[88:91]
  v_mfma_f32_16x16x32_bf16 v[88:91], a[24:27], v[28:31], v[88:91]
  v_mfma_f32_16x16x32_bf16 v[88:91], a[28:31], v[40:43], v[88:91]
  ds_read_b64_tr_b16 a[56:57], v242 offset:20608
  ds_read_b64_tr_b16 a[58:59], v242 offset:25728
  v_mfma_f32_16x16x32_bf16 v[92:95], a[16:19], v[8:11], 0
  v_mfma_f32_16x16x32_bf16 v[92:95], a[20:23], v[20:23], v[92:95]
  v_mfma_f32_16x16x32_bf16 v[92:95], a[24:27], v[32:35], v[92:95]
  ds_read_b64_tr_b16 a[60:61], v242 offset:30848
  ds_read_b64_tr_b16 a[62:63], v242 offset:35968
  v_mfma_f32_16x16x32_bf16 v[92:95], a[28:31], v[44:47], v[92:95]
  v_mfma_f32_16x16x32_bf16 v[96:99], a[16:19], v[12:15], 0
  v_mfma_f32_16x16x32_bf16 v[96:99], a[20:23], v[24:27], v[96:99]
  ds_read_b64_tr_b16 a[0:1], v241 offset:192
  ds_read_b64_tr_b16 a[2:3], v241 offset:5312
  v_mfma_f32_16x16x32_bf16 v[96:99], a[24:27], v[36:39], v[96:99]
  v_mfma_f32_16x16x32_bf16 v[96:99], a[28:31], v[48:51], v[96:99]
  s_getreg_b32 s43, hwreg(HW_REG_IB_STS)
  s_and_b32 s43, s43, 0xc0000f
  s_waitcnt lgkmcnt(10)
  v_mfma_f32_16x16x32_bf16 v[100:103], a[32:35], v[4:7], 0
  s_or_b32 s43, s43, s92
  s_cbranch_scc0 L_hso48_standalone__gqa_block_cached__near_ridge_kernel
L_hro48_standalone__gqa_block_cached__near_ridge_kernel:
  v_mfma_f32_16x16x32_bf16 v[100:103], a[36:39], v[16:19], v[100:103]
  ds_read_b64_tr_b16 a[4:5], v241 offset:10432
  ds_read_b64_tr_b16 a[6:7], v241 offset:15552
  v_mfma_f32_16x16x32_bf16 v[100:103], a[40:43], v[28:31], v[100:103]
  v_mfma_f32_16x16x32_bf16 v[100:103], a[44:47], v[40:43], v[100:103]
  ds_read_b64_tr_b16 a[8:9], v241 offset:20672
  ds_read_b64_tr_b16 a[10:11], v241 offset:25792
  v_mfma_f32_16x16x32_bf16 v[104:107], a[32:35], v[8:11], 0
  v_mfma_f32_16x16x32_bf16 v[104:107], a[36:39], v[20:23], v[104:107]
  v_mfma_f32_16x16x32_bf16 v[104:107], a[40:43], v[32:35], v[104:107]
  ds_read_b64_tr_b16 a[12:13], v241 offset:30912
  ds_read_b64_tr_b16 a[14:15], v241 offset:36032
  v_mfma_f32_16x16x32_bf16 v[104:107], a[44:47], v[44:47], v[104:107]
  v_mfma_f32_16x16x32_bf16 v[108:111], a[32:35], v[12:15], 0
  v_mfma_f32_16x16x32_bf16 v[108:111], a[36:39], v[24:27], v[108:111]
  ds_read_b64_tr_b16 a[16:17], v242 offset:192
  ds_read_b64_tr_b16 a[18:19], v242 offset:5312
  v_mfma_f32_16x16x32_bf16 v[108:111], a[40:43], v[36:39], v[108:111]
  v_mfma_f32_16x16x32_bf16 v[108:111], a[44:47], v[48:51], v[108:111]
  s_waitcnt lgkmcnt(10)
  v_mfma_f32_16x16x32_bf16 v[112:115], a[48:51], v[4:7], 0
  ds_read_b64_tr_b16 a[20:21], v242 offset:10432
  ds_read_b64_tr_b16 a[22:23], v242 offset:15552
  v_mfma_f32_16x16x32_bf16 v[112:115], a[52:55], v[16:19], v[112:115]
  v_mfma_f32_16x16x32_bf16 v[112:115], a[56:59], v[28:31], v[112:115]
  v_mfma_f32_16x16x32_bf16 v[112:115], a[60:63], v[40:43], v[112:115]
  ds_read_b64_tr_b16 a[24:25], v242 offset:20672
  ds_read_b64_tr_b16 a[26:27], v242 offset:25792
  v_mfma_f32_16x16x32_bf16 v[116:119], a[48:51], v[8:11], 0
  v_mfma_f32_16x16x32_bf16 v[116:119], a[52:55], v[20:23], v[116:119]
  s_getreg_b32 s43, hwreg(HW_REG_IB_STS)
  s_and_b32 s43, s43, 0xc0000f
  v_mfma_f32_16x16x32_bf16 v[116:119], a[56:59], v[32:35], v[116:119]
  s_or_b32 s43, s43, s92
  s_cbranch_scc0 L_hso66_standalone__gqa_block_cached__near_ridge_kernel
L_hro66_standalone__gqa_block_cached__near_ridge_kernel:
  v_mfma_f32_16x16x32_bf16 v[116:119], a[60:63], v[44:47], v[116:119]
  ds_read_b64_tr_b16 a[28:29], v242 offset:30912
  ds_read_b64_tr_b16 a[30:31], v242 offset:36032
  v_mfma_f32_16x16x32_bf16 v[120:123], a[48:51], v[12:15], 0
  v_mfma_f32_16x16x32_bf16 v[120:123], a[52:55], v[24:27], v[120:123]
  ds_read_b64_tr_b16 a[32:33], v241 offset:256
  ds_read_b64_tr_b16 a[34:35], v241 offset:5376
  v_mfma_f32_16x16x32_bf16 v[120:123], a[56:59], v[36:39], v[120:123]
  v_mfma_f32_16x16x32_bf16 v[120:123], a[60:63], v[48:51], v[120:123]
  s_waitcnt lgkmcnt(10)
  v_mfma_f32_16x16x32_bf16 v[124:127], a[0:3], v[4:7], 0
  ds_read_b64_tr_b16 a[36:37], v241 offset:10496
  ds_read_b64_tr_b16 a[38:39], v241 offset:15616
  v_mfma_f32_16x16x32_bf16 v[124:127], a[4:7], v[16:19], v[124:127]
  v_mfma_f32_16x16x32_bf16 v[124:127], a[8:11], v[28:31], v[124:127]
  v_mfma_f32_16x16x32_bf16 v[124:127], a[12:15], v[40:43], v[124:127]
  ds_read_b64_tr_b16 a[40:41], v241 offset:20736
  ds_read_b64_tr_b16 a[42:43], v241 offset:25856
  v_mfma_f32_16x16x32_bf16 v[128:131], a[0:3], v[8:11], 0
  v_mfma_f32_16x16x32_bf16 v[128:131], a[4:7], v[20:23], v[128:131]
  v_mfma_f32_16x16x32_bf16 v[128:131], a[8:11], v[32:35], v[128:131]
  ds_read_b64_tr_b16 a[44:45], v241 offset:30976
  ds_read_b64_tr_b16 a[46:47], v241 offset:36096
  v_mfma_f32_16x16x32_bf16 v[128:131], a[12:15], v[44:47], v[128:131]
  v_mfma_f32_16x16x32_bf16 v[132:135], a[0:3], v[12:15], 0
  v_mfma_f32_16x16x32_bf16 v[132:135], a[4:7], v[24:27], v[132:135]
  ds_read_b64_tr_b16 a[48:49], v242 offset:256
  ds_read_b64_tr_b16 a[50:51], v242 offset:5376
  v_mfma_f32_16x16x32_bf16 v[132:135], a[8:11], v[36:39], v[132:135]
  v_mfma_f32_16x16x32_bf16 v[132:135], a[12:15], v[48:51], v[132:135]
  s_getreg_b32 s43, hwreg(HW_REG_IB_STS)
  s_and_b32 s43, s43, 0xc0000f
  s_waitcnt lgkmcnt(10)
  v_mfma_f32_16x16x32_bf16 v[136:139], a[16:19], v[4:7], 0
  s_or_b32 s43, s43, s92
  s_cbranch_scc0 L_hso84_standalone__gqa_block_cached__near_ridge_kernel
L_hro84_standalone__gqa_block_cached__near_ridge_kernel:
  v_mfma_f32_16x16x32_bf16 v[136:139], a[20:23], v[16:19], v[136:139]
  ds_read_b64_tr_b16 a[52:53], v242 offset:10496
  ds_read_b64_tr_b16 a[54:55], v242 offset:15616
  v_mfma_f32_16x16x32_bf16 v[136:139], a[24:27], v[28:31], v[136:139]
  v_mfma_f32_16x16x32_bf16 v[136:139], a[28:31], v[40:43], v[136:139]
  ds_read_b64_tr_b16 a[56:57], v242 offset:20736
  ds_read_b64_tr_b16 a[58:59], v242 offset:25856
  v_mfma_f32_16x16x32_bf16 v[140:143], a[16:19], v[8:11], 0
  v_mfma_f32_16x16x32_bf16 v[140:143], a[20:23], v[20:23], v[140:143]
  v_mfma_f32_16x16x32_bf16 v[140:143], a[24:27], v[32:35], v[140:143]
  ds_read_b64_tr_b16 a[60:61], v242 offset:30976
  ds_read_b64_tr_b16 a[62:63], v242 offset:36096
  v_mfma_f32_16x16x32_bf16 v[140:143], a[28:31], v[44:47], v[140:143]
  v_mfma_f32_16x16x32_bf16 v[144:147], a[16:19], v[12:15], 0
  v_mfma_f32_16x16x32_bf16 v[144:147], a[20:23], v[24:27], v[144:147]
  v_mfma_f32_16x16x32_bf16 v[144:147], a[24:27], v[36:39], v[144:147]
  v_mfma_f32_16x16x32_bf16 v[144:147], a[28:31], v[48:51], v[144:147]
  s_waitcnt lgkmcnt(8)
  v_mfma_f32_16x16x32_bf16 v[148:151], a[32:35], v[4:7], 0
  v_mfma_f32_16x16x32_bf16 v[148:151], a[36:39], v[16:19], v[148:151]
  v_mfma_f32_16x16x32_bf16 v[148:151], a[40:43], v[28:31], v[148:151]
  v_mfma_f32_16x16x32_bf16 v[148:151], a[44:47], v[40:43], v[148:151]
  v_mfma_f32_16x16x32_bf16 v[152:155], a[32:35], v[8:11], 0
  v_mfma_f32_16x16x32_bf16 v[152:155], a[36:39], v[20:23], v[152:155]
  s_getreg_b32 s43, hwreg(HW_REG_IB_STS)
  s_and_b32 s43, s43, 0xc0000f
  v_mfma_f32_16x16x32_bf16 v[152:155], a[40:43], v[32:35], v[152:155]
  s_or_b32 s43, s43, s92
  s_cbranch_scc0 L_hso102_standalone__gqa_block_cached__near_ridge_kernel
L_hro102_standalone__gqa_block_cached__near_ridge_kernel:
  v_mfma_f32_16x16x32_bf16 v[152:155], a[44:47], v[44:47], v[152:155]
  v_mfma_f32_16x16x32_bf16 v[156:159], a[32:35], v[12:15], 0
  v_mfma_f32_16x16x32_bf16 v[156:159], a[36:39], v[24:27], v[156:159]
  v_mfma_f32_16x16x32_bf16 v[156:159], a[40:43], v[36:39], v[156:159]
  v_mfma_f32_16x16x32_bf16 v[156:159], a[44:47], v[48:51], v[156:159]
  s_waitcnt lgkmcnt(0)
  v_mfma_f32_16x16x32_bf16 v[160:163], a[48:51], v[4:7], 0
  v_mfma_f32_16x16x32_bf16 v[160:163], a[52:55], v[16:19], v[160:163]
  v_mfma_f32_16x16x32_bf16 v[160:163], a[56:59], v[28:31], v[160:163]
  v_mfma_f32_16x16x32_bf16 v[160:163], a[60:63], v[40:43], v[160:163]
  v_mfma_f32_16x16x32_bf16 v[164:167], a[48:51], v[8:11], 0
  v_mfma_f32_16x16x32_bf16 v[164:167], a[52:55], v[20:23], v[164:167]
  s_getreg_b32 s43, hwreg(HW_REG_IB_STS)
  s_and_b32 s43, s43, 0xc0000f
  v_mfma_f32_16x16x32_bf16 v[164:167], a[56:59], v[32:35], v[164:167]
  s_or_b32 s43, s43, s92
  s_cbranch_scc0 L_hso114_standalone__gqa_block_cached__near_ridge_kernel
L_hro114_standalone__gqa_block_cached__near_ridge_kernel:
  v_mfma_f32_16x16x32_bf16 v[164:167], a[60:63], v[44:47], v[164:167]
  v_mfma_f32_16x16x32_bf16 v[168:171], a[48:51], v[12:15], 0
  v_mfma_f32_16x16x32_bf16 v[168:171], a[52:55], v[24:27], v[168:171]
  v_mfma_f32_16x16x32_bf16 v[168:171], a[56:59], v[36:39], v[168:171]
  v_mfma_f32_16x16x32_bf16 v[168:171], a[60:63], v[48:51], v[168:171]
  s_barrier
  s_cmp_ge_u32 s35, 1
  s_cbranch_scc0 L_w1_standalone__gqa_block_cached__near_ridge_kernel
L_wr1_standalone__gqa_block_cached__near_ridge_kernel:
  ds_read_b64_tr_b16 a[0:1], v218 offset:0
  ds_read_b64_tr_b16 a[2:3], v218 offset:5120
  ds_read_b64_tr_b16 a[4:5], v218 offset:10240
  ds_read_b64_tr_b16 a[6:7], v218 offset:15360
  ds_read_b64_tr_b16 a[8:9], v218 offset:20480
  ds_read_b64_tr_b16 a[10:11], v218 offset:25600
  ds_read_b64_tr_b16 a[12:13], v218 offset:30720
  ds_read_b64_tr_b16 a[14:15], v218 offset:35840
  ds_read_b64_tr_b16 a[16:17], v219 offset:0
  ds_read_b64_tr_b16 a[18:19], v219 offset:5120
  ds_read_b64_tr_b16 a[20:21], v219 offset:10240
  ds_read_b64_tr_b16 a[22:23], v219 offset:15360
  s_waitcnt lgkmcnt(10)
  v_mfma_f32_16x16x32_bf16 v[52:55], a[0:3], a[64:67], v[52:55]
  ds_read_b64_tr_b16 a[24:25], v219 offset:20480
  ds_read_b64_tr_b16 a[26:27], v219 offset:25600
  s_waitcnt lgkmcnt(10)
  v_mfma_f32_16x16x32_bf16 v[52:55], a[4:7], a[68:71], v[52:55]
  ds_read_b64_tr_b16 a[28:29], v219 offset:30720
  s_waitcnt lgkmcnt(9)
  v_mfma_f32_16x16x32_bf16 v[52:55], a[8:11], a[72:75], v[52:55]
  ds_read_b64_tr_b16 a[30:31], v219 offset:35840
  s_waitcnt lgkmcnt(8)
  v_mfma_f32_16x16x32_bf16 v[52:55], a[12:15], a[76:79], v[52:55]
  ds_read_b64_tr_b16 a[32:33], v218 offset:64
  ds_read_b64_tr_b16 a[34:35], v218 offset:5184
  v_mfma_f32_16x16x32_bf16 v[56:59], a[0:3], a[80:83], v[56:59]
  ds_read_b64_tr_b16 a[36:37], v218 offset:10304
  ds_read_b64_tr_b16 a[38:39], v218 offset:15424
  v_mfma_f32_16x16x32_bf16 v[56:59], a[4:7], a[84:87], v[56:59]
  ds_read_b64_tr_b16 a[40:41], v218 offset:20544
  ds_read_b64_tr_b16 a[42:43], v218 offset:25664
  v_mfma_f32_16x16x32_bf16 v[56:59], a[8:11], a[88:91], v[56:59]
  ds_read_b64_tr_b16 a[44:45], v218 offset:30784
  ds_read_b64_tr_b16 a[46:47], v218 offset:35904
  v_mfma_f32_16x16x32_bf16 v[56:59], a[12:15], a[92:95], v[56:59]
  v_mfma_f32_16x16x32_bf16 v[60:63], a[0:3], a[96:99], v[60:63]
  v_mfma_f32_16x16x32_bf16 v[60:63], a[4:7], a[100:103], v[60:63]
  ds_read_b64_tr_b16 a[48:49], v219 offset:64
  ds_read_b64_tr_b16 a[50:51], v219 offset:5184
  v_mfma_f32_16x16x32_bf16 v[60:63], a[8:11], a[104:107], v[60:63]
  v_mfma_f32_16x16x32_bf16 v[60:63], a[12:15], a[108:111], v[60:63]
  s_getreg_b32 s43, hwreg(HW_REG_IB_STS)
  s_and_b32 s43, s43, 0xc0000f
  s_waitcnt lgkmcnt(10)
  v_mfma_f32_16x16x32_bf16 v[64:67], a[16:19], a[64:67], v[64:67]
  s_or_b32 s43, s43, s92
  s_cbranch_scc0 L_hsa12_standalone__gqa_block_cached__near_ridge_kernel
L_hra12_standalone__gqa_block_cached__near_ridge_kernel:
  v_mfma_f32_16x16x32_bf16 v[64:67], a[20:23], a[68:71], v[64:67]
  ds_read_b64_tr_b16 a[52:53], v219 offset:10304
  ds_read_b64_tr_b16 a[54:55], v219 offset:15424
  v_mfma_f32_16x16x32_bf16 v[64:67], a[24:27], a[72:75], v[64:67]
  v_mfma_f32_16x16x32_bf16 v[64:67], a[28:31], a[76:79], v[64:67]
  ds_read_b64_tr_b16 a[56:57], v219 offset:20544
  ds_read_b64_tr_b16 a[58:59], v219 offset:25664
  v_mfma_f32_16x16x32_bf16 v[68:71], a[16:19], a[80:83], v[68:71]
  v_mfma_f32_16x16x32_bf16 v[68:71], a[20:23], a[84:87], v[68:71]
  v_mfma_f32_16x16x32_bf16 v[68:71], a[24:27], a[88:91], v[68:71]
  ds_read_b64_tr_b16 a[60:61], v219 offset:30784
  ds_read_b64_tr_b16 a[62:63], v219 offset:35904
  v_mfma_f32_16x16x32_bf16 v[68:71], a[28:31], a[92:95], v[68:71]
  v_mfma_f32_16x16x32_bf16 v[72:75], a[16:19], a[96:99], v[72:75]
  v_mfma_f32_16x16x32_bf16 v[72:75], a[20:23], a[100:103], v[72:75]
  ds_read_b64_tr_b16 a[0:1], v218 offset:128
  ds_read_b64_tr_b16 a[2:3], v218 offset:5248
  v_mfma_f32_16x16x32_bf16 v[72:75], a[24:27], a[104:107], v[72:75]
  v_mfma_f32_16x16x32_bf16 v[72:75], a[28:31], a[108:111], v[72:75]
  s_waitcnt lgkmcnt(10)
  v_mfma_f32_16x16x32_bf16 v[76:79], a[32:35], a[64:67], v[76:79]
  ds_read_b64_tr_b16 a[4:5], v218 offset:10368
  ds_read_b64_tr_b16 a[6:7], v218 offset:15488
  v_mfma_f32_16x16x32_bf16 v[76:79], a[36:39], a[68:71], v[76:79]
  v_mfma_f32_16x16x32_bf16 v[76:79], a[40:43], a[72:75], v[76:79]
  v_mfma_f32_16x16x32_bf16 v[76:79], a[44:47], a[76:79], v[76:79]
  ds_read_b64_tr_b16 a[8:9], v218 offset:20608
  ds_read_b64_tr_b16 a[10:11], v218 offset:25728
  v_mfma_f32_16x16x32_bf16 v[80:83], a[32:35], a[80:83], v[80:83]
  v_mfma_f32_16x16x32_bf16 v[80:83], a[36:39], a[84:87], v[80:83]
  s_getreg_b32 s43, hwreg(HW_REG_IB_STS)
  s_and_b32 s43, s43, 0xc0000f
  v_mfma_f32_16x16x32_bf16 v[80:83], a[40:43], a[88:91], v[80:83]
  s_or_b32 s43, s43, s92
  s_cbranch_scc0 L_hsa30_standalone__gqa_block_cached__near_ridge_kernel
L_hra30_standalone__gqa_block_cached__near_ridge_kernel:
  v_mfma_f32_16x16x32_bf16 v[80:83], a[44:47], a[92:95], v[80:83]
  ds_read_b64_tr_b16 a[12:13], v218 offset:30848
  ds_read_b64_tr_b16 a[14:15], v218 offset:35968
  v_mfma_f32_16x16x32_bf16 v[84:87], a[32:35], a[96:99], v[84:87]
  v_mfma_f32_16x16x32_bf16 v[84:87], a[36:39], a[100:103], v[84:87]
  ds_read_b64_tr_b16 a[16:17], v219 offset:128
  ds_read_b64_tr_b16 a[18:19], v219 offset:5248
  v_mfma_f32_16x16x32_bf16 v[84:87], a[40:43], a[104:107], v[84:87]
  v_mfma_f32_16x16x32_bf16 v[84:87], a[44:47], a[108:111], v[84:87]
  s_waitcnt lgkmcnt(10)
  v_mfma_f32_16x16x32_bf16 v[88:91], a[48:51], a[64:67], v[88:91]
  ds_read_b64_tr_b16 a[20:21], v219 offset:10368
  ds_read_b64_tr_b16 a[22:23], v219 offset:15488
  v_mfma_f32_16x16x32_bf16 v[88:91], a[52:55], a[68:71], v[88:91]
  v_mfma_f32_16x16x32_bf16 v[88:91], a[56:59], a[72:75], v[88:91]
  v_mfma_f32_16x16x32_bf16 v[88:91], a[60:63], a[76:79], v[88:91]
  ds_read_b64_tr_b16 a[24:25], v219 offset:20608
  ds_read_b64_tr_b16 a[26:27], v219 offset:25728
  v_mfma_f32_16x16x32_bf16 v[92:95], a[48:51], a[80:83], v[92:95]
  v_mfma_f32_16x16x32_bf16 v[92:95], a[52:55], a[84:87], v[92:95]
  v_mfma_f32_16x16x32_bf16 v[92:95], a[56:59], a[88:91], v[92:95]
  ds_read_b64_tr_b16 a[28:29], v219 offset:30848
  ds_read_b64_tr_b16 a[30:31], v219 offset:35968
  v_mfma_f32_16x16x32_bf16 v[92:95], a[60:63], a[92:95], v[92:95]
  v_mfma_f32_16x16x32_bf16 v[96:99], a[48:51], a[96:99], v[96:99]
  v_mfma_f32_16x16x32_bf16 v[96:99], a[52:55], a[100:103], v[96:99]
  ds_read_b64_tr_b16 a[32:33], v218 offset:192
  ds_read_b64_tr_b16 a[34:35], v218 offset:5312
  v_mfma_f32_16x16x32_bf16 v[96:99], a[56:59], a[104:107], v[96:99]
  v_mfma_f32_16x16x32_bf16 v[96:99], a[60:63], a[108:111], v[96:99]
  s_getreg_b32 s43, hwreg(HW_REG_IB_STS)
  s_and_b32 s43, s43, 0xc0000f
  s_waitcnt lgkmcnt(10)
  v_mfma_f32_16x16x32_bf16 v[100:103], a[0:3], a[64:67], v[100:103]
  s_or_b32 s43, s43, s92
  s_cbranch_scc0 L_hsa48_standalone__gqa_block_cached__near_ridge_kernel
L_hra48_standalone__gqa_block_cached__near_ridge_kernel:
  v_mfma_f32_16x16x32_bf16 v[100:103], a[4:7], a[68:71], v[100:103]
  ds_read_b64_tr_b16 a[36:37], v218 offset:10432
  ds_read_b64_tr_b16 a[38:39], v218 offset:15552
  v_mfma_f32_16x16x32_bf16 v[100:103], a[8:11], a[72:75], v[100:103]
  v_mfma_f32_16x16x32_bf16 v[100:103], a[12:15], a[76:79], v[100:103]
  ds_read_b64_tr_b16 a[40:41], v218 offset:20672
  ds_read_b64_tr_b16 a[42:43], v218 offset:25792
  v_mfma_f32_16x16x32_bf16 v[104:107], a[0:3], a[80:83], v[104:107]
  v_mfma_f32_16x16x32_bf16 v[104:107], a[4:7], a[84:87], v[104:107]
  v_mfma_f32_16x16x32_bf16 v[104:107], a[8:11], a[88:91], v[104:107]
  ds_read_b64_tr_b16 a[44:45], v218 offset:30912
  ds_read_b64_tr_b16 a[46:47], v218 offset:36032
  v_mfma_f32_16x16x32_bf16 v[104:107], a[12:15], a[92:95], v[104:107]
  v_mfma_f32_16x16x32_bf16 v[108:111], a[0:3], a[96:99], v[108:111]
  v_mfma_f32_16x16x32_bf16 v[108:111], a[4:7], a[100:103], v[108:111]
  ds_read_b64_tr_b16 a[48:49], v219 offset:192
  ds_read_b64_tr_b16 a[50:51], v219 offset:5312
  v_mfma_f32_16x16x32_bf16 v[108:111], a[8:11], a[104:107], v[108:111]
  v_mfma_f32_16x16x32_bf16 v[108:111], a[12:15], a[108:111], v[108:111]
  s_waitcnt lgkmcnt(10)
  v_mfma_f32_16x16x32_bf16 v[112:115], a[16:19], a[64:67], v[112:115]
  ds_read_b64_tr_b16 a[52:53], v219 offset:10432
  ds_read_b64_tr_b16 a[54:55], v219 offset:15552
  v_mfma_f32_16x16x32_bf16 v[112:115], a[20:23], a[68:71], v[112:115]
  v_mfma_f32_16x16x32_bf16 v[112:115], a[24:27], a[72:75], v[112:115]
  v_mfma_f32_16x16x32_bf16 v[112:115], a[28:31], a[76:79], v[112:115]
  ds_read_b64_tr_b16 a[56:57], v219 offset:20672
  ds_read_b64_tr_b16 a[58:59], v219 offset:25792
  v_mfma_f32_16x16x32_bf16 v[116:119], a[16:19], a[80:83], v[116:119]
  v_mfma_f32_16x16x32_bf16 v[116:119], a[20:23], a[84:87], v[116:119]
  s_getreg_b32 s43, hwreg(HW_REG_IB_STS)
  s_and_b32 s43, s43, 0xc0000f
  v_mfma_f32_16x16x32_bf16 v[116:119], a[24:27], a[88:91], v[116:119]
  s_or_b32 s43, s43, s92
  s_cbranch_scc0 L_hsa66_standalone__gqa_block_cached__near_ridge_kernel
L_hra66_standalone__gqa_block_cached__near_ridge_kernel:
  v_mfma_f32_16x16x32_bf16 v[116:119], a[28:31], a[92:95], v[116:119]
  ds_read_b64_tr_b16 a[60:61], v219 offset:30912
  ds_read_b64_tr_b16 a[62:63], v219 offset:36032
  v_mfma_f32_16x16x32_bf16 v[120:123], a[16:19], a[96:99], v[120:123]
  v_mfma_f32_16x16x32_bf16 v[120:123], a[20:23], a[100:103], v[120:123]
  ds_read_b64_tr_b16 a[0:1], v218 offset:256
  ds_read_b64_tr_b16 a[2:3], v218 offset:5376
  v_mfma_f32_16x16x32_bf16 v[120:123], a[24:27], a[104:107], v[120:123]
  v_mfma_f32_16x16x32_bf16 v[120:123], a[28:31], a[108:111], v[120:123]
  s_waitcnt lgkmcnt(10)
  v_mfma_f32_16x16x32_bf16 v[124:127], a[32:35], a[64:67], v[124:127]
  ds_read_b64_tr_b16 a[4:5], v218 offset:10496
  ds_read_b64_tr_b16 a[6:7], v218 offset:15616
  v_mfma_f32_16x16x32_bf16 v[124:127], a[36:39], a[68:71], v[124:127]
  v_mfma_f32_16x16x32_bf16 v[124:127], a[40:43], a[72:75], v[124:127]
  v_mfma_f32_16x16x32_bf16 v[124:127], a[44:47], a[76:79], v[124:127]
  ds_read_b64_tr_b16 a[8:9], v218 offset:20736
  ds_read_b64_tr_b16 a[10:11], v218 offset:25856
  v_mfma_f32_16x16x32_bf16 v[128:131], a[32:35], a[80:83], v[128:131]
  v_mfma_f32_16x16x32_bf16 v[128:131], a[36:39], a[84:87], v[128:131]
  v_mfma_f32_16x16x32_bf16 v[128:131], a[40:43], a[88:91], v[128:131]
  ds_read_b64_tr_b16 a[12:13], v218 offset:30976
  ds_read_b64_tr_b16 a[14:15], v218 offset:36096
  v_mfma_f32_16x16x32_bf16 v[128:131], a[44:47], a[92:95], v[128:131]
  v_mfma_f32_16x16x32_bf16 v[132:135], a[32:35], a[96:99], v[132:135]
  v_mfma_f32_16x16x32_bf16 v[132:135], a[36:39], a[100:103], v[132:135]
  ds_read_b64_tr_b16 a[16:17], v219 offset:256
  ds_read_b64_tr_b16 a[18:19], v219 offset:5376
  v_mfma_f32_16x16x32_bf16 v[132:135], a[40:43], a[104:107], v[132:135]
  v_mfma_f32_16x16x32_bf16 v[132:135], a[44:47], a[108:111], v[132:135]
  s_getreg_b32 s43, hwreg(HW_REG_IB_STS)
  s_and_b32 s43, s43, 0xc0000f
  s_waitcnt lgkmcnt(10)
  v_mfma_f32_16x16x32_bf16 v[136:139], a[48:51], a[64:67], v[136:139]
  s_or_b32 s43, s43, s92
  s_cbranch_scc0 L_hsa84_standalone__gqa_block_cached__near_ridge_kernel
L_hra84_standalone__gqa_block_cached__near_ridge_kernel:
  v_mfma_f32_16x16x32_bf16 v[136:139], a[52:55], a[68:71], v[136:139]
  ds_read_b64_tr_b16 a[20:21], v219 offset:10496
  ds_read_b64_tr_b16 a[22:23], v219 offset:15616
  v_mfma_f32_16x16x32_bf16 v[136:139], a[56:59], a[72:75], v[136:139]
  v_mfma_f32_16x16x32_bf16 v[136:139], a[60:63], a[76:79], v[136:139]
  ds_read_b64_tr_b16 a[24:25], v219 offset:20736
  ds_read_b64_tr_b16 a[26:27], v219 offset:25856
  v_mfma_f32_16x16x32_bf16 v[140:143], a[48:51], a[80:83], v[140:143]
  v_mfma_f32_16x16x32_bf16 v[140:143], a[52:55], a[84:87], v[140:143]
  v_mfma_f32_16x16x32_bf16 v[140:143], a[56:59], a[88:91], v[140:143]
  ds_read_b64_tr_b16 a[28:29], v219 offset:30976
  ds_read_b64_tr_b16 a[30:31], v219 offset:36096
  v_mfma_f32_16x16x32_bf16 v[140:143], a[60:63], a[92:95], v[140:143]
  v_mfma_f32_16x16x32_bf16 v[144:147], a[48:51], a[96:99], v[144:147]
  v_mfma_f32_16x16x32_bf16 v[144:147], a[52:55], a[100:103], v[144:147]
  v_mfma_f32_16x16x32_bf16 v[144:147], a[56:59], a[104:107], v[144:147]
  v_mfma_f32_16x16x32_bf16 v[144:147], a[60:63], a[108:111], v[144:147]
  s_waitcnt lgkmcnt(8)
  v_mfma_f32_16x16x32_bf16 v[148:151], a[0:3], a[64:67], v[148:151]
  v_mfma_f32_16x16x32_bf16 v[148:151], a[4:7], a[68:71], v[148:151]
  v_mfma_f32_16x16x32_bf16 v[148:151], a[8:11], a[72:75], v[148:151]
  v_mfma_f32_16x16x32_bf16 v[148:151], a[12:15], a[76:79], v[148:151]
  v_mfma_f32_16x16x32_bf16 v[152:155], a[0:3], a[80:83], v[152:155]
  v_mfma_f32_16x16x32_bf16 v[152:155], a[4:7], a[84:87], v[152:155]
  s_getreg_b32 s43, hwreg(HW_REG_IB_STS)
  s_and_b32 s43, s43, 0xc0000f
  v_mfma_f32_16x16x32_bf16 v[152:155], a[8:11], a[88:91], v[152:155]
  s_or_b32 s43, s43, s92
  s_cbranch_scc0 L_hsa102_standalone__gqa_block_cached__near_ridge_kernel
L_hra102_standalone__gqa_block_cached__near_ridge_kernel:
  v_mfma_f32_16x16x32_bf16 v[152:155], a[12:15], a[92:95], v[152:155]
  v_mfma_f32_16x16x32_bf16 v[156:159], a[0:3], a[96:99], v[156:159]
  v_mfma_f32_16x16x32_bf16 v[156:159], a[4:7], a[100:103], v[156:159]
  v_mfma_f32_16x16x32_bf16 v[156:159], a[8:11], a[104:107], v[156:159]
  v_mfma_f32_16x16x32_bf16 v[156:159], a[12:15], a[108:111], v[156:159]
  s_waitcnt lgkmcnt(0)
  v_mfma_f32_16x16x32_bf16 v[160:163], a[16:19], a[64:67], v[160:163]
  v_mfma_f32_16x16x32_bf16 v[160:163], a[20:23], a[68:71], v[160:163]
  v_mfma_f32_16x16x32_bf16 v[160:163], a[24:27], a[72:75], v[160:163]
  v_mfma_f32_16x16x32_bf16 v[160:163], a[28:31], a[76:79], v[160:163]
  v_mfma_f32_16x16x32_bf16 v[164:167], a[16:19], a[80:83], v[164:167]
  v_mfma_f32_16x16x32_bf16 v[164:167], a[20:23], a[84:87], v[164:167]
  s_getreg_b32 s43, hwreg(HW_REG_IB_STS)
  s_and_b32 s43, s43, 0xc0000f
  v_mfma_f32_16x16x32_bf16 v[164:167], a[24:27], a[88:91], v[164:167]
  s_or_b32 s43, s43, s92
  s_cbranch_scc0 L_hsa114_standalone__gqa_block_cached__near_ridge_kernel
L_hra114_standalone__gqa_block_cached__near_ridge_kernel:
  v_mfma_f32_16x16x32_bf16 v[164:167], a[28:31], a[92:95], v[164:167]
  v_mfma_f32_16x16x32_bf16 v[168:171], a[16:19], a[96:99], v[168:171]
  v_mfma_f32_16x16x32_bf16 v[168:171], a[20:23], a[100:103], v[168:171]
  v_mfma_f32_16x16x32_bf16 v[168:171], a[24:27], a[104:107], v[168:171]
  v_mfma_f32_16x16x32_bf16 v[168:171], a[28:31], a[108:111], v[168:171]
  s_cmp_ge_u32 s35, 2
  s_cbranch_scc0 L_w2_standalone__gqa_block_cached__near_ridge_kernel
L_wr2_standalone__gqa_block_cached__near_ridge_kernel:
  s_cmp_eq_u32 s35, 3
  s_cbranch_scc0 L_sgl_standalone__gqa_block_cached__near_ridge_kernel
  ds_read_b64_tr_b16 a[32:33], v220 offset:0
  ds_read_b64_tr_b16 a[34:35], v220 offset:5120
  ds_read_b64_tr_b16 a[36:37], v220 offset:10240
  ds_read_b64_tr_b16 a[38:39], v220 offset:15360
  ds_read_b64_tr_b16 a[40:41], v220 offset:20480
  ds_read_b64_tr_b16 a[42:43], v220 offset:25600
  ds_read_b64_tr_b16 a[44:45], v220 offset:30720
  ds_read_b64_tr_b16 a[46:47], v220 offset:35840
  ds_read_b64_tr_b16 a[48:49], v222 offset:0
  ds_read_b64_tr_b16 a[50:51], v222 offset:5120
  ds_read_b64_tr_b16 a[52:53], v222 offset:10240
  ds_read_b64_tr_b16 a[54:55], v222 offset:15360
  s_waitcnt lgkmcnt(10)
  v_mfma_f32_16x16x32_bf16 v[52:55], a[32:35], a[112:115], v[52:55]
  ds_read_b64_tr_b16 a[56:57], v222 offset:20480
  ds_read_b64_tr_b16 a[58:59], v222 offset:25600
  s_waitcnt lgkmcnt(10)
  v_mfma_f32_16x16x32_bf16 v[52:55], a[36:39], a[116:119], v[52:55]
  ds_read_b64_tr_b16 a[60:61], v222 offset:30720
  s_waitcnt lgkmcnt(9)
  v_mfma_f32_16x16x32_bf16 v[52:55], a[40:43], a[120:123], v[52:55]
  ds_read_b64_tr_b16 a[62:63], v222 offset:35840
  s_waitcnt lgkmcnt(8)
  v_mfma_f32_16x16x32_bf16 v[52:55], a[44:47], a[124:127], v[52:55]
  ds_read_b64_tr_b16 a[0:1], v221 offset:0
  ds_read_b64_tr_b16 a[2:3], v221 offset:5120
  v_mfma_f32_16x16x32_bf16 v[56:59], a[32:35], a[128:131], v[56:59]
  ds_read_b64_tr_b16 a[4:5], v221 offset:10240
  ds_read_b64_tr_b16 a[6:7], v221 offset:15360
  v_mfma_f32_16x16x32_bf16 v[56:59], a[36:39], a[132:135], v[56:59]
  ds_read_b64_tr_b16 a[8:9], v221 offset:20480
  ds_read_b64_tr_b16 a[10:11], v221 offset:25600
  v_mfma_f32_16x16x32_bf16 v[56:59], a[40:43], a[136:139], v[56:59]
  ds_read_b64_tr_b16 a[12:13], v221 offset:30720
  ds_read_b64_tr_b16 a[14:15], v221 offset:35840
  v_mfma_f32_16x16x32_bf16 v[56:59], a[44:47], a[140:143], v[56:59]
  v_mfma_f32_16x16x32_bf16 v[60:63], a[32:35], a[144:147], v[60:63]
  v_mfma_f32_16x16x32_bf16 v[60:63], a[36:39], a[148:151], v[60:63]
  ds_read_b64_tr_b16 a[16:17], v223 offset:0
  ds_read_b64_tr_b16 a[18:19], v223 offset:5120
  v_mfma_f32_16x16x32_bf16 v[60:63], a[40:43], a[152:155], v[60:63]
  v_mfma_f32_16x16x32_bf16 v[60:63], a[44:47], a[156:159], v[60:63]
  s_waitcnt lgkmcnt(10)
  v_mfma_f32_16x16x32_bf16 v[52:55], a[48:51], a[160:163], v[52:55]
  ds_read_b64_tr_b16 a[20:21], v223 offset:10240
  ds_read_b64_tr_b16 a[22:23], v223 offset:15360
  v_mfma_f32_16x16x32_bf16 v[52:55], a[52:55], a[164:167], v[52:55]
  v_mfma_f32_16x16x32_bf16 v[52:55], a[56:59], a[168:171], v[52:55]
  v_mfma_f32_16x16x32_bf16 v[52:55], a[60:63], a[172:175], v[52:55]
  ds_read_b64_tr_b16 a[24:25], v223 offset:20480
  ds_read_b64_tr_b16 a[26:27], v223 offset:25600
  v_mfma_f32_16x16x32_bf16 v[56:59], a[48:51], a[176:179], v[56:59]
  v_mfma_f32_16x16x32_bf16 v[56:59], a[52:55], a[180:183], v[56:59]
  v_mfma_f32_16x16x32_bf16 v[56:59], a[56:59], a[184:187], v[56:59]
  ds_read_b64_tr_b16 a[28:29], v223 offset:30720
  ds_read_b64_tr_b16 a[30:31], v223 offset:35840
  v_mfma_f32_16x16x32_bf16 v[56:59], a[60:63], a[188:191], v[56:59]
  v_mfma_f32_16x16x32_bf16 v[60:63], a[48:51], a[192:195], v[60:63]
  v_mfma_f32_16x16x32_bf16 v[60:63], a[52:55], a[196:199], v[60:63]
  ds_read_b64_tr_b16 a[32:33], v220 offset:64
  ds_read_b64_tr_b16 a[34:35], v220 offset:5184
  v_mfma_f32_16x16x32_bf16 v[60:63], a[56:59], a[200:203], v[60:63]
  v_mfma_f32_16x16x32_bf16 v[60:63], a[60:63], a[204:207], v[60:63]
  s_waitcnt lgkmcnt(10)
  v_mfma_f32_16x16x32_bf16 v[64:67], a[0:3], a[112:115], v[64:67]
  ds_read_b64_tr_b16 a[36:37], v220 offset:10304
  ds_read_b64_tr_b16 a[38:39], v220 offset:15424
  v_mfma_f32_16x16x32_bf16 v[64:67], a[4:7], a[116:119], v[64:67]
  v_mfma_f32_16x16x32_bf16 v[64:67], a[8:11], a[120:123], v[64:67]
  v_mfma_f32_16x16x32_bf16 v[64:67], a[12:15], a[124:127], v[64:67]
  ds_read_b64_tr_b16 a[40:41], v220 offset:20544
  ds_read_b64_tr_b16 a[42:43], v220 offset:25664
  v_mfma_f32_16x16x32_bf16 v[68:71], a[0:3], a[128:131], v[68:71]
  v_mfma_f32_16x16x32_bf16 v[68:71], a[4:7], a[132:135], v[68:71]
  v_mfma_f32_16x16x32_bf16 v[68:71], a[8:11], a[136:139], v[68:71]
  ds_read_b64_tr_b16 a[44:45], v220 offset:30784
  ds_read_b64_tr_b16 a[46:47], v220 offset:35904
  v_mfma_f32_16x16x32_bf16 v[68:71], a[12:15], a[140:143], v[68:71]
  v_mfma_f32_16x16x32_bf16 v[72:75], a[0:3], a[144:147], v[72:75]
  v_mfma_f32_16x16x32_bf16 v[72:75], a[4:7], a[148:151], v[72:75]
  ds_read_b64_tr_b16 a[48:49], v222 offset:64
  ds_read_b64_tr_b16 a[50:51], v222 offset:5184
  v_mfma_f32_16x16x32_bf16 v[72:75], a[8:11], a[152:155], v[72:75]
  v_mfma_f32_16x16x32_bf16 v[72:75], a[12:15], a[156:159], v[72:75]
  s_waitcnt lgkmcnt(10)
  v_mfma_f32_16x16x32_bf16 v[64:67], a[16:19], a[160:163], v[64:67]
  ds_read_b64_tr_b16 a[52:53], v222 offset:10304
  ds_read_b64_tr_b16 a[54:55], v222 offset:15424
  v_mfma_f32_16x16x32_bf16 v[64:67], a[20:23], a[164:167], v[64:67]
  v_mfma_f32_16x16x32_bf16 v[64:67], a[24:27], a[168:171], v[64:67]
  v_mfma_f32_16x16x32_bf16 v[64:67], a[28:31], a[172:175], v[64:67]
  ds_read_b64_tr_b16 a[56:57], v222 offset:20544
  ds_read_b64_tr_b16 a[58:59], v222 offset:25664
  v_mfma_f32_16x16x32_bf16 v[68:71], a[16:19], a[176:179], v[68:71]
  v_mfma_f32_16x16x32_bf16 v[68:71], a[20:23], a[180:183], v[68:71]
  v_mfma_f32_16x16x32_bf16 v[68:71], a[24:27], a[184:187], v[68:71]
  ds_read_b64_tr_b16 a[60:61], v222 offset:30784
  ds_read_b64_tr_b16 a[62:63], v222 offset:35904
  v_mfma_f32_16x16x32_bf16 v[68:71], a[28:31], a[188:191], v[68:71]
  v_mfma_f32_16x16x32_bf16 v[72:75], a[16:19], a[192:195], v[72:75]
  v_mfma_f32_16x16x32_bf16 v[72:75], a[20:23], a[196:199], v[72:75]
  ds_read_b64_tr_b16 a[0:1], v221 offset:64
  ds_read_b64_tr_b16 a[2:3], v221 offset:5184
  v_mfma_f32_16x16x32_bf16 v[72:75], a[24:27], a[200:203], v[72:75]
  v_mfma_f32_16x16x32_bf16 v[72:75], a[28:31], a[204:207], v[72:75]
  s_waitcnt lgkmcnt(10)
  v_mfma_f32_16x16x32_bf16 v[76:79], a[32:35], a[112:115], v[76:79]
  ds_read_b64_tr_b16 a[4:5], v221 offset:10304
  ds_read_b64_tr_b16 a[6:7], v221 offset:15424
  v_mfma_f32_16x16x32_bf16 v[76:79], a[36:39], a[116:119], v[76:79]
  v_mfma_f32_16x16x32_bf16 v[76:79], a[40:43], a[120:123], v[76:79]
  v_cvt_pk_bf16_f32 v52, v52, v53
  v_cvt_pk_bf16_f32 v53, v54, v55
  v_mfma_f32_16x16x32_bf16 v[76:79], a[44:47], a[124:127], v[76:79]
  ds_read_b64_tr_b16 a[8:9], v221 offset:20544
  ds_read_b64_tr_b16 a[10:11], v221 offset:25664
  v_mfma_f32_16x16x32_bf16 v[80:83], a[32:35], a[128:131], v[80:83]
  v_cvt_pk_bf16_f32 v54, v64, v65
  v_cvt_pk_bf16_f32 v55, v66, v67
  v_mfma_f32_16x16x32_bf16 v[80:83], a[36:39], a[132:135], v[80:83]
  v_cvt_pk_bf16_f32 v56, v56, v57
  v_cvt_pk_bf16_f32 v57, v58, v59
  v_mfma_f32_16x16x32_bf16 v[80:83], a[40:43], a[136:139], v[80:83]
  ds_read_b64_tr_b16 a[12:13], v221 offset:30784
  ds_read_b64_tr_b16 a[14:15], v221 offset:35904
  v_mfma_f32_16x16x32_bf16 v[80:83], a[44:47], a[140:143], v[80:83]
  v_cvt_pk_bf16_f32 v58, v68, v69
  v_cvt_pk_bf16_f32 v59, v70, v71
  v_mfma_f32_16x16x32_bf16 v[84:87], a[32:35], a[144:147], v[84:87]
  v_cvt_pk_bf16_f32 v60, v60, v61
  v_cvt_pk_bf16_f32 v61, v62, v63
  v_mfma_f32_16x16x32_bf16 v[84:87], a[36:39], a[148:151], v[84:87]
  ds_read_b64_tr_b16 a[16:17], v223 offset:64
  ds_read_b64_tr_b16 a[18:19], v223 offset:5184
  v_mfma_f32_16x16x32_bf16 v[84:87], a[40:43], a[152:155], v[84:87]
  v_cvt_pk_bf16_f32 v62, v72, v73
  v_cvt_pk_bf16_f32 v63, v74, v75
  v_mfma_f32_16x16x32_bf16 v[84:87], a[44:47], a[156:159], v[84:87]
  v_permlane16_swap_b32 v52, v54
  s_waitcnt lgkmcnt(10)
  v_mfma_f32_16x16x32_bf16 v[76:79], a[48:51], a[160:163], v[76:79]
  ds_read_b64_tr_b16 a[20:21], v223 offset:10304
  ds_read_b64_tr_b16 a[22:23], v223 offset:15424
  v_mfma_f32_16x16x32_bf16 v[76:79], a[52:55], a[164:167], v[76:79]
  v_permlane16_swap_b32 v53, v55
  s_add_u32 s50, s28, 0
  v_mfma_f32_16x16x32_bf16 v[76:79], a[56:59], a[168:171], v[76:79]
  buffer_store_dwordx4 v[52:55], v240, s[12:15], s50 offen sc1
  v_permlane16_swap_b32 v56, v58
  v_mfma_f32_16x16x32_bf16 v[76:79], a[60:63], a[172:175], v[76:79]
  ds_read_b64_tr_b16 a[24:25], v223 offset:20544
  ds_read_b64_tr_b16 a[26:27], v223 offset:25664
  v_mfma_f32_16x16x32_bf16 v[80:83], a[48:51], a[176:179], v[80:83]
  v_permlane16_swap_b32 v57, v59
  s_add_u32 s50, s28, 5120
  v_mfma_f32_16x16x32_bf16 v[80:83], a[52:55], a[180:183], v[80:83]
  buffer_store_dwordx4 v[56:59], v240, s[12:15], s50 offen sc1
  v_permlane16_swap_b32 v60, v62
  v_mfma_f32_16x16x32_bf16 v[80:83], a[56:59], a[184:187], v[80:83]
  ds_read_b64_tr_b16 a[28:29], v223 offset:30784
  ds_read_b64_tr_b16 a[30:31], v223 offset:35904
  v_mfma_f32_16x16x32_bf16 v[80:83], a[60:63], a[188:191], v[80:83]
  v_permlane16_swap_b32 v61, v63
  s_add_u32 s50, s28, 10240
  v_mfma_f32_16x16x32_bf16 v[84:87], a[48:51], a[192:195], v[84:87]
  buffer_store_dwordx4 v[60:63], v240, s[12:15], s50 offen sc1
  v_mfma_f32_16x16x32_bf16 v[84:87], a[52:55], a[196:199], v[84:87]
  ds_read_b64_tr_b16 a[32:33], v220 offset:128
  ds_read_b64_tr_b16 a[34:35], v220 offset:5248
  v_mfma_f32_16x16x32_bf16 v[84:87], a[56:59], a[200:203], v[84:87]
  v_mfma_f32_16x16x32_bf16 v[84:87], a[60:63], a[204:207], v[84:87]
  s_waitcnt lgkmcnt(10)
  v_mfma_f32_16x16x32_bf16 v[88:91], a[0:3], a[112:115], v[88:91]
  ds_read_b64_tr_b16 a[36:37], v220 offset:10368
  ds_read_b64_tr_b16 a[38:39], v220 offset:15488
  v_mfma_f32_16x16x32_bf16 v[88:91], a[4:7], a[116:119], v[88:91]
  v_mfma_f32_16x16x32_bf16 v[88:91], a[8:11], a[120:123], v[88:91]
  v_mfma_f32_16x16x32_bf16 v[88:91], a[12:15], a[124:127], v[88:91]
  ds_read_b64_tr_b16 a[40:41], v220 offset:20608
  ds_read_b64_tr_b16 a[42:43], v220 offset:25728
  v_mfma_f32_16x16x32_bf16 v[92:95], a[0:3], a[128:131], v[92:95]
  v_mfma_f32_16x16x32_bf16 v[92:95], a[4:7], a[132:135], v[92:95]
  v_mfma_f32_16x16x32_bf16 v[92:95], a[8:11], a[136:139], v[92:95]
  ds_read_b64_tr_b16 a[44:45], v220 offset:30848
  ds_read_b64_tr_b16 a[46:47], v220 offset:35968
  v_mfma_f32_16x16x32_bf16 v[92:95], a[12:15], a[140:143], v[92:95]
  v_mfma_f32_16x16x32_bf16 v[96:99], a[0:3], a[144:147], v[96:99]
  v_mfma_f32_16x16x32_bf16 v[96:99], a[4:7], a[148:151], v[96:99]
  ds_read_b64_tr_b16 a[48:49], v222 offset:128
  ds_read_b64_tr_b16 a[50:51], v222 offset:5248
  v_mfma_f32_16x16x32_bf16 v[96:99], a[8:11], a[152:155], v[96:99]
  v_mfma_f32_16x16x32_bf16 v[96:99], a[12:15], a[156:159], v[96:99]
  s_waitcnt lgkmcnt(10)
  v_mfma_f32_16x16x32_bf16 v[88:91], a[16:19], a[160:163], v[88:91]
  ds_read_b64_tr_b16 a[52:53], v222 offset:10368
  ds_read_b64_tr_b16 a[54:55], v222 offset:15488
  v_mfma_f32_16x16x32_bf16 v[88:91], a[20:23], a[164:167], v[88:91]
  v_mfma_f32_16x16x32_bf16 v[88:91], a[24:27], a[168:171], v[88:91]
  v_mfma_f32_16x16x32_bf16 v[88:91], a[28:31], a[172:175], v[88:91]
  ds_read_b64_tr_b16 a[56:57], v222 offset:20608
  ds_read_b64_tr_b16 a[58:59], v222 offset:25728
  v_mfma_f32_16x16x32_bf16 v[92:95], a[16:19], a[176:179], v[92:95]
  v_mfma_f32_16x16x32_bf16 v[92:95], a[20:23], a[180:183], v[92:95]
  v_mfma_f32_16x16x32_bf16 v[92:95], a[24:27], a[184:187], v[92:95]
  ds_read_b64_tr_b16 a[60:61], v222 offset:30848
  ds_read_b64_tr_b16 a[62:63], v222 offset:35968
  v_mfma_f32_16x16x32_bf16 v[92:95], a[28:31], a[188:191], v[92:95]
  v_mfma_f32_16x16x32_bf16 v[96:99], a[16:19], a[192:195], v[96:99]
  v_mfma_f32_16x16x32_bf16 v[96:99], a[20:23], a[196:199], v[96:99]
  ds_read_b64_tr_b16 a[0:1], v221 offset:128
  ds_read_b64_tr_b16 a[2:3], v221 offset:5248
  v_mfma_f32_16x16x32_bf16 v[96:99], a[24:27], a[200:203], v[96:99]
  v_mfma_f32_16x16x32_bf16 v[96:99], a[28:31], a[204:207], v[96:99]
  s_waitcnt lgkmcnt(10)
  v_mfma_f32_16x16x32_bf16 v[100:103], a[32:35], a[112:115], v[100:103]
  ds_read_b64_tr_b16 a[4:5], v221 offset:10368
  ds_read_b64_tr_b16 a[6:7], v221 offset:15488
  v_mfma_f32_16x16x32_bf16 v[100:103], a[36:39], a[116:119], v[100:103]
  v_mfma_f32_16x16x32_bf16 v[100:103], a[40:43], a[120:123], v[100:103]
  v_cvt_pk_bf16_f32 v76, v76, v77
  v_cvt_pk_bf16_f32 v77, v78, v79
  v_mfma_f32_16x16x32_bf16 v[100:103], a[44:47], a[124:127], v[100:103]
  ds_read_b64_tr_b16 a[8:9], v221 offset:20608
  ds_read_b64_tr_b16 a[10:11], v221 offset:25728
  v_mfma_f32_16x16x32_bf16 v[104:107], a[32:35], a[128:131], v[104:107]
  v_cvt_pk_bf16_f32 v78, v88, v89
  v_cvt_pk_bf16_f32 v79, v90, v91
  v_mfma_f32_16x16x32_bf16 v[104:107], a[36:39], a[132:135], v[104:107]
  v_cvt_pk_bf16_f32 v80, v80, v81
  v_cvt_pk_bf16_f32 v81, v82, v83
  v_mfma_f32_16x16x32_bf16 v[104:107], a[40:43], a[136:139], v[104:107]
  ds_read_b64_tr_b16 a[12:13], v221 offset:30848
  ds_read_b64_tr_b16 a[14:15], v221 offset:35968
  v_mfma_f32_16x16x32_bf16 v[104:107], a[44:47], a[140:143], v[104:107]
  v_cvt_pk_bf16_f32 v82, v92, v93
  v_cvt_pk_bf16_f32 v83, v94, v95
  v_mfma_f32_16x16x32_bf16 v[108:111], a[32:35], a[144:147], v[108:111]
  v_cvt_pk_bf16_f32 v84, v84, v85
  v_cvt_pk_bf16_f32 v85, v86, v87
  v_mfma_f32_16x16x32_bf16 v[108:111], a[36:39], a[148:151], v[108:111]
  ds_read_b64_tr_b16 a[16:17], v223 offset:128
  ds_read_b64_tr_b16 a[18:19], v223 offset:5248
  v_mfma_f32_16x16x32_bf16 v[108:111], a[40:43], a[152:155], v[108:111]
  v_cvt_pk_bf16_f32 v86, v96, v97
  v_cvt_pk_bf16_f32 v87, v98, v99
  v_mfma_f32_16x16x32_bf16 v[108:111], a[44:47], a[156:159], v[108:111]
  v_permlane16_swap_b32 v76, v78
  s_waitcnt lgkmcnt(10)
  v_mfma_f32_16x16x32_bf16 v[100:103], a[48:51], a[160:163], v[100:103]
  ds_read_b64_tr_b16 a[20:21], v223 offset:10368
  ds_read_b64_tr_b16 a[22:23], v223 offset:15488
  v_mfma_f32_16x16x32_bf16 v[100:103], a[52:55], a[164:167], v[100:103]
  v_permlane16_swap_b32 v77, v79
  s_add_u32 s50, s28, 1024
  v_mfma_f32_16x16x32_bf16 v[100:103], a[56:59], a[168:171], v[100:103]
  buffer_store_dwordx4 v[76:79], v240, s[12:15], s50 offen sc1
  v_permlane16_swap_b32 v80, v82
  v_mfma_f32_16x16x32_bf16 v[100:103], a[60:63], a[172:175], v[100:103]
  ds_read_b64_tr_b16 a[24:25], v223 offset:20608
  ds_read_b64_tr_b16 a[26:27], v223 offset:25728
  v_mfma_f32_16x16x32_bf16 v[104:107], a[48:51], a[176:179], v[104:107]
  v_permlane16_swap_b32 v81, v83
  s_add_u32 s50, s28, 6144
  v_mfma_f32_16x16x32_bf16 v[104:107], a[52:55], a[180:183], v[104:107]
  buffer_store_dwordx4 v[80:83], v240, s[12:15], s50 offen sc1
  v_permlane16_swap_b32 v84, v86
  v_mfma_f32_16x16x32_bf16 v[104:107], a[56:59], a[184:187], v[104:107]
  ds_read_b64_tr_b16 a[28:29], v223 offset:30848
  ds_read_b64_tr_b16 a[30:31], v223 offset:35968
  v_mfma_f32_16x16x32_bf16 v[104:107], a[60:63], a[188:191], v[104:107]
  v_permlane16_swap_b32 v85, v87
  s_add_u32 s50, s28, 11264
  v_mfma_f32_16x16x32_bf16 v[108:111], a[48:51], a[192:195], v[108:111]
  buffer_store_dwordx4 v[84:87], v240, s[12:15], s50 offen sc1
  v_mfma_f32_16x16x32_bf16 v[108:111], a[52:55], a[196:199], v[108:111]
  ds_read_b64_tr_b16 a[32:33], v220 offset:192
  ds_read_b64_tr_b16 a[34:35], v220 offset:5312
  v_mfma_f32_16x16x32_bf16 v[108:111], a[56:59], a[200:203], v[108:111]
  v_mfma_f32_16x16x32_bf16 v[108:111], a[60:63], a[204:207], v[108:111]
  s_waitcnt lgkmcnt(10)
  v_mfma_f32_16x16x32_bf16 v[112:115], a[0:3], a[112:115], v[112:115]
  ds_read_b64_tr_b16 a[36:37], v220 offset:10432
  ds_read_b64_tr_b16 a[38:39], v220 offset:15552
  v_mfma_f32_16x16x32_bf16 v[112:115], a[4:7], a[116:119], v[112:115]
  v_mfma_f32_16x16x32_bf16 v[112:115], a[8:11], a[120:123], v[112:115]
  v_mfma_f32_16x16x32_bf16 v[112:115], a[12:15], a[124:127], v[112:115]
  ds_read_b64_tr_b16 a[40:41], v220 offset:20672
  ds_read_b64_tr_b16 a[42:43], v220 offset:25792
  v_mfma_f32_16x16x32_bf16 v[116:119], a[0:3], a[128:131], v[116:119]
  v_mfma_f32_16x16x32_bf16 v[116:119], a[4:7], a[132:135], v[116:119]
  v_mfma_f32_16x16x32_bf16 v[116:119], a[8:11], a[136:139], v[116:119]
  ds_read_b64_tr_b16 a[44:45], v220 offset:30912
  ds_read_b64_tr_b16 a[46:47], v220 offset:36032
  v_mfma_f32_16x16x32_bf16 v[116:119], a[12:15], a[140:143], v[116:119]
  v_mfma_f32_16x16x32_bf16 v[120:123], a[0:3], a[144:147], v[120:123]
  v_mfma_f32_16x16x32_bf16 v[120:123], a[4:7], a[148:151], v[120:123]
  ds_read_b64_tr_b16 a[48:49], v222 offset:192
  ds_read_b64_tr_b16 a[50:51], v222 offset:5312
  v_mfma_f32_16x16x32_bf16 v[120:123], a[8:11], a[152:155], v[120:123]
  v_mfma_f32_16x16x32_bf16 v[120:123], a[12:15], a[156:159], v[120:123]
  s_waitcnt lgkmcnt(10)
  v_mfma_f32_16x16x32_bf16 v[112:115], a[16:19], a[160:163], v[112:115]
  ds_read_b64_tr_b16 a[52:53], v222 offset:10432
  ds_read_b64_tr_b16 a[54:55], v222 offset:15552
  v_mfma_f32_16x16x32_bf16 v[112:115], a[20:23], a[164:167], v[112:115]
  v_mfma_f32_16x16x32_bf16 v[112:115], a[24:27], a[168:171], v[112:115]
  v_mfma_f32_16x16x32_bf16 v[112:115], a[28:31], a[172:175], v[112:115]
  ds_read_b64_tr_b16 a[56:57], v222 offset:20672
  ds_read_b64_tr_b16 a[58:59], v222 offset:25792
  v_mfma_f32_16x16x32_bf16 v[116:119], a[16:19], a[176:179], v[116:119]
  v_mfma_f32_16x16x32_bf16 v[116:119], a[20:23], a[180:183], v[116:119]
  v_mfma_f32_16x16x32_bf16 v[116:119], a[24:27], a[184:187], v[116:119]
  ds_read_b64_tr_b16 a[60:61], v222 offset:30912
  ds_read_b64_tr_b16 a[62:63], v222 offset:36032
  v_mfma_f32_16x16x32_bf16 v[116:119], a[28:31], a[188:191], v[116:119]
  v_mfma_f32_16x16x32_bf16 v[120:123], a[16:19], a[192:195], v[120:123]
  v_mfma_f32_16x16x32_bf16 v[120:123], a[20:23], a[196:199], v[120:123]
  ds_read_b64_tr_b16 a[0:1], v221 offset:192
  ds_read_b64_tr_b16 a[2:3], v221 offset:5312
  v_mfma_f32_16x16x32_bf16 v[120:123], a[24:27], a[200:203], v[120:123]
  v_mfma_f32_16x16x32_bf16 v[120:123], a[28:31], a[204:207], v[120:123]
  s_waitcnt lgkmcnt(10)
  v_mfma_f32_16x16x32_bf16 v[124:127], a[32:35], a[112:115], v[124:127]
  ds_read_b64_tr_b16 a[4:5], v221 offset:10432
  ds_read_b64_tr_b16 a[6:7], v221 offset:15552
  v_mfma_f32_16x16x32_bf16 v[124:127], a[36:39], a[116:119], v[124:127]
  v_mfma_f32_16x16x32_bf16 v[124:127], a[40:43], a[120:123], v[124:127]
  v_cvt_pk_bf16_f32 v100, v100, v101
  v_cvt_pk_bf16_f32 v101, v102, v103
  v_mfma_f32_16x16x32_bf16 v[124:127], a[44:47], a[124:127], v[124:127]
  ds_read_b64_tr_b16 a[8:9], v221 offset:20672
  ds_read_b64_tr_b16 a[10:11], v221 offset:25792
  v_mfma_f32_16x16x32_bf16 v[128:131], a[32:35], a[128:131], v[128:131]
  v_cvt_pk_bf16_f32 v102, v112, v113
  v_cvt_pk_bf16_f32 v103, v114, v115
  v_mfma_f32_16x16x32_bf16 v[128:131], a[36:39], a[132:135], v[128:131]
  v_cvt_pk_bf16_f32 v104, v104, v105
  v_cvt_pk_bf16_f32 v105, v106, v107
  v_mfma_f32_16x16x32_bf16 v[128:131], a[40:43], a[136:139], v[128:131]
  ds_read_b64_tr_b16 a[12:13], v221 offset:30912
  ds_read_b64_tr_b16 a[14:15], v221 offset:36032
  v_mfma_f32_16x16x32_bf16 v[128:131], a[44:47], a[140:143], v[128:131]
  v_cvt_pk_bf16_f32 v106, v116, v117
  v_cvt_pk_bf16_f32 v107, v118, v119
  v_mfma_f32_16x16x32_bf16 v[132:135], a[32:35], a[144:147], v[132:135]
  v_cvt_pk_bf16_f32 v108, v108, v109
  v_cvt_pk_bf16_f32 v109, v110, v111
  v_mfma_f32_16x16x32_bf16 v[132:135], a[36:39], a[148:151], v[132:135]
  ds_read_b64_tr_b16 a[16:17], v223 offset:192
  ds_read_b64_tr_b16 a[18:19], v223 offset:5312
  v_mfma_f32_16x16x32_bf16 v[132:135], a[40:43], a[152:155], v[132:135]
  v_cvt_pk_bf16_f32 v110, v120, v121
  v_cvt_pk_bf16_f32 v111, v122, v123
  v_mfma_f32_16x16x32_bf16 v[132:135], a[44:47], a[156:159], v[132:135]
  v_permlane16_swap_b32 v100, v102
  s_waitcnt lgkmcnt(10)
  v_mfma_f32_16x16x32_bf16 v[124:127], a[48:51], a[160:163], v[124:127]
  ds_read_b64_tr_b16 a[20:21], v223 offset:10432
  ds_read_b64_tr_b16 a[22:23], v223 offset:15552
  v_mfma_f32_16x16x32_bf16 v[124:127], a[52:55], a[164:167], v[124:127]
  v_permlane16_swap_b32 v101, v103
  s_add_u32 s50, s28, 2048
  v_mfma_f32_16x16x32_bf16 v[124:127], a[56:59], a[168:171], v[124:127]
  buffer_store_dwordx4 v[100:103], v240, s[12:15], s50 offen sc1
  v_permlane16_swap_b32 v104, v106
  v_mfma_f32_16x16x32_bf16 v[124:127], a[60:63], a[172:175], v[124:127]
  ds_read_b64_tr_b16 a[24:25], v223 offset:20672
  ds_read_b64_tr_b16 a[26:27], v223 offset:25792
  v_mfma_f32_16x16x32_bf16 v[128:131], a[48:51], a[176:179], v[128:131]
  v_permlane16_swap_b32 v105, v107
  s_add_u32 s50, s28, 7168
  v_mfma_f32_16x16x32_bf16 v[128:131], a[52:55], a[180:183], v[128:131]
  buffer_store_dwordx4 v[104:107], v240, s[12:15], s50 offen sc1
  v_permlane16_swap_b32 v108, v110
  v_mfma_f32_16x16x32_bf16 v[128:131], a[56:59], a[184:187], v[128:131]
  ds_read_b64_tr_b16 a[28:29], v223 offset:30912
  ds_read_b64_tr_b16 a[30:31], v223 offset:36032
  v_mfma_f32_16x16x32_bf16 v[128:131], a[60:63], a[188:191], v[128:131]
  v_permlane16_swap_b32 v109, v111
  s_add_u32 s50, s28, 12288
  v_mfma_f32_16x16x32_bf16 v[132:135], a[48:51], a[192:195], v[132:135]
  buffer_store_dwordx4 v[108:111], v240, s[12:15], s50 offen sc1
  v_mfma_f32_16x16x32_bf16 v[132:135], a[52:55], a[196:199], v[132:135]
  ds_read_b64_tr_b16 a[32:33], v220 offset:256
  ds_read_b64_tr_b16 a[34:35], v220 offset:5376
  v_mfma_f32_16x16x32_bf16 v[132:135], a[56:59], a[200:203], v[132:135]
  v_mfma_f32_16x16x32_bf16 v[132:135], a[60:63], a[204:207], v[132:135]
  s_waitcnt lgkmcnt(10)
  v_mfma_f32_16x16x32_bf16 v[136:139], a[0:3], a[112:115], v[136:139]
  ds_read_b64_tr_b16 a[36:37], v220 offset:10496
  ds_read_b64_tr_b16 a[38:39], v220 offset:15616
  v_mfma_f32_16x16x32_bf16 v[136:139], a[4:7], a[116:119], v[136:139]
  v_mfma_f32_16x16x32_bf16 v[136:139], a[8:11], a[120:123], v[136:139]
  v_mfma_f32_16x16x32_bf16 v[136:139], a[12:15], a[124:127], v[136:139]
  ds_read_b64_tr_b16 a[40:41], v220 offset:20736
  ds_read_b64_tr_b16 a[42:43], v220 offset:25856
  v_mfma_f32_16x16x32_bf16 v[140:143], a[0:3], a[128:131], v[140:143]
  v_mfma_f32_16x16x32_bf16 v[140:143], a[4:7], a[132:135], v[140:143]
  v_mfma_f32_16x16x32_bf16 v[140:143], a[8:11], a[136:139], v[140:143]
  ds_read_b64_tr_b16 a[44:45], v220 offset:30976
  ds_read_b64_tr_b16 a[46:47], v220 offset:36096
  v_mfma_f32_16x16x32_bf16 v[140:143], a[12:15], a[140:143], v[140:143]
  v_mfma_f32_16x16x32_bf16 v[144:147], a[0:3], a[144:147], v[144:147]
  v_mfma_f32_16x16x32_bf16 v[144:147], a[4:7], a[148:151], v[144:147]
  ds_read_b64_tr_b16 a[48:49], v222 offset:256
  ds_read_b64_tr_b16 a[50:51], v222 offset:5376
  v_mfma_f32_16x16x32_bf16 v[144:147], a[8:11], a[152:155], v[144:147]
  v_mfma_f32_16x16x32_bf16 v[144:147], a[12:15], a[156:159], v[144:147]
  s_waitcnt lgkmcnt(10)
  v_mfma_f32_16x16x32_bf16 v[136:139], a[16:19], a[160:163], v[136:139]
  ds_read_b64_tr_b16 a[52:53], v222 offset:10496
  ds_read_b64_tr_b16 a[54:55], v222 offset:15616
  v_mfma_f32_16x16x32_bf16 v[136:139], a[20:23], a[164:167], v[136:139]
  v_mfma_f32_16x16x32_bf16 v[136:139], a[24:27], a[168:171], v[136:139]
  v_mfma_f32_16x16x32_bf16 v[136:139], a[28:31], a[172:175], v[136:139]
  ds_read_b64_tr_b16 a[56:57], v222 offset:20736
  ds_read_b64_tr_b16 a[58:59], v222 offset:25856
  v_mfma_f32_16x16x32_bf16 v[140:143], a[16:19], a[176:179], v[140:143]
  v_mfma_f32_16x16x32_bf16 v[140:143], a[20:23], a[180:183], v[140:143]
  v_mfma_f32_16x16x32_bf16 v[140:143], a[24:27], a[184:187], v[140:143]
  ds_read_b64_tr_b16 a[60:61], v222 offset:30976
  ds_read_b64_tr_b16 a[62:63], v222 offset:36096
  v_mfma_f32_16x16x32_bf16 v[140:143], a[28:31], a[188:191], v[140:143]
  v_mfma_f32_16x16x32_bf16 v[144:147], a[16:19], a[192:195], v[144:147]
  v_mfma_f32_16x16x32_bf16 v[144:147], a[20:23], a[196:199], v[144:147]
  ds_read_b64_tr_b16 a[0:1], v221 offset:256
  ds_read_b64_tr_b16 a[2:3], v221 offset:5376
  v_mfma_f32_16x16x32_bf16 v[144:147], a[24:27], a[200:203], v[144:147]
  v_mfma_f32_16x16x32_bf16 v[144:147], a[28:31], a[204:207], v[144:147]
  s_waitcnt lgkmcnt(10)
  v_mfma_f32_16x16x32_bf16 v[148:151], a[32:35], a[112:115], v[148:151]
  ds_read_b64_tr_b16 a[4:5], v221 offset:10496
  ds_read_b64_tr_b16 a[6:7], v221 offset:15616
  v_mfma_f32_16x16x32_bf16 v[148:151], a[36:39], a[116:119], v[148:151]
  v_mfma_f32_16x16x32_bf16 v[148:151], a[40:43], a[120:123], v[148:151]
  v_cvt_pk_bf16_f32 v124, v124, v125
  v_cvt_pk_bf16_f32 v125, v126, v127
  v_mfma_f32_16x16x32_bf16 v[148:151], a[44:47], a[124:127], v[148:151]
  ds_read_b64_tr_b16 a[8:9], v221 offset:20736
  ds_read_b64_tr_b16 a[10:11], v221 offset:25856
  v_mfma_f32_16x16x32_bf16 v[152:155], a[32:35], a[128:131], v[152:155]
  v_cvt_pk_bf16_f32 v126, v136, v137
  v_cvt_pk_bf16_f32 v127, v138, v139
  v_mfma_f32_16x16x32_bf16 v[152:155], a[36:39], a[132:135], v[152:155]
  v_cvt_pk_bf16_f32 v128, v128, v129
  v_cvt_pk_bf16_f32 v129, v130, v131
  v_mfma_f32_16x16x32_bf16 v[152:155], a[40:43], a[136:139], v[152:155]
  ds_read_b64_tr_b16 a[12:13], v221 offset:30976
  ds_read_b64_tr_b16 a[14:15], v221 offset:36096
  v_mfma_f32_16x16x32_bf16 v[152:155], a[44:47], a[140:143], v[152:155]
  v_cvt_pk_bf16_f32 v130, v140, v141
  v_cvt_pk_bf16_f32 v131, v142, v143
  v_mfma_f32_16x16x32_bf16 v[156:159], a[32:35], a[144:147], v[156:159]
  v_cvt_pk_bf16_f32 v132, v132, v133
  v_cvt_pk_bf16_f32 v133, v134, v135
  v_mfma_f32_16x16x32_bf16 v[156:159], a[36:39], a[148:151], v[156:159]
  ds_read_b64_tr_b16 a[16:17], v223 offset:256
  ds_read_b64_tr_b16 a[18:19], v223 offset:5376
  v_mfma_f32_16x16x32_bf16 v[156:159], a[40:43], a[152:155], v[156:159]
  v_cvt_pk_bf16_f32 v134, v144, v145
  v_cvt_pk_bf16_f32 v135, v146, v147
  v_mfma_f32_16x16x32_bf16 v[156:159], a[44:47], a[156:159], v[156:159]
  v_permlane16_swap_b32 v124, v126
  s_waitcnt lgkmcnt(10)
  v_mfma_f32_16x16x32_bf16 v[148:151], a[48:51], a[160:163], v[148:151]
  s_mov_b64 exec, 0xffff
  buffer_load_dword v206, v235, s[16:19], 0 offen sc1
  s_mov_b64 exec, -1
  v_mfma_f32_16x16x32_bf16 v[148:151], a[52:55], a[164:167], v[148:151]
  ds_read_b64_tr_b16 a[20:21], v223 offset:10496
  ds_read_b64_tr_b16 a[22:23], v223 offset:15616
  v_mfma_f32_16x16x32_bf16 v[148:151], a[56:59], a[168:171], v[148:151]
  v_permlane16_swap_b32 v125, v127
  s_add_u32 s50, s28, 3072
  v_mfma_f32_16x16x32_bf16 v[148:151], a[60:63], a[172:175], v[148:151]
  ds_read_b64_tr_b16 a[24:25], v223 offset:20736
  ds_read_b64_tr_b16 a[26:27], v223 offset:25856
  v_mfma_f32_16x16x32_bf16 v[152:155], a[48:51], a[176:179], v[152:155]
  buffer_store_dwordx4 v[124:127], v240, s[12:15], s50 offen sc1
  v_permlane16_swap_b32 v128, v130
  v_mfma_f32_16x16x32_bf16 v[152:155], a[52:55], a[180:183], v[152:155]
  v_permlane16_swap_b32 v129, v131
  s_add_u32 s50, s28, 8192
  v_mfma_f32_16x16x32_bf16 v[152:155], a[56:59], a[184:187], v[152:155]
  ds_read_b64_tr_b16 a[28:29], v223 offset:30976
  ds_read_b64_tr_b16 a[30:31], v223 offset:36096
  v_mfma_f32_16x16x32_bf16 v[152:155], a[60:63], a[188:191], v[152:155]
  buffer_store_dwordx4 v[128:131], v240, s[12:15], s50 offen sc1
  v_permlane16_swap_b32 v132, v134
  v_mfma_f32_16x16x32_bf16 v[156:159], a[48:51], a[192:195], v[156:159]
  v_permlane16_swap_b32 v133, v135
  s_add_u32 s50, s28, 13312
  v_mfma_f32_16x16x32_bf16 v[156:159], a[52:55], a[196:199], v[156:159]
  buffer_store_dwordx4 v[132:135], v240, s[12:15], s50 offen sc1
  v_mfma_f32_16x16x32_bf16 v[156:159], a[56:59], a[200:203], v[156:159]
  v_mfma_f32_16x16x32_bf16 v[156:159], a[60:63], a[204:207], v[156:159]
  s_waitcnt lgkmcnt(8)
  v_mfma_f32_16x16x32_bf16 v[160:163], a[0:3], a[112:115], v[160:163]
  v_mfma_f32_16x16x32_bf16 v[160:163], a[4:7], a[116:119], v[160:163]
  v_mfma_f32_16x16x32_bf16 v[160:163], a[8:11], a[120:123], v[160:163]
  v_mfma_f32_16x16x32_bf16 v[160:163], a[12:15], a[124:127], v[160:163]
  v_mfma_f32_16x16x32_bf16 v[164:167], a[0:3], a[128:131], v[164:167]
  v_mfma_f32_16x16x32_bf16 v[164:167], a[4:7], a[132:135], v[164:167]
  v_mfma_f32_16x16x32_bf16 v[164:167], a[8:11], a[136:139], v[164:167]
  v_mfma_f32_16x16x32_bf16 v[164:167], a[12:15], a[140:143], v[164:167]
  v_mfma_f32_16x16x32_bf16 v[168:171], a[0:3], a[144:147], v[168:171]
  v_mfma_f32_16x16x32_bf16 v[168:171], a[4:7], a[148:151], v[168:171]
  v_mfma_f32_16x16x32_bf16 v[168:171], a[8:11], a[152:155], v[168:171]
  v_mfma_f32_16x16x32_bf16 v[168:171], a[12:15], a[156:159], v[168:171]
  s_waitcnt lgkmcnt(0)
  v_mfma_f32_16x16x32_bf16 v[160:163], a[16:19], a[160:163], v[160:163]
  v_mfma_f32_16x16x32_bf16 v[160:163], a[20:23], a[164:167], v[160:163]
  v_mfma_f32_16x16x32_bf16 v[160:163], a[24:27], a[168:171], v[160:163]
  v_mfma_f32_16x16x32_bf16 v[160:163], a[28:31], a[172:175], v[160:163]
  v_mfma_f32_16x16x32_bf16 v[164:167], a[16:19], a[176:179], v[164:167]
  v_mfma_f32_16x16x32_bf16 v[164:167], a[20:23], a[180:183], v[164:167]
  v_mfma_f32_16x16x32_bf16 v[164:167], a[24:27], a[184:187], v[164:167]
  v_mfma_f32_16x16x32_bf16 v[164:167], a[28:31], a[188:191], v[164:167]
  v_mfma_f32_16x16x32_bf16 v[168:171], a[16:19], a[192:195], v[168:171]
  v_mfma_f32_16x16x32_bf16 v[168:171], a[20:23], a[196:199], v[168:171]
  v_mfma_f32_16x16x32_bf16 v[168:171], a[24:27], a[200:203], v[168:171]
  v_mfma_f32_16x16x32_bf16 v[168:171], a[28:31], a[204:207], v[168:171]
  v_cvt_pk_bf16_f32 v148, v148, v149
  v_cvt_pk_bf16_f32 v149, v150, v151
  v_cvt_pk_bf16_f32 v150, v160, v161
  v_cvt_pk_bf16_f32 v151, v162, v163
  v_cvt_pk_bf16_f32 v152, v152, v153
  v_cvt_pk_bf16_f32 v153, v154, v155
  v_cvt_pk_bf16_f32 v154, v164, v165
  v_cvt_pk_bf16_f32 v155, v166, v167
  v_cvt_pk_bf16_f32 v156, v156, v157
  v_cvt_pk_bf16_f32 v157, v158, v159
  v_cvt_pk_bf16_f32 v158, v168, v169
  v_cvt_pk_bf16_f32 v159, v170, v171
  v_permlane16_swap_b32 v148, v150
  v_permlane16_swap_b32 v149, v151
  s_add_u32 s50, s28, 4096
  buffer_store_dwordx4 v[148:151], v240, s[12:15], s50 offen sc1
  v_permlane16_swap_b32 v152, v154
  v_permlane16_swap_b32 v153, v155
  s_add_u32 s50, s28, 9216
  buffer_store_dwordx4 v[152:155], v240, s[12:15], s50 offen sc1
  v_permlane16_swap_b32 v156, v158
  v_permlane16_swap_b32 v157, v159
  s_add_u32 s50, s28, 14336
  buffer_store_dwordx4 v[156:159], v240, s[12:15], s50 offen sc1
L_fin_standalone__gqa_block_cached__near_ridge_kernel:
  s_waitcnt vmcnt(0)
  s_mov_b64 exec, 128
  buffer_store_dword v230, v229, s[16:19], s95 offen sc1
  s_mov_b64 exec, -1
  s_mov_b32 s48, 0
  s_mov_b32 s46, 0xffff
  s_cmp_lt_u32 s40, 2
  s_cselect_b32 s46, 0xff, s46
  s_branch L_ev_C_standalone__gqa_block_cached__near_ridge_kernel
L_pl_C_standalone__gqa_block_cached__near_ridge_kernel:
  s_mov_b32 exec_lo, s46
  s_mov_b32 exec_hi, 0
  buffer_load_dword v206, v235, s[16:19], 0 offen sc1
  s_waitcnt vmcnt(0)
L_ev_C_standalone__gqa_block_cached__near_ridge_kernel:
  v_cmp_ne_u32 vcc, v236, v206
  s_mov_b64 exec, -1
  s_add_u32 s48, s48, 1
  s_cmp_ge_u32 s48, 50000
  s_cselect_b32 s47, s46, vcc_lo
  s_and_b32 s47, s47, s46
  s_cbranch_scc1 L_nw_C_standalone__gqa_block_cached__near_ridge_kernel
  s_sleep 10
  s_branch L_pl_C_standalone__gqa_block_cached__near_ridge_kernel
L_nw_C_standalone__gqa_block_cached__near_ridge_kernel:
  s_bitcmp1_b32 s47, 0
  s_cbranch_scc1 L_fs0_C_standalone__gqa_block_cached__near_ridge_kernel
L_fr0_C_standalone__gqa_block_cached__near_ridge_kernel:
  s_bitcmp1_b32 s47, 1
  s_cbranch_scc1 L_fs1_C_standalone__gqa_block_cached__near_ridge_kernel
L_fr1_C_standalone__gqa_block_cached__near_ridge_kernel:
  s_bitcmp1_b32 s47, 2
  s_cbranch_scc1 L_fs2_C_standalone__gqa_block_cached__near_ridge_kernel
L_fr2_C_standalone__gqa_block_cached__near_ridge_kernel:
  s_bitcmp1_b32 s47, 3
  s_cbranch_scc1 L_fs3_C_standalone__gqa_block_cached__near_ridge_kernel
L_fr3_C_standalone__gqa_block_cached__near_ridge_kernel:
  s_bitcmp1_b32 s47, 4
  s_cbranch_scc1 L_fs4_C_standalone__gqa_block_cached__near_ridge_kernel
L_fr4_C_standalone__gqa_block_cached__near_ridge_kernel:
  s_bitcmp1_b32 s47, 5
  s_cbranch_scc1 L_fs5_C_standalone__gqa_block_cached__near_ridge_kernel
L_fr5_C_standalone__gqa_block_cached__near_ridge_kernel:
  s_bitcmp1_b32 s47, 6
  s_cbranch_scc1 L_fs6_C_standalone__gqa_block_cached__near_ridge_kernel
L_fr6_C_standalone__gqa_block_cached__near_ridge_kernel:
  s_bitcmp1_b32 s47, 7
  s_cbranch_scc1 L_fs7_C_standalone__gqa_block_cached__near_ridge_kernel
L_fr7_C_standalone__gqa_block_cached__near_ridge_kernel:
  s_bitcmp1_b32 s47, 8
  s_cbranch_scc1 L_fs8_C_standalone__gqa_block_cached__near_ridge_kernel
L_fr8_C_standalone__gqa_block_cached__near_ridge_kernel:
  s_bitcmp1_b32 s47, 9
  s_cbranch_scc1 L_fs9_C_standalone__gqa_block_cached__near_ridge_kernel
L_fr9_C_standalone__gqa_block_cached__near_ridge_kernel:
  s_bitcmp1_b32 s47, 10
  s_cbranch_scc1 L_fs10_C_standalone__gqa_block_cached__near_ridge_kernel
L_fr10_C_standalone__gqa_block_cached__near_ridge_kernel:
  s_bitcmp1_b32 s47, 11
  s_cbranch_scc1 L_fs11_C_standalone__gqa_block_cached__near_ridge_kernel
L_fr11_C_standalone__gqa_block_cached__near_ridge_kernel:
  s_bitcmp1_b32 s47, 12
  s_cbranch_scc1 L_fs12_C_standalone__gqa_block_cached__near_ridge_kernel
L_fr12_C_standalone__gqa_block_cached__near_ridge_kernel:
  s_bitcmp1_b32 s47, 13
  s_cbranch_scc1 L_fs13_C_standalone__gqa_block_cached__near_ridge_kernel
L_fr13_C_standalone__gqa_block_cached__near_ridge_kernel:
  s_bitcmp1_b32 s47, 14
  s_cbranch_scc1 L_fs14_C_standalone__gqa_block_cached__near_ridge_kernel
L_fr14_C_standalone__gqa_block_cached__near_ridge_kernel:
  s_bitcmp1_b32 s47, 15
  s_cbranch_scc1 L_fs15_C_standalone__gqa_block_cached__near_ridge_kernel
L_fr15_C_standalone__gqa_block_cached__near_ridge_kernel:
  s_andn2_b32 s46, s46, s47
  s_cbranch_scc1 L_pl_C_standalone__gqa_block_cached__near_ridge_kernel
  s_waitcnt vmcnt(0)
  s_mov_b32 s43, 0x3f80
  s_mov_b32 s44, 0x3f800000
  v_dot2_f32_bf16 v4, v12, s43, 0
  v_dot2_f32_bf16 v5, v12, s44, 0
  v_dot2_f32_bf16 v6, v13, s43, 0
  v_dot2_f32_bf16 v7, v13, s44, 0
  v_dot2_f32_bf16 v8, v14, s43, 0
  v_dot2_f32_bf16 v9, v14, s44, 0
  v_dot2_f32_bf16 v10, v15, s43, 0
  v_dot2_f32_bf16 v11, v15, s44, 0
  v_dot2_f32_bf16 v4, v16, s43, v4
  v_dot2_f32_bf16 v5, v16, s44, v5
  v_dot2_f32_bf16 v6, v17, s43, v6
  v_dot2_f32_bf16 v7, v17, s44, v7
  v_dot2_f32_bf16 v8, v18, s43, v8
  v_dot2_f32_bf16 v9, v18, s44, v9
  v_dot2_f32_bf16 v10, v19, s43, v10
  v_dot2_f32_bf16 v11, v19, s44, v11
  v_dot2_f32_bf16 v4, v20, s43, v4
  v_dot2_f32_bf16 v5, v20, s44, v5
  v_dot2_f32_bf16 v6, v21, s43, v6
  v_dot2_f32_bf16 v7, v21, s44, v7
  v_dot2_f32_bf16 v8, v22, s43, v8
  v_dot2_f32_bf16 v9, v22, s44, v9
  v_dot2_f32_bf16 v10, v23, s43, v10
  v_dot2_f32_bf16 v11, v23, s44, v11
  v_dot2_f32_bf16 v4, v24, s43, v4
  v_dot2_f32_bf16 v5, v24, s44, v5
  v_dot2_f32_bf16 v6, v25, s43, v6
  v_dot2_f32_bf16 v7, v25, s44, v7
  v_dot2_f32_bf16 v8, v26, s43, v8
  v_dot2_f32_bf16 v9, v26, s44, v9
  v_dot2_f32_bf16 v10, v27, s43, v10
  v_dot2_f32_bf16 v11, v27, s44, v11
  v_dot2_f32_bf16 v4, v28, s43, v4
  v_dot2_f32_bf16 v5, v28, s44, v5
  v_dot2_f32_bf16 v6, v29, s43, v6
  v_dot2_f32_bf16 v7, v29, s44, v7
  v_dot2_f32_bf16 v8, v30, s43, v8
  v_dot2_f32_bf16 v9, v30, s44, v9
  v_dot2_f32_bf16 v10, v31, s43, v10
  v_dot2_f32_bf16 v11, v31, s44, v11
  v_dot2_f32_bf16 v4, v32, s43, v4
  v_dot2_f32_bf16 v5, v32, s44, v5
  v_dot2_f32_bf16 v6, v33, s43, v6
  v_dot2_f32_bf16 v7, v33, s44, v7
  v_dot2_f32_bf16 v8, v34, s43, v8
  v_dot2_f32_bf16 v9, v34, s44, v9
  v_dot2_f32_bf16 v10, v35, s43, v10
  v_dot2_f32_bf16 v11, v35, s44, v11
  v_dot2_f32_bf16 v4, v36, s43, v4
  v_dot2_f32_bf16 v5, v36, s44, v5
  v_dot2_f32_bf16 v6, v37, s43, v6
  v_dot2_f32_bf16 v7, v37, s44, v7
  v_dot2_f32_bf16 v8, v38, s43, v8
  v_dot2_f32_bf16 v9, v38, s44, v9
  v_dot2_f32_bf16 v10, v39, s43, v10
  v_dot2_f32_bf16 v11, v39, s44, v11
  v_dot2_f32_bf16 v4, v40, s43, v4
  v_dot2_f32_bf16 v5, v40, s44, v5
  v_dot2_f32_bf16 v6, v41, s43, v6
  v_dot2_f32_bf16 v7, v41, s44, v7
  v_dot2_f32_bf16 v8, v42, s43, v8
  v_dot2_f32_bf16 v9, v42, s44, v9
  v_dot2_f32_bf16 v10, v43, s43, v10
  v_dot2_f32_bf16 v11, v43, s44, v11
  s_nop 2
  v_cvt_pk_bf16_f32 v4, v4, v5
  v_cvt_pk_bf16_f32 v5, v6, v7
  v_cvt_pk_bf16_f32 v6, v8, v9
  v_cvt_pk_bf16_f32 v7, v10, v11
  buffer_store_dwordx4 v[4:7], v233, s[36:39], 0 offen sc1
  s_cmp_lt_u32 s40, 2
  s_cbranch_scc1 L_fd_C_standalone__gqa_block_cached__near_ridge_kernel
  v_dot2_f32_bf16 v44, v52, s43, 0
  v_dot2_f32_bf16 v45, v52, s44, 0
  v_dot2_f32_bf16 v46, v53, s43, 0
  v_dot2_f32_bf16 v47, v53, s44, 0
  v_dot2_f32_bf16 v48, v54, s43, 0
  v_dot2_f32_bf16 v49, v54, s44, 0
  v_dot2_f32_bf16 v50, v55, s43, 0
  v_dot2_f32_bf16 v51, v55, s44, 0
  v_dot2_f32_bf16 v44, v56, s43, v44
  v_dot2_f32_bf16 v45, v56, s44, v45
  v_dot2_f32_bf16 v46, v57, s43, v46
  v_dot2_f32_bf16 v47, v57, s44, v47
  v_dot2_f32_bf16 v48, v58, s43, v48
  v_dot2_f32_bf16 v49, v58, s44, v49
  v_dot2_f32_bf16 v50, v59, s43, v50
  v_dot2_f32_bf16 v51, v59, s44, v51
  v_dot2_f32_bf16 v44, v60, s43, v44
  v_dot2_f32_bf16 v45, v60, s44, v45
  v_dot2_f32_bf16 v46, v61, s43, v46
  v_dot2_f32_bf16 v47, v61, s44, v47
  v_dot2_f32_bf16 v48, v62, s43, v48
  v_dot2_f32_bf16 v49, v62, s44, v49
  v_dot2_f32_bf16 v50, v63, s43, v50
  v_dot2_f32_bf16 v51, v63, s44, v51
  v_dot2_f32_bf16 v44, v64, s43, v44
  v_dot2_f32_bf16 v45, v64, s44, v45
  v_dot2_f32_bf16 v46, v65, s43, v46
  v_dot2_f32_bf16 v47, v65, s44, v47
  v_dot2_f32_bf16 v48, v66, s43, v48
  v_dot2_f32_bf16 v49, v66, s44, v49
  v_dot2_f32_bf16 v50, v67, s43, v50
  v_dot2_f32_bf16 v51, v67, s44, v51
  v_dot2_f32_bf16 v44, v68, s43, v44
  v_dot2_f32_bf16 v45, v68, s44, v45
  v_dot2_f32_bf16 v46, v69, s43, v46
  v_dot2_f32_bf16 v47, v69, s44, v47
  v_dot2_f32_bf16 v48, v70, s43, v48
  v_dot2_f32_bf16 v49, v70, s44, v49
  v_dot2_f32_bf16 v50, v71, s43, v50
  v_dot2_f32_bf16 v51, v71, s44, v51
  v_dot2_f32_bf16 v44, v72, s43, v44
  v_dot2_f32_bf16 v45, v72, s44, v45
  v_dot2_f32_bf16 v46, v73, s43, v46
  v_dot2_f32_bf16 v47, v73, s44, v47
  v_dot2_f32_bf16 v48, v74, s43, v48
  v_dot2_f32_bf16 v49, v74, s44, v49
  v_dot2_f32_bf16 v50, v75, s43, v50
  v_dot2_f32_bf16 v51, v75, s44, v51
  v_dot2_f32_bf16 v44, v76, s43, v44
  v_dot2_f32_bf16 v45, v76, s44, v45
  v_dot2_f32_bf16 v46, v77, s43, v46
  v_dot2_f32_bf16 v47, v77, s44, v47
  v_dot2_f32_bf16 v48, v78, s43, v48
  v_dot2_f32_bf16 v49, v78, s44, v49
  v_dot2_f32_bf16 v50, v79, s43, v50
  v_dot2_f32_bf16 v51, v79, s44, v51
  v_dot2_f32_bf16 v44, v80, s43, v44
  v_dot2_f32_bf16 v45, v80, s44, v45
  v_dot2_f32_bf16 v46, v81, s43, v46
  v_dot2_f32_bf16 v47, v81, s44, v47
  v_dot2_f32_bf16 v48, v82, s43, v48
  v_dot2_f32_bf16 v49, v82, s44, v49
  v_dot2_f32_bf16 v50, v83, s43, v50
  v_dot2_f32_bf16 v51, v83, s44, v51
  s_nop 2
  v_cvt_pk_bf16_f32 v44, v44, v45
  v_cvt_pk_bf16_f32 v45, v46, v47
  v_cvt_pk_bf16_f32 v46, v48, v49
  v_cvt_pk_bf16_f32 v47, v50, v51
  buffer_store_dwordx4 v[44:47], v234, s[36:39], 0 offen sc1
L_fd_C_standalone__gqa_block_cached__near_ridge_kernel:
L_end_standalone__gqa_block_cached__near_ridge_kernel:
  s_endpgm
L_fs0_C_standalone__gqa_block_cached__near_ridge_kernel:
  s_mov_b32 s50, 0
  buffer_load_dwordx4 v[12:15], v231, s[12:15], s50 offen sc1
  s_branch L_fr0_C_standalone__gqa_block_cached__near_ridge_kernel
L_fs1_C_standalone__gqa_block_cached__near_ridge_kernel:
  s_mov_b32 s50, 46080
  buffer_load_dwordx4 v[16:19], v231, s[12:15], s50 offen sc1
  s_branch L_fr1_C_standalone__gqa_block_cached__near_ridge_kernel
L_fs2_C_standalone__gqa_block_cached__near_ridge_kernel:
  s_mov_b32 s50, 92160
  buffer_load_dwordx4 v[20:23], v231, s[12:15], s50 offen sc1
  s_branch L_fr2_C_standalone__gqa_block_cached__near_ridge_kernel
L_fs3_C_standalone__gqa_block_cached__near_ridge_kernel:
  s_mov_b32 s50, 138240
  buffer_load_dwordx4 v[24:27], v231, s[12:15], s50 offen sc1
  s_branch L_fr3_C_standalone__gqa_block_cached__near_ridge_kernel
L_fs4_C_standalone__gqa_block_cached__near_ridge_kernel:
  s_mov_b32 s50, 184320
  buffer_load_dwordx4 v[28:31], v231, s[12:15], s50 offen sc1
  s_branch L_fr4_C_standalone__gqa_block_cached__near_ridge_kernel
L_fs5_C_standalone__gqa_block_cached__near_ridge_kernel:
  s_mov_b32 s50, 230400
  buffer_load_dwordx4 v[32:35], v231, s[12:15], s50 offen sc1
  s_branch L_fr5_C_standalone__gqa_block_cached__near_ridge_kernel
L_fs6_C_standalone__gqa_block_cached__near_ridge_kernel:
  s_mov_b32 s50, 276480
  buffer_load_dwordx4 v[36:39], v231, s[12:15], s50 offen sc1
  s_branch L_fr6_C_standalone__gqa_block_cached__near_ridge_kernel
L_fs7_C_standalone__gqa_block_cached__near_ridge_kernel:
  s_mov_b32 s50, 322560
  buffer_load_dwordx4 v[40:43], v231, s[12:15], s50 offen sc1
  s_branch L_fr7_C_standalone__gqa_block_cached__near_ridge_kernel
L_fs8_C_standalone__gqa_block_cached__near_ridge_kernel:
  s_mov_b32 s50, 0
  buffer_load_dwordx4 v[52:55], v232, s[12:15], s50 offen sc1
  s_branch L_fr8_C_standalone__gqa_block_cached__near_ridge_kernel
L_fs9_C_standalone__gqa_block_cached__near_ridge_kernel:
  s_mov_b32 s50, 46080
  buffer_load_dwordx4 v[56:59], v232, s[12:15], s50 offen sc1
  s_branch L_fr9_C_standalone__gqa_block_cached__near_ridge_kernel
L_fs10_C_standalone__gqa_block_cached__near_ridge_kernel:
  s_mov_b32 s50, 92160
  buffer_load_dwordx4 v[60:63], v232, s[12:15], s50 offen sc1
  s_branch L_fr10_C_standalone__gqa_block_cached__near_ridge_kernel
L_fs11_C_standalone__gqa_block_cached__near_ridge_kernel:
  s_mov_b32 s50, 138240
  buffer_load_dwordx4 v[64:67], v232, s[12:15], s50 offen sc1
  s_branch L_fr11_C_standalone__gqa_block_cached__near_ridge_kernel
L_fs12_C_standalone__gqa_block_cached__near_ridge_kernel:
  s_mov_b32 s50, 184320
  buffer_load_dwordx4 v[68:71], v232, s[12:15], s50 offen sc1
  s_branch L_fr12_C_standalone__gqa_block_cached__near_ridge_kernel
L_fs13_C_standalone__gqa_block_cached__near_ridge_kernel:
  s_mov_b32 s50, 230400
  buffer_load_dwordx4 v[72:75], v232, s[12:15], s50 offen sc1
  s_branch L_fr13_C_standalone__gqa_block_cached__near_ridge_kernel
L_fs14_C_standalone__gqa_block_cached__near_ridge_kernel:
  s_mov_b32 s50, 276480
  buffer_load_dwordx4 v[76:79], v232, s[12:15], s50 offen sc1
  s_branch L_fr14_C_standalone__gqa_block_cached__near_ridge_kernel
L_fs15_C_standalone__gqa_block_cached__near_ridge_kernel:
  s_mov_b32 s50, 322560
  buffer_load_dwordx4 v[80:83], v232, s[12:15], s50 offen sc1
  s_branch L_fr15_C_standalone__gqa_block_cached__near_ridge_kernel
  s_waitcnt vmcnt(0)
L_sgl_standalone__gqa_block_cached__near_ridge_kernel:
  ds_read_b64_tr_b16 a[32:33], v220 offset:0
  ds_read_b64_tr_b16 a[34:35], v220 offset:5120
  ds_read_b64_tr_b16 a[36:37], v220 offset:10240
  ds_read_b64_tr_b16 a[38:39], v220 offset:15360
  ds_read_b64_tr_b16 a[40:41], v220 offset:20480
  ds_read_b64_tr_b16 a[42:43], v220 offset:25600
  ds_read_b64_tr_b16 a[44:45], v220 offset:30720
  ds_read_b64_tr_b16 a[46:47], v220 offset:35840
  ds_read_b64_tr_b16 a[48:49], v221 offset:0
  ds_read_b64_tr_b16 a[50:51], v221 offset:5120
  ds_read_b64_tr_b16 a[52:53], v221 offset:10240
  ds_read_b64_tr_b16 a[54:55], v221 offset:15360
  s_waitcnt lgkmcnt(10)
  v_mfma_f32_16x16x32_bf16 v[52:55], a[32:35], a[112:115], v[52:55]
  ds_read_b64_tr_b16 a[56:57], v221 offset:20480
  ds_read_b64_tr_b16 a[58:59], v221 offset:25600
  s_waitcnt lgkmcnt(10)
  v_mfma_f32_16x16x32_bf16 v[52:55], a[36:39], a[116:119], v[52:55]
  ds_read_b64_tr_b16 a[60:61], v221 offset:30720
  s_waitcnt lgkmcnt(9)
  v_mfma_f32_16x16x32_bf16 v[52:55], a[40:43], a[120:123], v[52:55]
  ds_read_b64_tr_b16 a[62:63], v221 offset:35840
  s_waitcnt lgkmcnt(8)
  v_mfma_f32_16x16x32_bf16 v[52:55], a[44:47], a[124:127], v[52:55]
  ds_read_b64_tr_b16 a[0:1], v220 offset:64
  ds_read_b64_tr_b16 a[2:3], v220 offset:5184
  v_mfma_f32_16x16x32_bf16 v[56:59], a[32:35], a[128:131], v[56:59]
  ds_read_b64_tr_b16 a[4:5], v220 offset:10304
  ds_read_b64_tr_b16 a[6:7], v220 offset:15424
  v_mfma_f32_16x16x32_bf16 v[56:59], a[36:39], a[132:135], v[56:59]
  ds_read_b64_tr_b16 a[8:9], v220 offset:20544
  ds_read_b64_tr_b16 a[10:11], v220 offset:25664
  v_mfma_f32_16x16x32_bf16 v[56:59], a[40:43], a[136:139], v[56:59]
  ds_read_b64_tr_b16 a[12:13], v220 offset:30784
  ds_read_b64_tr_b16 a[14:15], v220 offset:35904
  v_mfma_f32_16x16x32_bf16 v[56:59], a[44:47], a[140:143], v[56:59]
  v_mfma_f32_16x16x32_bf16 v[60:63], a[32:35], a[144:147], v[60:63]
  v_mfma_f32_16x16x32_bf16 v[60:63], a[36:39], a[148:151], v[60:63]
  ds_read_b64_tr_b16 a[16:17], v221 offset:64
  ds_read_b64_tr_b16 a[18:19], v221 offset:5184
  v_mfma_f32_16x16x32_bf16 v[60:63], a[40:43], a[152:155], v[60:63]
  v_mfma_f32_16x16x32_bf16 v[60:63], a[44:47], a[156:159], v[60:63]
  s_getreg_b32 s43, hwreg(HW_REG_IB_STS)
  s_and_b32 s43, s43, 0xc0000f
  s_waitcnt lgkmcnt(10)
  v_mfma_f32_16x16x32_bf16 v[64:67], a[48:51], a[112:115], v[64:67]
  s_or_b32 s43, s43, s92
  s_cbranch_scc0 L_hsb12_standalone__gqa_block_cached__near_ridge_kernel
L_hrb12_standalone__gqa_block_cached__near_ridge_kernel:
  v_mfma_f32_16x16x32_bf16 v[64:67], a[52:55], a[116:119], v[64:67]
  ds_read_b64_tr_b16 a[20:21], v221 offset:10304
  ds_read_b64_tr_b16 a[22:23], v221 offset:15424
  v_mfma_f32_16x16x32_bf16 v[64:67], a[56:59], a[120:123], v[64:67]
  v_mfma_f32_16x16x32_bf16 v[64:67], a[60:63], a[124:127], v[64:67]
  ds_read_b64_tr_b16 a[24:25], v221 offset:20544
  ds_read_b64_tr_b16 a[26:27], v221 offset:25664
  v_mfma_f32_16x16x32_bf16 v[68:71], a[48:51], a[128:131], v[68:71]
  v_mfma_f32_16x16x32_bf16 v[68:71], a[52:55], a[132:135], v[68:71]
  v_mfma_f32_16x16x32_bf16 v[68:71], a[56:59], a[136:139], v[68:71]
  ds_read_b64_tr_b16 a[28:29], v221 offset:30784
  ds_read_b64_tr_b16 a[30:31], v221 offset:35904
  v_mfma_f32_16x16x32_bf16 v[68:71], a[60:63], a[140:143], v[68:71]
  v_mfma_f32_16x16x32_bf16 v[72:75], a[48:51], a[144:147], v[72:75]
  v_mfma_f32_16x16x32_bf16 v[72:75], a[52:55], a[148:151], v[72:75]
  ds_read_b64_tr_b16 a[32:33], v220 offset:128
  ds_read_b64_tr_b16 a[34:35], v220 offset:5248
  v_mfma_f32_16x16x32_bf16 v[72:75], a[56:59], a[152:155], v[72:75]
  v_mfma_f32_16x16x32_bf16 v[72:75], a[60:63], a[156:159], v[72:75]
  s_waitcnt lgkmcnt(10)
  v_mfma_f32_16x16x32_bf16 v[76:79], a[0:3], a[112:115], v[76:79]
  ds_read_b64_tr_b16 a[36:37], v220 offset:10368
  ds_read_b64_tr_b16 a[38:39], v220 offset:15488
  v_mfma_f32_16x16x32_bf16 v[76:79], a[4:7], a[116:119], v[76:79]
  v_mfma_f32_16x16x32_bf16 v[76:79], a[8:11], a[120:123], v[76:79]
  v_mfma_f32_16x16x32_bf16 v[76:79], a[12:15], a[124:127], v[76:79]
  ds_read_b64_tr_b16 a[40:41], v220 offset:20608
  ds_read_b64_tr_b16 a[42:43], v220 offset:25728
  v_mfma_f32_16x16x32_bf16 v[80:83], a[0:3], a[128:131], v[80:83]
  v_mfma_f32_16x16x32_bf16 v[80:83], a[4:7], a[132:135], v[80:83]
  s_getreg_b32 s43, hwreg(HW_REG_IB_STS)
  s_and_b32 s43, s43, 0xc0000f
  v_mfma_f32_16x16x32_bf16 v[80:83], a[8:11], a[136:139], v[80:83]
  s_or_b32 s43, s43, s92
  s_cbranch_scc0 L_hsb30_standalone__gqa_block_cached__near_ridge_kernel
L_hrb30_standalone__gqa_block_cached__near_ridge_kernel:
  v_mfma_f32_16x16x32_bf16 v[80:83], a[12:15], a[140:143], v[80:83]
  ds_read_b64_tr_b16 a[44:45], v220 offset:30848
  ds_read_b64_tr_b16 a[46:47], v220 offset:35968
  v_mfma_f32_16x16x32_bf16 v[84:87], a[0:3], a[144:147], v[84:87]
  v_mfma_f32_16x16x32_bf16 v[84:87], a[4:7], a[148:151], v[84:87]
  ds_read_b64_tr_b16 a[48:49], v221 offset:128
  ds_read_b64_tr_b16 a[50:51], v221 offset:5248
  v_mfma_f32_16x16x32_bf16 v[84:87], a[8:11], a[152:155], v[84:87]
  v_mfma_f32_16x16x32_bf16 v[84:87], a[12:15], a[156:159], v[84:87]
  s_waitcnt lgkmcnt(10)
  v_mfma_f32_16x16x32_bf16 v[88:91], a[16:19], a[112:115], v[88:91]
  ds_read_b64_tr_b16 a[52:53], v221 offset:10368
  ds_read_b64_tr_b16 a[54:55], v221 offset:15488
  v_mfma_f32_16x16x32_bf16 v[88:91], a[20:23], a[116:119], v[88:91]
  v_mfma_f32_16x16x32_bf16 v[88:91], a[24:27], a[120:123], v[88:91]
  v_mfma_f32_16x16x32_bf16 v[88:91], a[28:31], a[124:127], v[88:91]
  ds_read_b64_tr_b16 a[56:57], v221 offset:20608
  ds_read_b64_tr_b16 a[58:59], v221 offset:25728
  v_mfma_f32_16x16x32_bf16 v[92:95], a[16:19], a[128:131], v[92:95]
  v_mfma_f32_16x16x32_bf16 v[92:95], a[20:23], a[132:135], v[92:95]
  v_mfma_f32_16x16x32_bf16 v[92:95], a[24:27], a[136:139], v[92:95]
  ds_read_b64_tr_b16 a[60:61], v221 offset:30848
  ds_read_b64_tr_b16 a[62:63], v221 offset:35968
  v_mfma_f32_16x16x32_bf16 v[92:95], a[28:31], a[140:143], v[92:95]
  v_mfma_f32_16x16x32_bf16 v[96:99], a[16:19], a[144:147], v[96:99]
  v_mfma_f32_16x16x32_bf16 v[96:99], a[20:23], a[148:151], v[96:99]
  ds_read_b64_tr_b16 a[0:1], v220 offset:192
  ds_read_b64_tr_b16 a[2:3], v220 offset:5312
  v_mfma_f32_16x16x32_bf16 v[96:99], a[24:27], a[152:155], v[96:99]
  v_mfma_f32_16x16x32_bf16 v[96:99], a[28:31], a[156:159], v[96:99]
  s_getreg_b32 s43, hwreg(HW_REG_IB_STS)
  s_and_b32 s43, s43, 0xc0000f
  s_waitcnt lgkmcnt(10)
  v_mfma_f32_16x16x32_bf16 v[100:103], a[32:35], a[112:115], v[100:103]
  s_or_b32 s43, s43, s92
  s_cbranch_scc0 L_hsb48_standalone__gqa_block_cached__near_ridge_kernel
L_hrb48_standalone__gqa_block_cached__near_ridge_kernel:
  v_mfma_f32_16x16x32_bf16 v[100:103], a[36:39], a[116:119], v[100:103]
  ds_read_b64_tr_b16 a[4:5], v220 offset:10432
  ds_read_b64_tr_b16 a[6:7], v220 offset:15552
  v_mfma_f32_16x16x32_bf16 v[100:103], a[40:43], a[120:123], v[100:103]
  v_mfma_f32_16x16x32_bf16 v[100:103], a[44:47], a[124:127], v[100:103]
  ds_read_b64_tr_b16 a[8:9], v220 offset:20672
  ds_read_b64_tr_b16 a[10:11], v220 offset:25792
  v_mfma_f32_16x16x32_bf16 v[104:107], a[32:35], a[128:131], v[104:107]
  v_mfma_f32_16x16x32_bf16 v[104:107], a[36:39], a[132:135], v[104:107]
  v_mfma_f32_16x16x32_bf16 v[104:107], a[40:43], a[136:139], v[104:107]
  ds_read_b64_tr_b16 a[12:13], v220 offset:30912
  ds_read_b64_tr_b16 a[14:15], v220 offset:36032
  v_mfma_f32_16x16x32_bf16 v[104:107], a[44:47], a[140:143], v[104:107]
  v_mfma_f32_16x16x32_bf16 v[108:111], a[32:35], a[144:147], v[108:111]
  v_mfma_f32_16x16x32_bf16 v[108:111], a[36:39], a[148:151], v[108:111]
  ds_read_b64_tr_b16 a[16:17], v221 offset:192
  ds_read_b64_tr_b16 a[18:19], v221 offset:5312
  v_mfma_f32_16x16x32_bf16 v[108:111], a[40:43], a[152:155], v[108:111]
  v_mfma_f32_16x16x32_bf16 v[108:111], a[44:47], a[156:159], v[108:111]
  s_waitcnt lgkmcnt(10)
  v_mfma_f32_16x16x32_bf16 v[112:115], a[48:51], a[112:115], v[112:115]
  ds_read_b64_tr_b16 a[20:21], v221 offset:10432
  ds_read_b64_tr_b16 a[22:23], v221 offset:15552
  v_mfma_f32_16x16x32_bf16 v[112:115], a[52:55], a[116:119], v[112:115]
  v_mfma_f32_16x16x32_bf16 v[112:115], a[56:59], a[120:123], v[112:115]
  v_mfma_f32_16x16x32_bf16 v[112:115], a[60:63], a[124:127], v[112:115]
  ds_read_b64_tr_b16 a[24:25], v221 offset:20672
  ds_read_b64_tr_b16 a[26:27], v221 offset:25792
  v_mfma_f32_16x16x32_bf16 v[116:119], a[48:51], a[128:131], v[116:119]
  v_mfma_f32_16x16x32_bf16 v[116:119], a[52:55], a[132:135], v[116:119]
  s_getreg_b32 s43, hwreg(HW_REG_IB_STS)
  s_and_b32 s43, s43, 0xc0000f
  v_mfma_f32_16x16x32_bf16 v[116:119], a[56:59], a[136:139], v[116:119]
  s_or_b32 s43, s43, s92
  s_cbranch_scc0 L_hsb66_standalone__gqa_block_cached__near_ridge_kernel
L_hrb66_standalone__gqa_block_cached__near_ridge_kernel:
  v_mfma_f32_16x16x32_bf16 v[116:119], a[60:63], a[140:143], v[116:119]
  ds_read_b64_tr_b16 a[28:29], v221 offset:30912
  ds_read_b64_tr_b16 a[30:31], v221 offset:36032
  v_mfma_f32_16x16x32_bf16 v[120:123], a[48:51], a[144:147], v[120:123]
  v_mfma_f32_16x16x32_bf16 v[120:123], a[52:55], a[148:151], v[120:123]
  ds_read_b64_tr_b16 a[32:33], v220 offset:256
  ds_read_b64_tr_b16 a[34:35], v220 offset:5376
  v_mfma_f32_16x16x32_bf16 v[120:123], a[56:59], a[152:155], v[120:123]
  v_mfma_f32_16x16x32_bf16 v[120:123], a[60:63], a[156:159], v[120:123]
  s_waitcnt lgkmcnt(10)
  v_mfma_f32_16x16x32_bf16 v[124:127], a[0:3], a[112:115], v[124:127]
  ds_read_b64_tr_b16 a[36:37], v220 offset:10496
  ds_read_b64_tr_b16 a[38:39], v220 offset:15616
  v_mfma_f32_16x16x32_bf16 v[124:127], a[4:7], a[116:119], v[124:127]
  v_mfma_f32_16x16x32_bf16 v[124:127], a[8:11], a[120:123], v[124:127]
  v_mfma_f32_16x16x32_bf16 v[124:127], a[12:15], a[124:127], v[124:127]
  ds_read_b64_tr_b16 a[40:41], v220 offset:20736
  ds_read_b64_tr_b16 a[42:43], v220 offset:25856
  v_mfma_f32_16x16x32_bf16 v[128:131], a[0:3], a[128:131], v[128:131]
  v_mfma_f32_16x16x32_bf16 v[128:131], a[4:7], a[132:135], v[128:131]
  v_mfma_f32_16x16x32_bf16 v[128:131], a[8:11], a[136:139], v[128:131]
  ds_read_b64_tr_b16 a[44:45], v220 offset:30976
  ds_read_b64_tr_b16 a[46:47], v220 offset:36096
  v_mfma_f32_16x16x32_bf16 v[128:131], a[12:15], a[140:143], v[128:131]
  v_mfma_f32_16x16x32_bf16 v[132:135], a[0:3], a[144:147], v[132:135]
  v_mfma_f32_16x16x32_bf16 v[132:135], a[4:7], a[148:151], v[132:135]
  ds_read_b64_tr_b16 a[48:49], v221 offset:256
  ds_read_b64_tr_b16 a[50:51], v221 offset:5376
  v_mfma_f32_16x16x32_bf16 v[132:135], a[8:11], a[152:155], v[132:135]
  v_mfma_f32_16x16x32_bf16 v[132:135], a[12:15], a[156:159], v[132:135]
  s_getreg_b32 s43, hwreg(HW_REG_IB_STS)
  s_and_b32 s43, s43, 0xc0000f
  s_waitcnt lgkmcnt(10)
  v_mfma_f32_16x16x32_bf16 v[136:139], a[16:19], a[112:115], v[136:139]
  s_or_b32 s43, s43, s92
  s_cbranch_scc0 L_hsb84_standalone__gqa_block_cached__near_ridge_kernel
L_hrb84_standalone__gqa_block_cached__near_ridge_kernel:
  v_mfma_f32_16x16x32_bf16 v[136:139], a[20:23], a[116:119], v[136:139]
  ds_read_b64_tr_b16 a[52:53], v221 offset:10496
  ds_read_b64_tr_b16 a[54:55], v221 offset:15616
  v_mfma_f32_16x16x32_bf16 v[136:139], a[24:27], a[120:123], v[136:139]
  v_mfma_f32_16x16x32_bf16 v[136:139], a[28:31], a[124:127], v[136:139]
  ds_read_b64_tr_b16 a[56:57], v221 offset:20736
  ds_read_b64_tr_b16 a[58:59], v221 offset:25856
  v_mfma_f32_16x16x32_bf16 v[140:143], a[16:19], a[128:131], v[140:143]
  v_mfma_f32_16x16x32_bf16 v[140:143], a[20:23], a[132:135], v[140:143]
  v_mfma_f32_16x16x32_bf16 v[140:143], a[24:27], a[136:139], v[140:143]
  ds_read_b64_tr_b16 a[60:61], v221 offset:30976
  ds_read_b64_tr_b16 a[62:63], v221 offset:36096
  v_mfma_f32_16x16x32_bf16 v[140:143], a[28:31], a[140:143], v[140:143]
  v_mfma_f32_16x16x32_bf16 v[144:147], a[16:19], a[144:147], v[144:147]
  v_mfma_f32_16x16x32_bf16 v[144:147], a[20:23], a[148:151], v[144:147]
  v_mfma_f32_16x16x32_bf16 v[144:147], a[24:27], a[152:155], v[144:147]
  v_mfma_f32_16x16x32_bf16 v[144:147], a[28:31], a[156:159], v[144:147]
  s_waitcnt lgkmcnt(8)
  v_mfma_f32_16x16x32_bf16 v[148:151], a[32:35], a[112:115], v[148:151]
  v_mfma_f32_16x16x32_bf16 v[148:151], a[36:39], a[116:119], v[148:151]
  v_mfma_f32_16x16x32_bf16 v[148:151], a[40:43], a[120:123], v[148:151]
  v_mfma_f32_16x16x32_bf16 v[148:151], a[44:47], a[124:127], v[148:151]
  v_mfma_f32_16x16x32_bf16 v[152:155], a[32:35], a[128:131], v[152:155]
  v_mfma_f32_16x16x32_bf16 v[152:155], a[36:39], a[132:135], v[152:155]
  s_getreg_b32 s43, hwreg(HW_REG_IB_STS)
  s_and_b32 s43, s43, 0xc0000f
  v_mfma_f32_16x16x32_bf16 v[152:155], a[40:43], a[136:139], v[152:155]
  s_or_b32 s43, s43, s92
  s_cbranch_scc0 L_hsb102_standalone__gqa_block_cached__near_ridge_kernel
L_hrb102_standalone__gqa_block_cached__near_ridge_kernel:
  v_mfma_f32_16x16x32_bf16 v[152:155], a[44:47], a[140:143], v[152:155]
  v_mfma_f32_16x16x32_bf16 v[156:159], a[32:35], a[144:147], v[156:159]
  v_mfma_f32_16x16x32_bf16 v[156:159], a[36:39], a[148:151], v[156:159]
  v_mfma_f32_16x16x32_bf16 v[156:159], a[40:43], a[152:155], v[156:159]
  v_mfma_f32_16x16x32_bf16 v[156:159], a[44:47], a[156:159], v[156:159]
  s_waitcnt lgkmcnt(0)
  v_mfma_f32_16x16x32_bf16 v[160:163], a[48:51], a[112:115], v[160:163]
  v_mfma_f32_16x16x32_bf16 v[160:163], a[52:55], a[116:119], v[160:163]
  v_mfma_f32_16x16x32_bf16 v[160:163], a[56:59], a[120:123], v[160:163]
  v_mfma_f32_16x16x32_bf16 v[160:163], a[60:63], a[124:127], v[160:163]
  v_mfma_f32_16x16x32_bf16 v[164:167], a[48:51], a[128:131], v[164:167]
  v_mfma_f32_16x16x32_bf16 v[164:167], a[52:55], a[132:135], v[164:167]
  s_getreg_b32 s43, hwreg(HW_REG_IB_STS)
  s_and_b32 s43, s43, 0xc0000f
  v_mfma_f32_16x16x32_bf16 v[164:167], a[56:59], a[136:139], v[164:167]
  s_or_b32 s43, s43, s92
  s_cbranch_scc0 L_hsb114_standalone__gqa_block_cached__near_ridge_kernel
L_hrb114_standalone__gqa_block_cached__near_ridge_kernel:
  v_mfma_f32_16x16x32_bf16 v[164:167], a[60:63], a[140:143], v[164:167]
  v_mfma_f32_16x16x32_bf16 v[168:171], a[48:51], a[144:147], v[168:171]
  v_mfma_f32_16x16x32_bf16 v[168:171], a[52:55], a[148:151], v[168:171]
  v_mfma_f32_16x16x32_bf16 v[168:171], a[56:59], a[152:155], v[168:171]
  v_mfma_f32_16x16x32_bf16 v[168:171], a[60:63], a[156:159], v[168:171]
  s_cmp_ge_u32 s35, 3
  s_cbranch_scc0 L_w3_standalone__gqa_block_cached__near_ridge_kernel
L_wr3_standalone__gqa_block_cached__near_ridge_kernel:
  ds_read_b64_tr_b16 a[0:1], v222 offset:0
  ds_read_b64_tr_b16 a[2:3], v222 offset:5120
  ds_read_b64_tr_b16 a[4:5], v222 offset:10240
  ds_read_b64_tr_b16 a[6:7], v222 offset:15360
  ds_read_b64_tr_b16 a[8:9], v222 offset:20480
  ds_read_b64_tr_b16 a[10:11], v222 offset:25600
  ds_read_b64_tr_b16 a[12:13], v222 offset:30720
  ds_read_b64_tr_b16 a[14:15], v222 offset:35840
  ds_read_b64_tr_b16 a[16:17], v223 offset:0
  ds_read_b64_tr_b16 a[18:19], v223 offset:5120
  ds_read_b64_tr_b16 a[20:21], v223 offset:10240
  ds_read_b64_tr_b16 a[22:23], v223 offset:15360
  s_waitcnt lgkmcnt(10)
  v_mfma_f32_16x16x32_bf16 v[52:55], a[0:3], a[160:163], v[52:55]
  ds_read_b64_tr_b16 a[24:25], v223 offset:20480
  ds_read_b64_tr_b16 a[26:27], v223 offset:25600
  s_waitcnt lgkmcnt(10)
  v_mfma_f32_16x16x32_bf16 v[52:55], a[4:7], a[164:167], v[52:55]
  ds_read_b64_tr_b16 a[28:29], v223 offset:30720
  s_waitcnt lgkmcnt(9)
  v_mfma_f32_16x16x32_bf16 v[52:55], a[8:11], a[168:171], v[52:55]
  ds_read_b64_tr_b16 a[30:31], v223 offset:35840
  s_waitcnt lgkmcnt(8)
  v_mfma_f32_16x16x32_bf16 v[52:55], a[12:15], a[172:175], v[52:55]
  ds_read_b64_tr_b16 a[32:33], v222 offset:64
  ds_read_b64_tr_b16 a[34:35], v222 offset:5184
  v_mfma_f32_16x16x32_bf16 v[56:59], a[0:3], a[176:179], v[56:59]
  ds_read_b64_tr_b16 a[36:37], v222 offset:10304
  ds_read_b64_tr_b16 a[38:39], v222 offset:15424
  v_mfma_f32_16x16x32_bf16 v[56:59], a[4:7], a[180:183], v[56:59]
  ds_read_b64_tr_b16 a[40:41], v222 offset:20544
  ds_read_b64_tr_b16 a[42:43], v222 offset:25664
  v_mfma_f32_16x16x32_bf16 v[56:59], a[8:11], a[184:187], v[56:59]
  ds_read_b64_tr_b16 a[44:45], v222 offset:30784
  ds_read_b64_tr_b16 a[46:47], v222 offset:35904
  v_mfma_f32_16x16x32_bf16 v[56:59], a[12:15], a[188:191], v[56:59]
  v_mfma_f32_16x16x32_bf16 v[60:63], a[0:3], a[192:195], v[60:63]
  v_mfma_f32_16x16x32_bf16 v[60:63], a[4:7], a[196:199], v[60:63]
  ds_read_b64_tr_b16 a[48:49], v223 offset:64
  ds_read_b64_tr_b16 a[50:51], v223 offset:5184
  v_mfma_f32_16x16x32_bf16 v[60:63], a[8:11], a[200:203], v[60:63]
  v_mfma_f32_16x16x32_bf16 v[60:63], a[12:15], a[204:207], v[60:63]
  s_waitcnt lgkmcnt(10)
  v_mfma_f32_16x16x32_bf16 v[64:67], a[16:19], a[160:163], v[64:67]
  ds_read_b64_tr_b16 a[52:53], v223 offset:10304
  ds_read_b64_tr_b16 a[54:55], v223 offset:15424
  v_mfma_f32_16x16x32_bf16 v[64:67], a[20:23], a[164:167], v[64:67]
  v_mfma_f32_16x16x32_bf16 v[64:67], a[24:27], a[168:171], v[64:67]
  v_mfma_f32_16x16x32_bf16 v[64:67], a[28:31], a[172:175], v[64:67]
  ds_read_b64_tr_b16 a[56:57], v223 offset:20544
  ds_read_b64_tr_b16 a[58:59], v223 offset:25664
  v_mfma_f32_16x16x32_bf16 v[68:71], a[16:19], a[176:179], v[68:71]
  v_mfma_f32_16x16x32_bf16 v[68:71], a[20:23], a[180:183], v[68:71]
  v_mfma_f32_16x16x32_bf16 v[68:71], a[24:27], a[184:187], v[68:71]
  ds_read_b64_tr_b16 a[60:61], v223 offset:30784
  ds_read_b64_tr_b16 a[62:63], v223 offset:35904
  v_mfma_f32_16x16x32_bf16 v[68:71], a[28:31], a[188:191], v[68:71]
  v_mfma_f32_16x16x32_bf16 v[72:75], a[16:19], a[192:195], v[72:75]
  v_mfma_f32_16x16x32_bf16 v[72:75], a[20:23], a[196:199], v[72:75]
  ds_read_b64_tr_b16 a[0:1], v222 offset:128
  ds_read_b64_tr_b16 a[2:3], v222 offset:5248
  v_mfma_f32_16x16x32_bf16 v[72:75], a[24:27], a[200:203], v[72:75]
  v_mfma_f32_16x16x32_bf16 v[72:75], a[28:31], a[204:207], v[72:75]
  s_waitcnt lgkmcnt(10)
  v_mfma_f32_16x16x32_bf16 v[76:79], a[32:35], a[160:163], v[76:79]
  ds_read_b64_tr_b16 a[4:5], v222 offset:10368
  ds_read_b64_tr_b16 a[6:7], v222 offset:15488
  v_mfma_f32_16x16x32_bf16 v[76:79], a[36:39], a[164:167], v[76:79]
  v_mfma_f32_16x16x32_bf16 v[76:79], a[40:43], a[168:171], v[76:79]
  v_cvt_pk_bf16_f32 v52, v52, v53
  v_cvt_pk_bf16_f32 v53, v54, v55
  v_mfma_f32_16x16x32_bf16 v[76:79], a[44:47], a[172:175], v[76:79]
  ds_read_b64_tr_b16 a[8:9], v222 offset:20608
  ds_read_b64_tr_b16 a[10:11], v222 offset:25728
  v_mfma_f32_16x16x32_bf16 v[80:83], a[32:35], a[176:179], v[80:83]
  v_cvt_pk_bf16_f32 v54, v64, v65
  v_cvt_pk_bf16_f32 v55, v66, v67
  v_mfma_f32_16x16x32_bf16 v[80:83], a[36:39], a[180:183], v[80:83]
  v_cvt_pk_bf16_f32 v56, v56, v57
  v_cvt_pk_bf16_f32 v57, v58, v59
  v_mfma_f32_16x16x32_bf16 v[80:83], a[40:43], a[184:187], v[80:83]
  ds_read_b64_tr_b16 a[12:13], v222 offset:30848
  ds_read_b64_tr_b16 a[14:15], v222 offset:35968
  v_mfma_f32_16x16x32_bf16 v[80:83], a[44:47], a[188:191], v[80:83]
  v_cvt_pk_bf16_f32 v58, v68, v69
  v_cvt_pk_bf16_f32 v59, v70, v71
  v_mfma_f32_16x16x32_bf16 v[84:87], a[32:35], a[192:195], v[84:87]
  v_cvt_pk_bf16_f32 v60, v60, v61
  v_cvt_pk_bf16_f32 v61, v62, v63
  v_mfma_f32_16x16x32_bf16 v[84:87], a[36:39], a[196:199], v[84:87]
  ds_read_b64_tr_b16 a[16:17], v223 offset:128
  ds_read_b64_tr_b16 a[18:19], v223 offset:5248
  v_mfma_f32_16x16x32_bf16 v[84:87], a[40:43], a[200:203], v[84:87]
  v_cvt_pk_bf16_f32 v62, v72, v73
  v_cvt_pk_bf16_f32 v63, v74, v75
  v_mfma_f32_16x16x32_bf16 v[84:87], a[44:47], a[204:207], v[84:87]
  v_permlane16_swap_b32 v52, v54
  s_waitcnt lgkmcnt(10)
  v_mfma_f32_16x16x32_bf16 v[88:91], a[48:51], a[160:163], v[88:91]
  ds_read_b64_tr_b16 a[20:21], v223 offset:10368
  ds_read_b64_tr_b16 a[22:23], v223 offset:15488
  v_mfma_f32_16x16x32_bf16 v[88:91], a[52:55], a[164:167], v[88:91]
  v_permlane16_swap_b32 v53, v55
  s_add_u32 s50, s28, 0
  v_mfma_f32_16x16x32_bf16 v[88:91], a[56:59], a[168:171], v[88:91]
  buffer_store_dwordx4 v[52:55], v240, s[12:15], s50 offen sc1
  v_permlane16_swap_b32 v56, v58
  v_mfma_f32_16x16x32_bf16 v[88:91], a[60:63], a[172:175], v[88:91]
  ds_read_b64_tr_b16 a[24:25], v223 offset:20608
  ds_read_b64_tr_b16 a[26:27], v223 offset:25728
  v_mfma_f32_16x16x32_bf16 v[92:95], a[48:51], a[176:179], v[92:95]
  v_permlane16_swap_b32 v57, v59
  s_add_u32 s50, s28, 5120
  v_mfma_f32_16x16x32_bf16 v[92:95], a[52:55], a[180:183], v[92:95]
  buffer_store_dwordx4 v[56:59], v240, s[12:15], s50 offen sc1
  v_permlane16_swap_b32 v60, v62
  v_mfma_f32_16x16x32_bf16 v[92:95], a[56:59], a[184:187], v[92:95]
  ds_read_b64_tr_b16 a[28:29], v223 offset:30848
  ds_read_b64_tr_b16 a[30:31], v223 offset:35968
  v_mfma_f32_16x16x32_bf16 v[92:95], a[60:63], a[188:191], v[92:95]
  v_permlane16_swap_b32 v61, v63
  s_add_u32 s50, s28, 10240
  v_mfma_f32_16x16x32_bf16 v[96:99], a[48:51], a[192:195], v[96:99]
  buffer_store_dwordx4 v[60:63], v240, s[12:15], s50 offen sc1
  v_mfma_f32_16x16x32_bf16 v[96:99], a[52:55], a[196:199], v[96:99]
  ds_read_b64_tr_b16 a[32:33], v222 offset:192
  ds_read_b64_tr_b16 a[34:35], v222 offset:5312
  v_mfma_f32_16x16x32_bf16 v[96:99], a[56:59], a[200:203], v[96:99]
  v_mfma_f32_16x16x32_bf16 v[96:99], a[60:63], a[204:207], v[96:99]
  s_waitcnt lgkmcnt(10)
  v_mfma_f32_16x16x32_bf16 v[100:103], a[0:3], a[160:163], v[100:103]
  ds_read_b64_tr_b16 a[36:37], v222 offset:10432
  ds_read_b64_tr_b16 a[38:39], v222 offset:15552
  v_mfma_f32_16x16x32_bf16 v[100:103], a[4:7], a[164:167], v[100:103]
  v_mfma_f32_16x16x32_bf16 v[100:103], a[8:11], a[168:171], v[100:103]
  v_cvt_pk_bf16_f32 v76, v76, v77
  v_cvt_pk_bf16_f32 v77, v78, v79
  v_mfma_f32_16x16x32_bf16 v[100:103], a[12:15], a[172:175], v[100:103]
  ds_read_b64_tr_b16 a[40:41], v222 offset:20672
  ds_read_b64_tr_b16 a[42:43], v222 offset:25792
  v_mfma_f32_16x16x32_bf16 v[104:107], a[0:3], a[176:179], v[104:107]
  v_cvt_pk_bf16_f32 v78, v88, v89
  v_cvt_pk_bf16_f32 v79, v90, v91
  v_mfma_f32_16x16x32_bf16 v[104:107], a[4:7], a[180:183], v[104:107]
  v_cvt_pk_bf16_f32 v80, v80, v81
  v_cvt_pk_bf16_f32 v81, v82, v83
  v_mfma_f32_16x16x32_bf16 v[104:107], a[8:11], a[184:187], v[104:107]
  ds_read_b64_tr_b16 a[44:45], v222 offset:30912
  ds_read_b64_tr_b16 a[46:47], v222 offset:36032
  v_mfma_f32_16x16x32_bf16 v[104:107], a[12:15], a[188:191], v[104:107]
  v_cvt_pk_bf16_f32 v82, v92, v93
  v_cvt_pk_bf16_f32 v83, v94, v95
  v_mfma_f32_16x16x32_bf16 v[108:111], a[0:3], a[192:195], v[108:111]
  v_cvt_pk_bf16_f32 v84, v84, v85
  v_cvt_pk_bf16_f32 v85, v86, v87
  v_mfma_f32_16x16x32_bf16 v[108:111], a[4:7], a[196:199], v[108:111]
  ds_read_b64_tr_b16 a[48:49], v223 offset:192
  ds_read_b64_tr_b16 a[50:51], v223 offset:5312
  v_mfma_f32_16x16x32_bf16 v[108:111], a[8:11], a[200:203], v[108:111]
  v_cvt_pk_bf16_f32 v86, v96, v97
  v_cvt_pk_bf16_f32 v87, v98, v99
  v_mfma_f32_16x16x32_bf16 v[108:111], a[12:15], a[204:207], v[108:111]
  v_permlane16_swap_b32 v76, v78
  s_waitcnt lgkmcnt(10)
  v_mfma_f32_16x16x32_bf16 v[112:115], a[16:19], a[160:163], v[112:115]
  ds_read_b64_tr_b16 a[52:53], v223 offset:10432
  ds_read_b64_tr_b16 a[54:55], v223 offset:15552
  v_mfma_f32_16x16x32_bf16 v[112:115], a[20:23], a[164:167], v[112:115]
  v_permlane16_swap_b32 v77, v79
  s_add_u32 s50, s28, 1024
  v_mfma_f32_16x16x32_bf16 v[112:115], a[24:27], a[168:171], v[112:115]
  buffer_store_dwordx4 v[76:79], v240, s[12:15], s50 offen sc1
  v_permlane16_swap_b32 v80, v82
  v_mfma_f32_16x16x32_bf16 v[112:115], a[28:31], a[172:175], v[112:115]
  ds_read_b64_tr_b16 a[56:57], v223 offset:20672
  ds_read_b64_tr_b16 a[58:59], v223 offset:25792
  v_mfma_f32_16x16x32_bf16 v[116:119], a[16:19], a[176:179], v[116:119]
  v_permlane16_swap_b32 v81, v83
  s_add_u32 s50, s28, 6144
  v_mfma_f32_16x16x32_bf16 v[116:119], a[20:23], a[180:183], v[116:119]
  buffer_store_dwordx4 v[80:83], v240, s[12:15], s50 offen sc1
  v_permlane16_swap_b32 v84, v86
  v_mfma_f32_16x16x32_bf16 v[116:119], a[24:27], a[184:187], v[116:119]
  ds_read_b64_tr_b16 a[60:61], v223 offset:30912
  ds_read_b64_tr_b16 a[62:63], v223 offset:36032
  v_mfma_f32_16x16x32_bf16 v[116:119], a[28:31], a[188:191], v[116:119]
  v_permlane16_swap_b32 v85, v87
  s_add_u32 s50, s28, 11264
  v_mfma_f32_16x16x32_bf16 v[120:123], a[16:19], a[192:195], v[120:123]
  buffer_store_dwordx4 v[84:87], v240, s[12:15], s50 offen sc1
  v_mfma_f32_16x16x32_bf16 v[120:123], a[20:23], a[196:199], v[120:123]
  ds_read_b64_tr_b16 a[0:1], v222 offset:256
  ds_read_b64_tr_b16 a[2:3], v222 offset:5376
  v_mfma_f32_16x16x32_bf16 v[120:123], a[24:27], a[200:203], v[120:123]
  v_mfma_f32_16x16x32_bf16 v[120:123], a[28:31], a[204:207], v[120:123]
  s_waitcnt lgkmcnt(10)
  v_mfma_f32_16x16x32_bf16 v[124:127], a[32:35], a[160:163], v[124:127]
  ds_read_b64_tr_b16 a[4:5], v222 offset:10496
  ds_read_b64_tr_b16 a[6:7], v222 offset:15616
  v_mfma_f32_16x16x32_bf16 v[124:127], a[36:39], a[164:167], v[124:127]
  v_mfma_f32_16x16x32_bf16 v[124:127], a[40:43], a[168:171], v[124:127]
  v_cvt_pk_bf16_f32 v100, v100, v101
  v_cvt_pk_bf16_f32 v101, v102, v103
  v_mfma_f32_16x16x32_bf16 v[124:127], a[44:47], a[172:175], v[124:127]
  ds_read_b64_tr_b16 a[8:9], v222 offset:20736
  ds_read_b64_tr_b16 a[10:11], v222 offset:25856
  v_mfma_f32_16x16x32_bf16 v[128:131], a[32:35], a[176:179], v[128:131]
  v_cvt_pk_bf16_f32 v102, v112, v113
  v_cvt_pk_bf16_f32 v103, v114, v115
  v_mfma_f32_16x16x32_bf16 v[128:131], a[36:39], a[180:183], v[128:131]
  v_cvt_pk_bf16_f32 v104, v104, v105
  v_cvt_pk_bf16_f32 v105, v106, v107
  v_mfma_f32_16x16x32_bf16 v[128:131], a[40:43], a[184:187], v[128:131]
  ds_read_b64_tr_b16 a[12:13], v222 offset:30976
  ds_read_b64_tr_b16 a[14:15], v222 offset:36096
  v_mfma_f32_16x16x32_bf16 v[128:131], a[44:47], a[188:191], v[128:131]
  v_cvt_pk_bf16_f32 v106, v116, v117
  v_cvt_pk_bf16_f32 v107, v118, v119
  v_mfma_f32_16x16x32_bf16 v[132:135], a[32:35], a[192:195], v[132:135]
  v_cvt_pk_bf16_f32 v108, v108, v109
  v_cvt_pk_bf16_f32 v109, v110, v111
  v_mfma_f32_16x16x32_bf16 v[132:135], a[36:39], a[196:199], v[132:135]
  ds_read_b64_tr_b16 a[16:17], v223 offset:256
  ds_read_b64_tr_b16 a[18:19], v223 offset:5376
  v_mfma_f32_16x16x32_bf16 v[132:135], a[40:43], a[200:203], v[132:135]
  v_cvt_pk_bf16_f32 v110, v120, v121
  v_cvt_pk_bf16_f32 v111, v122, v123
  v_mfma_f32_16x16x32_bf16 v[132:135], a[44:47], a[204:207], v[132:135]
  v_permlane16_swap_b32 v100, v102
  s_waitcnt lgkmcnt(10)
  v_mfma_f32_16x16x32_bf16 v[136:139], a[48:51], a[160:163], v[136:139]
  s_mov_b64 exec, 0xffff
  buffer_load_dword v206, v235, s[16:19], 0 offen sc1
  s_mov_b64 exec, -1
  v_mfma_f32_16x16x32_bf16 v[136:139], a[52:55], a[164:167], v[136:139]
  ds_read_b64_tr_b16 a[20:21], v223 offset:10496
  ds_read_b64_tr_b16 a[22:23], v223 offset:15616
  v_mfma_f32_16x16x32_bf16 v[136:139], a[56:59], a[168:171], v[136:139]
  v_permlane16_swap_b32 v101, v103
  s_add_u32 s50, s28, 2048
  v_mfma_f32_16x16x32_bf16 v[136:139], a[60:63], a[172:175], v[136:139]
  ds_read_b64_tr_b16 a[24:25], v223 offset:20736
  ds_read_b64_tr_b16 a[26:27], v223 offset:25856
  v_mfma_f32_16x16x32_bf16 v[140:143], a[48:51], a[176:179], v[140:143]
  buffer_store_dwordx4 v[100:103], v240, s[12:15], s50 offen sc1
  v_permlane16_swap_b32 v104, v106
  v_mfma_f32_16x16x32_bf16 v[140:143], a[52:55], a[180:183], v[140:143]
  v_permlane16_swap_b32 v105, v107
  s_add_u32 s50, s28, 7168
  v_mfma_f32_16x16x32_bf16 v[140:143], a[56:59], a[184:187], v[140:143]
  ds_read_b64_tr_b16 a[28:29], v223 offset:30976
  ds_read_b64_tr_b16 a[30:31], v223 offset:36096
  v_mfma_f32_16x16x32_bf16 v[140:143], a[60:63], a[188:191], v[140:143]
  buffer_store_dwordx4 v[104:107], v240, s[12:15], s50 offen sc1
  v_permlane16_swap_b32 v108, v110
  v_mfma_f32_16x16x32_bf16 v[144:147], a[48:51], a[192:195], v[144:147]
  v_permlane16_swap_b32 v109, v111
  s_add_u32 s50, s28, 12288
  v_mfma_f32_16x16x32_bf16 v[144:147], a[52:55], a[196:199], v[144:147]
  buffer_store_dwordx4 v[108:111], v240, s[12:15], s50 offen sc1
  v_mfma_f32_16x16x32_bf16 v[144:147], a[56:59], a[200:203], v[144:147]
  v_mfma_f32_16x16x32_bf16 v[144:147], a[60:63], a[204:207], v[144:147]
  s_waitcnt lgkmcnt(8)
  v_mfma_f32_16x16x32_bf16 v[148:151], a[0:3], a[160:163], v[148:151]
  v_mfma_f32_16x16x32_bf16 v[148:151], a[4:7], a[164:167], v[148:151]
  v_mfma_f32_16x16x32_bf16 v[148:151], a[8:11], a[168:171], v[148:151]
  v_cvt_pk_bf16_f32 v124, v124, v125
  v_cvt_pk_bf16_f32 v125, v126, v127
  v_mfma_f32_16x16x32_bf16 v[148:151], a[12:15], a[172:175], v[148:151]
  v_cvt_pk_bf16_f32 v126, v136, v137
  v_cvt_pk_bf16_f32 v127, v138, v139
  v_mfma_f32_16x16x32_bf16 v[152:155], a[0:3], a[176:179], v[152:155]
  v_cvt_pk_bf16_f32 v128, v128, v129
  v_cvt_pk_bf16_f32 v129, v130, v131
  v_mfma_f32_16x16x32_bf16 v[152:155], a[4:7], a[180:183], v[152:155]
  v_cvt_pk_bf16_f32 v130, v140, v141
  v_cvt_pk_bf16_f32 v131, v142, v143
  v_mfma_f32_16x16x32_bf16 v[152:155], a[8:11], a[184:187], v[152:155]
  v_cvt_pk_bf16_f32 v132, v132, v133
  v_cvt_pk_bf16_f32 v133, v134, v135
  v_mfma_f32_16x16x32_bf16 v[152:155], a[12:15], a[188:191], v[152:155]
  v_cvt_pk_bf16_f32 v134, v144, v145
  v_cvt_pk_bf16_f32 v135, v146, v147
  v_mfma_f32_16x16x32_bf16 v[156:159], a[0:3], a[192:195], v[156:159]
  v_permlane16_swap_b32 v124, v126
  v_permlane16_swap_b32 v125, v127
  v_mfma_f32_16x16x32_bf16 v[156:159], a[4:7], a[196:199], v[156:159]
  s_add_u32 s50, s28, 3072
  buffer_store_dwordx4 v[124:127], v240, s[12:15], s50 offen sc1
  v_mfma_f32_16x16x32_bf16 v[156:159], a[8:11], a[200:203], v[156:159]
  v_permlane16_swap_b32 v128, v130
  v_permlane16_swap_b32 v129, v131
  v_mfma_f32_16x16x32_bf16 v[156:159], a[12:15], a[204:207], v[156:159]
  s_add_u32 s50, s28, 8192
  s_waitcnt lgkmcnt(0)
  v_mfma_f32_16x16x32_bf16 v[160:163], a[16:19], a[160:163], v[160:163]
  buffer_store_dwordx4 v[128:131], v240, s[12:15], s50 offen sc1
  v_permlane16_swap_b32 v132, v134
  v_mfma_f32_16x16x32_bf16 v[160:163], a[20:23], a[164:167], v[160:163]
  v_permlane16_swap_b32 v133, v135
  s_add_u32 s50, s28, 13312
  v_mfma_f32_16x16x32_bf16 v[160:163], a[24:27], a[168:171], v[160:163]
  buffer_store_dwordx4 v[132:135], v240, s[12:15], s50 offen sc1
  v_mfma_f32_16x16x32_bf16 v[160:163], a[28:31], a[172:175], v[160:163]
  v_mfma_f32_16x16x32_bf16 v[164:167], a[16:19], a[176:179], v[164:167]
  v_mfma_f32_16x16x32_bf16 v[164:167], a[20:23], a[180:183], v[164:167]
  v_mfma_f32_16x16x32_bf16 v[164:167], a[24:27], a[184:187], v[164:167]
  v_mfma_f32_16x16x32_bf16 v[164:167], a[28:31], a[188:191], v[164:167]
  v_mfma_f32_16x16x32_bf16 v[168:171], a[16:19], a[192:195], v[168:171]
  v_mfma_f32_16x16x32_bf16 v[168:171], a[20:23], a[196:199], v[168:171]
  v_mfma_f32_16x16x32_bf16 v[168:171], a[24:27], a[200:203], v[168:171]
  v_mfma_f32_16x16x32_bf16 v[168:171], a[28:31], a[204:207], v[168:171]
  v_cvt_pk_bf16_f32 v148, v148, v149
  v_cvt_pk_bf16_f32 v149, v150, v151
  v_cvt_pk_bf16_f32 v150, v160, v161
  v_cvt_pk_bf16_f32 v151, v162, v163
  v_cvt_pk_bf16_f32 v152, v152, v153
  v_cvt_pk_bf16_f32 v153, v154, v155
  v_cvt_pk_bf16_f32 v154, v164, v165
  v_cvt_pk_bf16_f32 v155, v166, v167
  v_cvt_pk_bf16_f32 v156, v156, v157
  v_cvt_pk_bf16_f32 v157, v158, v159
  v_cvt_pk_bf16_f32 v158, v168, v169
  v_cvt_pk_bf16_f32 v159, v170, v171
  v_permlane16_swap_b32 v148, v150
  v_permlane16_swap_b32 v149, v151
  s_add_u32 s50, s28, 4096
  buffer_store_dwordx4 v[148:151], v240, s[12:15], s50 offen sc1
  v_permlane16_swap_b32 v152, v154
  v_permlane16_swap_b32 v153, v155
  s_add_u32 s50, s28, 9216
  buffer_store_dwordx4 v[152:155], v240, s[12:15], s50 offen sc1
  v_permlane16_swap_b32 v156, v158
  v_permlane16_swap_b32 v157, v159
  s_add_u32 s50, s28, 14336
  buffer_store_dwordx4 v[156:159], v240, s[12:15], s50 offen sc1
  s_branch L_fin_standalone__gqa_block_cached__near_ridge_kernel
  s_waitcnt vmcnt(0)
L_w1_standalone__gqa_block_cached__near_ridge_kernel:
  s_waitcnt vmcnt(0)
  s_call_b64 s[32:33], L_tick_standalone__gqa_block_cached__near_ridge_kernel
  s_cmp_ge_u32 s35, 1
  s_cbranch_scc1 L_wr1_standalone__gqa_block_cached__near_ridge_kernel
  s_add_u32 s48, s48, 1
  s_cmp_lt_u32 s48, 50000
  s_cbranch_scc1 L_w1_standalone__gqa_block_cached__near_ridge_kernel
  s_mov_b32 s25, 7
  s_branch L_w1_standalone__gqa_block_cached__near_ridge_kernel
L_w2_standalone__gqa_block_cached__near_ridge_kernel:
  s_waitcnt vmcnt(0)
  s_call_b64 s[32:33], L_tick_standalone__gqa_block_cached__near_ridge_kernel
  s_cmp_ge_u32 s35, 2
  s_cbranch_scc1 L_wr2_standalone__gqa_block_cached__near_ridge_kernel
  s_add_u32 s48, s48, 1
  s_cmp_lt_u32 s48, 50000
  s_cbranch_scc1 L_w2_standalone__gqa_block_cached__near_ridge_kernel
  s_mov_b32 s25, 7
  s_branch L_w2_standalone__gqa_block_cached__near_ridge_kernel
L_w3_standalone__gqa_block_cached__near_ridge_kernel:
  s_waitcnt vmcnt(0)
  s_call_b64 s[32:33], L_tick_standalone__gqa_block_cached__near_ridge_kernel
  s_cmp_ge_u32 s35, 3
  s_cbranch_scc1 L_wr3_standalone__gqa_block_cached__near_ridge_kernel
  s_add_u32 s48, s48, 1
  s_cmp_lt_u32 s48, 50000
  s_cbranch_scc1 L_w3_standalone__gqa_block_cached__near_ridge_kernel
  s_mov_b32 s25, 7
  s_branch L_w3_standalone__gqa_block_cached__near_ridge_kernel
L_hso12_standalone__gqa_block_cached__near_ridge_kernel:
  s_call_b64 s[32:33], L_tick_standalone__gqa_block_cached__near_ridge_kernel
  s_branch L_hro12_standalone__gqa_block_cached__near_ridge_kernel
L_hso30_standalone__gqa_block_cached__near_ridge_kernel:
  s_call_b64 s[32:33], L_tick_standalone__gqa_block_cached__near_ridge_kernel
  s_branch L_hro30_standalone__gqa_block_cached__near_ridge_kernel
L_hso48_standalone__gqa_block_cached__near_ridge_kernel:
  s_call_b64 s[32:33], L_tick_standalone__gqa_block_cached__near_ridge_kernel
  s_branch L_hro48_standalone__gqa_block_cached__near_ridge_kernel
L_hso66_standalone__gqa_block_cached__near_ridge_kernel:
  s_call_b64 s[32:33], L_tick_standalone__gqa_block_cached__near_ridge_kernel
  s_branch L_hro66_standalone__gqa_block_cached__near_ridge_kernel
L_hso84_standalone__gqa_block_cached__near_ridge_kernel:
  s_call_b64 s[32:33], L_tick_standalone__gqa_block_cached__near_ridge_kernel
  s_branch L_hro84_standalone__gqa_block_cached__near_ridge_kernel
L_hso102_standalone__gqa_block_cached__near_ridge_kernel:
  s_call_b64 s[32:33], L_tick_standalone__gqa_block_cached__near_ridge_kernel
  s_branch L_hro102_standalone__gqa_block_cached__near_ridge_kernel
L_hso114_standalone__gqa_block_cached__near_ridge_kernel:
  s_call_b64 s[32:33], L_tick_standalone__gqa_block_cached__near_ridge_kernel
  s_branch L_hro114_standalone__gqa_block_cached__near_ridge_kernel
L_hsa12_standalone__gqa_block_cached__near_ridge_kernel:
  s_call_b64 s[32:33], L_tick_standalone__gqa_block_cached__near_ridge_kernel
  s_branch L_hra12_standalone__gqa_block_cached__near_ridge_kernel
L_hsa30_standalone__gqa_block_cached__near_ridge_kernel:
  s_call_b64 s[32:33], L_tick_standalone__gqa_block_cached__near_ridge_kernel
  s_branch L_hra30_standalone__gqa_block_cached__near_ridge_kernel
L_hsa48_standalone__gqa_block_cached__near_ridge_kernel:
  s_call_b64 s[32:33], L_tick_standalone__gqa_block_cached__near_ridge_kernel
  s_branch L_hra48_standalone__gqa_block_cached__near_ridge_kernel
L_hsa66_standalone__gqa_block_cached__near_ridge_kernel:
  s_call_b64 s[32:33], L_tick_standalone__gqa_block_cached__near_ridge_kernel
  s_branch L_hra66_standalone__gqa_block_cached__near_ridge_kernel
L_hsa84_standalone__gqa_block_cached__near_ridge_kernel:
  s_call_b64 s[32:33], L_tick_standalone__gqa_block_cached__near_ridge_kernel
  s_branch L_hra84_standalone__gqa_block_cached__near_ridge_kernel
L_hsa102_standalone__gqa_block_cached__near_ridge_kernel:
  s_call_b64 s[32:33], L_tick_standalone__gqa_block_cached__near_ridge_kernel
  s_branch L_hra102_standalone__gqa_block_cached__near_ridge_kernel
L_hsa114_standalone__gqa_block_cached__near_ridge_kernel:
  s_call_b64 s[32:33], L_tick_standalone__gqa_block_cached__near_ridge_kernel
  s_branch L_hra114_standalone__gqa_block_cached__near_ridge_kernel
L_hsb12_standalone__gqa_block_cached__near_ridge_kernel:
  s_call_b64 s[32:33], L_tick_standalone__gqa_block_cached__near_ridge_kernel
  s_branch L_hrb12_standalone__gqa_block_cached__near_ridge_kernel
L_hsb30_standalone__gqa_block_cached__near_ridge_kernel:
  s_call_b64 s[32:33], L_tick_standalone__gqa_block_cached__near_ridge_kernel
  s_branch L_hrb30_standalone__gqa_block_cached__near_ridge_kernel
L_hsb48_standalone__gqa_block_cached__near_ridge_kernel:
  s_call_b64 s[32:33], L_tick_standalone__gqa_block_cached__near_ridge_kernel
  s_branch L_hrb48_standalone__gqa_block_cached__near_ridge_kernel
L_hsb66_standalone__gqa_block_cached__near_ridge_kernel:
  s_call_b64 s[32:33], L_tick_standalone__gqa_block_cached__near_ridge_kernel
  s_branch L_hrb66_standalone__gqa_block_cached__near_ridge_kernel
L_hsb84_standalone__gqa_block_cached__near_ridge_kernel:
  s_call_b64 s[32:33], L_tick_standalone__gqa_block_cached__near_ridge_kernel
  s_branch L_hrb84_standalone__gqa_block_cached__near_ridge_kernel
L_hsb102_standalone__gqa_block_cached__near_ridge_kernel:
  s_call_b64 s[32:33], L_tick_standalone__gqa_block_cached__near_ridge_kernel
  s_branch L_hrb102_standalone__gqa_block_cached__near_ridge_kernel
L_hsb114_standalone__gqa_block_cached__near_ridge_kernel:
  s_call_b64 s[32:33], L_tick_standalone__gqa_block_cached__near_ridge_kernel
  s_branch L_hrb114_standalone__gqa_block_cached__near_ridge_kernel
L_tick_standalone__gqa_block_cached__near_ridge_kernel:
  s_mov_b32 s35, s21
  s_cmp_eq_u32 s35, 3
  s_cselect_b32 s92, 1, 0
  s_bitcmp1_b32 s51, 0
  s_cbranch_scc1 L_t1_standalone__gqa_block_cached__near_ridge_kernel
  s_mov_b64 exec, 8
  buffer_store_dword v230, v229, s[16:19], s95 offen sc1
  s_mov_b64 exec, -1
L_t1_standalone__gqa_block_cached__near_ridge_kernel:
  v_cmp_ne_u32 vcc, v227, v228
  s_mov_b32 s51, 1
  s_or_b32 s25, s25, vcc_lo
L_svc_standalone__gqa_block_cached__near_ridge_kernel:
  s_and_b32 s25, s25, 7
  s_andn2_b32 s25, s25, s20
  s_cbranch_scc0 L_tp_standalone__gqa_block_cached__near_ridge_kernel
  s_ff1_i32_b32 s43, s25
  s_bitset1_b32 s20, s43
  s_add_u32 s44, s43, 1
  s_add_u32 s45, s44, s3
  s_and_b32 s45, s45, 3
  s_mul_i32 s45, s45, 36864
  s_mul_i32 s44, s44, 40960
  s_cmp_eq_u32 s21, 1
  s_cbranch_scc1 L_sv1_standalone__gqa_block_cached__near_ridge_kernel
  s_cmp_eq_u32 s21, 2
  s_cbranch_scc1 L_sv2_standalone__gqa_block_cached__near_ridge_kernel
L_sv0_standalone__gqa_block_cached__near_ridge_kernel:
  buffer_load_dwordx4 a[64:67], v237, s[8:11], s45 offen offset:0 sc1
  buffer_load_dwordx4 a[80:83], v238, s[8:11], s45 offen offset:0 sc1
  buffer_load_dwordx4 a[96:99], v239, s[8:11], s45 offen offset:0 sc1
  buffer_load_dwordx4 a[68:71], v237, s[8:11], s45 offen offset:1024 sc1
  buffer_load_dwordx4 a[84:87], v238, s[8:11], s45 offen offset:1024 sc1
  buffer_load_dwordx4 a[100:103], v239, s[8:11], s45 offen offset:1024 sc1
  buffer_load_dwordx4 a[72:75], v237, s[8:11], s45 offen offset:2048 sc1
  buffer_load_dwordx4 a[88:91], v238, s[8:11], s45 offen offset:2048 sc1
  buffer_load_dwordx4 a[104:107], v239, s[8:11], s45 offen offset:2048 sc1
  buffer_load_dwordx4 a[76:79], v237, s[8:11], s45 offen offset:3072 sc1
  buffer_load_dwordx4 a[92:95], v238, s[8:11], s45 offen offset:3072 sc1
  buffer_load_dwordx4 a[108:111], v239, s[8:11], s45 offen offset:3072 sc1
  v_add_u32 v218, s44, v241
  v_add_u32 v219, s44, v242
  s_add_u32 s21, s21, 1
  s_branch L_svc_standalone__gqa_block_cached__near_ridge_kernel
L_sv1_standalone__gqa_block_cached__near_ridge_kernel:
  buffer_load_dwordx4 a[112:115], v237, s[8:11], s45 offen offset:0 sc1
  buffer_load_dwordx4 a[128:131], v238, s[8:11], s45 offen offset:0 sc1
  buffer_load_dwordx4 a[144:147], v239, s[8:11], s45 offen offset:0 sc1
  buffer_load_dwordx4 a[116:119], v237, s[8:11], s45 offen offset:1024 sc1
  buffer_load_dwordx4 a[132:135], v238, s[8:11], s45 offen offset:1024 sc1
  buffer_load_dwordx4 a[148:151], v239, s[8:11], s45 offen offset:1024 sc1
  buffer_load_dwordx4 a[120:123], v237, s[8:11], s45 offen offset:2048 sc1
  buffer_load_dwordx4 a[136:139], v238, s[8:11], s45 offen offset:2048 sc1
  buffer_load_dwordx4 a[152:155], v239, s[8:11], s45 offen offset:2048 sc1
  buffer_load_dwordx4 a[124:127], v237, s[8:11], s45 offen offset:3072 sc1
  buffer_load_dwordx4 a[140:143], v238, s[8:11], s45 offen offset:3072 sc1
  buffer_load_dwordx4 a[156:159], v239, s[8:11], s45 offen offset:3072 sc1
  v_add_u32 v220, s44, v241
  v_add_u32 v221, s44, v242
  s_add_u32 s21, s21, 1
  s_branch L_svc_standalone__gqa_block_cached__near_ridge_kernel
L_sv2_standalone__gqa_block_cached__near_ridge_kernel:
  buffer_load_dwordx4 a[160:163], v237, s[8:11], s45 offen offset:0 sc1
  buffer_load_dwordx4 a[176:179], v238, s[8:11], s45 offen offset:0 sc1
  buffer_load_dwordx4 a[192:195], v239, s[8:11], s45 offen offset:0 sc1
  buffer_load_dwordx4 a[164:167], v237, s[8:11], s45 offen offset:1024 sc1
  buffer_load_dwordx4 a[180:183], v238, s[8:11], s45 offen offset:1024 sc1
  buffer_load_dwordx4 a[196:199], v239, s[8:11], s45 offen offset:1024 sc1
  buffer_load_dwordx4 a[168:171], v237, s[8:11], s45 offen offset:2048 sc1
  buffer_load_dwordx4 a[184:187], v238, s[8:11], s45 offen offset:2048 sc1
  buffer_load_dwordx4 a[200:203], v239, s[8:11], s45 offen offset:2048 sc1
  buffer_load_dwordx4 a[172:175], v237, s[8:11], s45 offen offset:3072 sc1
  buffer_load_dwordx4 a[188:191], v238, s[8:11], s45 offen offset:3072 sc1
  buffer_load_dwordx4 a[204:207], v239, s[8:11], s45 offen offset:3072 sc1
  v_add_u32 v222, s44, v241
  v_add_u32 v223, s44, v242
  s_add_u32 s21, s21, 1
  s_branch L_svc_standalone__gqa_block_cached__near_ridge_kernel
L_tp_standalone__gqa_block_cached__near_ridge_kernel:
  s_cmp_eq_u32 s20, 7
  s_cbranch_scc1 L_tr_standalone__gqa_block_cached__near_ridge_kernel
  s_andn2_b32 exec_lo, 7, s20
  s_mov_b32 exec_hi, 0
  buffer_load_dword v228, v229, s[16:19], s95 offen sc1
  s_mov_b64 exec, -1
L_tr_standalone__gqa_block_cached__near_ridge_kernel:
  s_setpc_b64 s[32:33]
  s_waitcnt vmcnt(0)
L_ok_standalone__gqa_block_cached__near_ridge_kernel_p0s:
  s_call_b64 s[52:53], L_rareB_standalone__gqa_block_cached__near_ridge_kernel
  s_branch L_ok_standalone__gqa_block_cached__near_ridge_kernel_p0
L_ok_standalone__gqa_block_cached__near_ridge_kernel_p1s:
  s_call_b64 s[52:53], L_rareA_standalone__gqa_block_cached__near_ridge_kernel
  s_branch L_ok_standalone__gqa_block_cached__near_ridge_kernel_p1
L_ok_standalone__gqa_block_cached__near_ridge_kernel_0s:
  s_call_b64 s[52:53], L_rareB_standalone__gqa_block_cached__near_ridge_kernel
  s_branch L_ok_standalone__gqa_block_cached__near_ridge_kernel_0
L_ok_standalone__gqa_block_cached__near_ridge_kernel_1s:
  s_call_b64 s[52:53], L_rareA_standalone__gqa_block_cached__near_ridge_kernel
  s_branch L_ok_standalone__gqa_block_cached__near_ridge_kernel_1
L_ok_standalone__gqa_block_cached__near_ridge_kernel_2s:
  s_call_b64 s[52:53], L_rareB_standalone__gqa_block_cached__near_ridge_kernel
  s_branch L_ok_standalone__gqa_block_cached__near_ridge_kernel_2
L_ok_standalone__gqa_block_cached__near_ridge_kernel_3s:
  s_call_b64 s[52:53], L_rareA_standalone__gqa_block_cached__near_ridge_kernel
  s_branch L_ok_standalone__gqa_block_cached__near_ridge_kernel_3
L_ok_standalone__gqa_block_cached__near_ridge_kernel_4s:
  s_call_b64 s[52:53], L_rareB_standalone__gqa_block_cached__near_ridge_kernel
  s_branch L_ok_standalone__gqa_block_cached__near_ridge_kernel_4
L_ok_standalone__gqa_block_cached__near_ridge_kernel_5s:
  s_call_b64 s[52:53], L_rareA_standalone__gqa_block_cached__near_ridge_kernel
  s_branch L_ok_standalone__gqa_block_cached__near_ridge_kernel_5
L_ok_standalone__gqa_block_cached__near_ridge_kernel_6s:
  s_call_b64 s[52:53], L_rareB_standalone__gqa_block_cached__near_ridge_kernel
  s_branch L_ok_standalone__gqa_block_cached__near_ridge_kernel_6
L_ok_standalone__gqa_block_cached__near_ridge_kernel_7s:
  s_call_b64 s[52:53], L_rareA_standalone__gqa_block_cached__near_ridge_kernel
  s_branch L_ok_standalone__gqa_block_cached__near_ridge_kernel_7
L_ok_standalone__gqa_block_cached__near_ridge_kernel_p31s:
  s_call_b64 s[52:53], L_rareA_standalone__gqa_block_cached__near_ridge_kernel
  s_branch L_ok_standalone__gqa_block_cached__near_ridge_kernel_p31
L_cend_standalone__gqa_block_cached__near_ridge_kernel:
L_rareA_standalone__gqa_block_cached__near_ridge_kernel:
  s_nop 15
  s_nop 3
  v_max3_f32 v207, v124, v125, v126
  v_max3_f32 v207, v207, v127, v136
  v_max3_f32 v207, v207, v137, v138
  v_max_f32 v207, v207, v139
  v_mov_b32 v206, v207
  s_nop 1
  v_permlane16_swap_b32 v207, v206
  v_max_f32 v207, v207, v206
  v_mov_b32 v206, v207
  s_nop 1
  v_permlane32_swap_b32 v207, v206
  v_max_f32 v207, v207, v206
  v_ceil_f32_e64 v207, v207
  v_add_f32 v207, 0x40e00000, v207
  v_max_f32_e64 v207, 0, v207
  v_exp_f32 v208, -v207
  v_sub_f32 v100, v100, v207
  v_sub_f32 v101, v101, v207
  v_sub_f32 v102, v102, v207
  v_sub_f32 v103, v103, v207
  v_sub_f32 v112, v112, v207
  v_sub_f32 v113, v113, v207
  v_sub_f32 v114, v114, v207
  v_sub_f32 v115, v115, v207
  v_sub_f32 v124, v124, v207
  v_sub_f32 v125, v125, v207
  v_sub_f32 v126, v126, v207
  v_sub_f32 v127, v127, v207
  v_sub_f32 v136, v136, v207
  v_sub_f32 v137, v137, v207
  v_sub_f32 v138, v138, v207
  v_sub_f32 v139, v139, v207
  v_sub_f32 v172, v172, v207
  v_sub_f32 v173, v173, v207
  v_sub_f32 v174, v174, v207
  v_sub_f32 v175, v175, v207
  v_mul_f32 v184, v184, v208
  v_mul_f32 v4, v4, v208
  v_mul_f32 v5, v5, v208
  v_mul_f32 v6, v6, v208
  v_mul_f32 v7, v7, v208
  v_mul_f32 v16, v16, v208
  v_mul_f32 v17, v17, v208
  v_mul_f32 v18, v18, v208
  v_mul_f32 v19, v19, v208
  v_mul_f32 v28, v28, v208
  v_mul_f32 v29, v29, v208
  v_mul_f32 v30, v30, v208
  v_mul_f32 v31, v31, v208
  v_mul_f32 v40, v40, v208
  v_mul_f32 v41, v41, v208
  v_mul_f32 v42, v42, v208
  v_mul_f32 v43, v43, v208
  v_mul_f32 v52, v52, v208
  v_mul_f32 v53, v53, v208
  v_mul_f32 v54, v54, v208
  v_mul_f32 v55, v55, v208
  v_mul_f32 v64, v64, v208
  v_mul_f32 v65, v65, v208
  v_mul_f32 v66, v66, v208
  v_mul_f32 v67, v67, v208
  v_mul_f32 v76, v76, v208
  v_mul_f32 v77, v77, v208
  v_mul_f32 v78, v78, v208
  v_mul_f32 v79, v79, v208
  v_mul_f32 v88, v88, v208
  v_mul_f32 v89, v89, v208
  v_mul_f32 v90, v90, v208
  v_mul_f32 v91, v91, v208
  v_exp_f32 v209, v124
  v_exp_f32 v210, v125
  s_nop 0
  v_cvt_pk_bf16_f32 v160, v209, v210
  v_exp_f32 v209, v126
  v_exp_f32 v210, v127
  s_nop 0
  v_cvt_pk_bf16_f32 v161, v209, v210
  v_exp_f32 v209, v136
  v_exp_f32 v210, v137
  s_nop 0
  v_cvt_pk_bf16_f32 v162, v209, v210
  v_exp_f32 v209, v138
  v_exp_f32 v210, v139
  s_nop 0
  v_cvt_pk_bf16_f32 v163, v209, v210
  v_max3_f32 v207, v128, v129, v130
  v_max3_f32 v207, v207, v131, v140
  v_max3_f32 v207, v207, v141, v142
  v_max_f32 v207, v207, v143
  v_mov_b32 v206, v207
  s_nop 1
  v_permlane16_swap_b32 v207, v206
  v_max_f32 v207, v207, v206
  v_mov_b32 v206, v207
  s_nop 1
  v_permlane32_swap_b32 v207, v206
  v_max_f32 v207, v207, v206
  v_ceil_f32_e64 v207, v207
  v_add_f32 v207, 0x40e00000, v207
  v_max_f32_e64 v207, 0, v207
  v_exp_f32 v208, -v207
  v_sub_f32 v104, v104, v207
  v_sub_f32 v105, v105, v207
  v_sub_f32 v106, v106, v207
  v_sub_f32 v107, v107, v207
  v_sub_f32 v116, v116, v207
  v_sub_f32 v117, v117, v207
  v_sub_f32 v118, v118, v207
  v_sub_f32 v119, v119, v207
  v_sub_f32 v128, v128, v207
  v_sub_f32 v129, v129, v207
  v_sub_f32 v130, v130, v207
  v_sub_f32 v131, v131, v207
  v_sub_f32 v140, v140, v207
  v_sub_f32 v141, v141, v207
  v_sub_f32 v142, v142, v207
  v_sub_f32 v143, v143, v207
  v_sub_f32 v176, v176, v207
  v_sub_f32 v177, v177, v207
  v_sub_f32 v178, v178, v207
  v_sub_f32 v179, v179, v207
  v_mul_f32 v188, v188, v208
  v_mul_f32 v8, v8, v208
  v_mul_f32 v9, v9, v208
  v_mul_f32 v10, v10, v208
  v_mul_f32 v11, v11, v208
  v_mul_f32 v20, v20, v208
  v_mul_f32 v21, v21, v208
  v_mul_f32 v22, v22, v208
  v_mul_f32 v23, v23, v208
  v_mul_f32 v32, v32, v208
  v_mul_f32 v33, v33, v208
  v_mul_f32 v34, v34, v208
  v_mul_f32 v35, v35, v208
  v_mul_f32 v44, v44, v208
  v_mul_f32 v45, v45, v208
  v_mul_f32 v46, v46, v208
  v_mul_f32 v47, v47, v208
  v_mul_f32 v56, v56, v208
  v_mul_f32 v57, v57, v208
  v_mul_f32 v58, v58, v208
  v_mul_f32 v59, v59, v208
  v_mul_f32 v68, v68, v208
  v_mul_f32 v69, v69, v208
  v_mul_f32 v70, v70, v208
  v_mul_f32 v71, v71, v208
  v_mul_f32 v80, v80, v208
  v_mul_f32 v81, v81, v208
  v_mul_f32 v82, v82, v208
  v_mul_f32 v83, v83, v208
  v_mul_f32 v92, v92, v208
  v_mul_f32 v93, v93, v208
  v_mul_f32 v94, v94, v208
  v_mul_f32 v95, v95, v208
  v_exp_f32 v209, v128
  v_exp_f32 v210, v129
  s_nop 0
  v_cvt_pk_bf16_f32 v164, v209, v210
  v_exp_f32 v209, v130
  v_exp_f32 v210, v131
  s_nop 0
  v_cvt_pk_bf16_f32 v165, v209, v210
  v_exp_f32 v209, v140
  v_exp_f32 v210, v141
  s_nop 0
  v_cvt_pk_bf16_f32 v166, v209, v210
  v_exp_f32 v209, v142
  v_exp_f32 v210, v143
  s_nop 0
  v_cvt_pk_bf16_f32 v167, v209, v210
  v_max3_f32 v207, v132, v133, v134
  v_max3_f32 v207, v207, v135, v144
  v_max3_f32 v207, v207, v145, v146
  v_max_f32 v207, v207, v147
  v_mov_b32 v206, v207
  s_nop 1
  v_permlane16_swap_b32 v207, v206
  v_max_f32 v207, v207, v206
  v_mov_b32 v206, v207
  s_nop 1
  v_permlane32_swap_b32 v207, v206
  v_max_f32 v207, v207, v206
  v_ceil_f32_e64 v207, v207
  v_add_f32 v207, 0x40e00000, v207
  v_max_f32_e64 v207, 0, v207
  v_exp_f32 v208, -v207
  v_sub_f32 v108, v108, v207
  v_sub_f32 v109, v109, v207
  v_sub_f32 v110, v110, v207
  v_sub_f32 v111, v111, v207
  v_sub_f32 v120, v120, v207
  v_sub_f32 v121, v121, v207
  v_sub_f32 v122, v122, v207
  v_sub_f32 v123, v123, v207
  v_sub_f32 v132, v132, v207
  v_sub_f32 v133, v133, v207
  v_sub_f32 v134, v134, v207
  v_sub_f32 v135, v135, v207
  v_sub_f32 v144, v144, v207
  v_sub_f32 v145, v145, v207
  v_sub_f32 v146, v146, v207
  v_sub_f32 v147, v147, v207
  v_sub_f32 v180, v180, v207
  v_sub_f32 v181, v181, v207
  v_sub_f32 v182, v182, v207
  v_sub_f32 v183, v183, v207
  v_mul_f32 v192, v192, v208
  v_mul_f32 v12, v12, v208
  v_mul_f32 v13, v13, v208
  v_mul_f32 v14, v14, v208
  v_mul_f32 v15, v15, v208
  v_mul_f32 v24, v24, v208
  v_mul_f32 v25, v25, v208
  v_mul_f32 v26, v26, v208
  v_mul_f32 v27, v27, v208
  v_mul_f32 v36, v36, v208
  v_mul_f32 v37, v37, v208
  v_mul_f32 v38, v38, v208
  v_mul_f32 v39, v39, v208
  v_mul_f32 v48, v48, v208
  v_mul_f32 v49, v49, v208
  v_mul_f32 v50, v50, v208
  v_mul_f32 v51, v51, v208
  v_mul_f32 v60, v60, v208
  v_mul_f32 v61, v61, v208
  v_mul_f32 v62, v62, v208
  v_mul_f32 v63, v63, v208
  v_mul_f32 v72, v72, v208
  v_mul_f32 v73, v73, v208
  v_mul_f32 v74, v74, v208
  v_mul_f32 v75, v75, v208
  v_mul_f32 v84, v84, v208
  v_mul_f32 v85, v85, v208
  v_mul_f32 v86, v86, v208
  v_mul_f32 v87, v87, v208
  v_mul_f32 v96, v96, v208
  v_mul_f32 v97, v97, v208
  v_mul_f32 v98, v98, v208
  v_mul_f32 v99, v99, v208
  v_exp_f32 v209, v132
  v_exp_f32 v210, v133
  s_nop 0
  v_cvt_pk_bf16_f32 v168, v209, v210
  v_exp_f32 v209, v134
  v_exp_f32 v210, v135
  s_nop 0
  v_cvt_pk_bf16_f32 v169, v209, v210
  v_exp_f32 v209, v144
  v_exp_f32 v210, v145
  s_nop 0
  v_cvt_pk_bf16_f32 v170, v209, v210
  v_exp_f32 v209, v146
  v_exp_f32 v210, v147
  s_nop 0
  v_cvt_pk_bf16_f32 v171, v209, v210
  s_nop 3
  s_setpc_b64 s[52:53]
L_rareB_standalone__gqa_block_cached__near_ridge_kernel:
  s_nop 15
  s_nop 3
  v_max3_f32 v207, v100, v101, v102
  v_max3_f32 v207, v207, v103, v112
  v_max3_f32 v207, v207, v113, v114
  v_max_f32 v207, v207, v115
  v_mov_b32 v206, v207
  s_nop 1
  v_permlane16_swap_b32 v207, v206
  v_max_f32 v207, v207, v206
  v_mov_b32 v206, v207
  s_nop 1
  v_permlane32_swap_b32 v207, v206
  v_max_f32 v207, v207, v206
  v_ceil_f32_e64 v207, v207
  v_add_f32 v207, 0x40e00000, v207
  v_max_f32_e64 v207, 0, v207
  v_exp_f32 v208, -v207
  v_sub_f32 v100, v100, v207
  v_sub_f32 v101, v101, v207
  v_sub_f32 v102, v102, v207
  v_sub_f32 v103, v103, v207
  v_sub_f32 v112, v112, v207
  v_sub_f32 v113, v113, v207
  v_sub_f32 v114, v114, v207
  v_sub_f32 v115, v115, v207
  v_sub_f32 v124, v124, v207
  v_sub_f32 v125, v125, v207
  v_sub_f32 v126, v126, v207
  v_sub_f32 v127, v127, v207
  v_sub_f32 v136, v136, v207
  v_sub_f32 v137, v137, v207
  v_sub_f32 v138, v138, v207
  v_sub_f32 v139, v139, v207
  v_sub_f32 v172, v172, v207
  v_sub_f32 v173, v173, v207
  v_sub_f32 v174, v174, v207
  v_sub_f32 v175, v175, v207
  v_mul_f32 v184, v184, v208
  v_mul_f32 v4, v4, v208
  v_mul_f32 v5, v5, v208
  v_mul_f32 v6, v6, v208
  v_mul_f32 v7, v7, v208
  v_mul_f32 v16, v16, v208
  v_mul_f32 v17, v17, v208
  v_mul_f32 v18, v18, v208
  v_mul_f32 v19, v19, v208
  v_mul_f32 v28, v28, v208
  v_mul_f32 v29, v29, v208
  v_mul_f32 v30, v30, v208
  v_mul_f32 v31, v31, v208
  v_mul_f32 v40, v40, v208
  v_mul_f32 v41, v41, v208
  v_mul_f32 v42, v42, v208
  v_mul_f32 v43, v43, v208
  v_mul_f32 v52, v52, v208
  v_mul_f32 v53, v53, v208
  v_mul_f32 v54, v54, v208
  v_mul_f32 v55, v55, v208
  v_mul_f32 v64, v64, v208
  v_mul_f32 v65, v65, v208
  v_mul_f32 v66, v66, v208
  v_mul_f32 v67, v67, v208
  v_mul_f32 v76, v76, v208
  v_mul_f32 v77, v77, v208
  v_mul_f32 v78, v78, v208
  v_mul_f32 v79, v79, v208
  v_mul_f32 v88, v88, v208
  v_mul_f32 v89, v89, v208
  v_mul_f32 v90, v90, v208
  v_mul_f32 v91, v91, v208
  v_exp_f32 v209, v100
  v_exp_f32 v210, v101
  s_nop 0
  v_cvt_pk_bf16_f32 v148, v209, v210
  v_exp_f32 v209, v102
  v_exp_f32 v210, v103
  s_nop 0
  v_cvt_pk_bf16_f32 v149, v209, v210
  v_exp_f32 v209, v112
  v_exp_f32 v210, v113
  s_nop 0
  v_cvt_pk_bf16_f32 v150, v209, v210
  v_exp_f32 v209, v114
  v_exp_f32 v210, v115
  s_nop 0
  v_cvt_pk_bf16_f32 v151, v209, v210
  v_max3_f32 v207, v104, v105, v106
  v_max3_f32 v207, v207, v107, v116
  v_max3_f32 v207, v207, v117, v118
  v_max_f32 v207, v207, v119
  v_mov_b32 v206, v207
  s_nop 1
  v_permlane16_swap_b32 v207, v206
  v_max_f32 v207, v207, v206
  v_mov_b32 v206, v207
  s_nop 1
  v_permlane32_swap_b32 v207, v206
  v_max_f32 v207, v207, v206
  v_ceil_f32_e64 v207, v207
  v_add_f32 v207, 0x40e00000, v207
  v_max_f32_e64 v207, 0, v207
  v_exp_f32 v208, -v207
  v_sub_f32 v104, v104, v207
  v_sub_f32 v105, v105, v207
  v_sub_f32 v106, v106, v207
  v_sub_f32 v107, v107, v207
  v_sub_f32 v116, v116, v207
  v_sub_f32 v117, v117, v207
  v_sub_f32 v118, v118, v207
  v_sub_f32 v119, v119, v207
  v_sub_f32 v128, v128, v207
  v_sub_f32 v129, v129, v207
  v_sub_f32 v130, v130, v207
  v_sub_f32 v131, v131, v207
  v_sub_f32 v140, v140, v207
  v_sub_f32 v141, v141, v207
  v_sub_f32 v142, v142, v207
  v_sub_f32 v143, v143, v207
  v_sub_f32 v176, v176, v207
  v_sub_f32 v177, v177, v207
  v_sub_f32 v178, v178, v207
  v_sub_f32 v179, v179, v207
  v_mul_f32 v188, v188, v208
  v_mul_f32 v8, v8, v208
  v_mul_f32 v9, v9, v208
  v_mul_f32 v10, v10, v208
  v_mul_f32 v11, v11, v208
  v_mul_f32 v20, v20, v208
  v_mul_f32 v21, v21, v208
  v_mul_f32 v22, v22, v208
  v_mul_f32 v23, v23, v208
  v_mul_f32 v32, v32, v208
  v_mul_f32 v33, v33, v208
  v_mul_f32 v34, v34, v208
  v_mul_f32 v35, v35, v208
  v_mul_f32 v44, v44, v208
  v_mul_f32 v45, v45, v208
  v_mul_f32 v46, v46, v208
  v_mul_f32 v47, v47, v208
  v_mul_f32 v56, v56, v208
  v_mul_f32 v57, v57, v208
  v_mul_f32 v58, v58, v208
  v_mul_f32 v59, v59, v208
  v_mul_f32 v68, v68, v208
  v_mul_f32 v69, v69, v208
  v_mul_f32 v70, v70, v208
  v_mul_f32 v71, v71, v208
  v_mul_f32 v80, v80, v208
  v_mul_f32 v81, v81, v208
  v_mul_f32 v82, v82, v208
  v_mul_f32 v83, v83, v208
  v_mul_f32 v92, v92, v208
  v_mul_f32 v93, v93, v208
  v_mul_f32 v94, v94, v208
  v_mul_f32 v95, v95, v208
  v_exp_f32 v209, v104
  v_exp_f32 v210, v105
  s_nop 0
  v_cvt_pk_bf16_f32 v152, v209, v210
  v_exp_f32 v209, v106
  v_exp_f32 v210, v107
  s_nop 0
  v_cvt_pk_bf16_f32 v153, v209, v210
  v_exp_f32 v209, v116
  v_exp_f32 v210, v117
  s_nop 0
  v_cvt_pk_bf16_f32 v154, v209, v210
  v_exp_f32 v209, v118
  v_exp_f32 v210, v119
  s_nop 0
  v_cvt_pk_bf16_f32 v155, v209, v210
  v_max3_f32 v207, v108, v109, v110
  v_max3_f32 v207, v207, v111, v120
  v_max3_f32 v207, v207, v121, v122
  v_max_f32 v207, v207, v123
  v_mov_b32 v206, v207
  s_nop 1
  v_permlane16_swap_b32 v207, v206
  v_max_f32 v207, v207, v206
  v_mov_b32 v206, v207
  s_nop 1
  v_permlane32_swap_b32 v207, v206
  v_max_f32 v207, v207, v206
  v_ceil_f32_e64 v207, v207
  v_add_f32 v207, 0x40e00000, v207
  v_max_f32_e64 v207, 0, v207
  v_exp_f32 v208, -v207
  v_sub_f32 v108, v108, v207
  v_sub_f32 v109, v109, v207
  v_sub_f32 v110, v110, v207
  v_sub_f32 v111, v111, v207
  v_sub_f32 v120, v120, v207
  v_sub_f32 v121, v121, v207
  v_sub_f32 v122, v122, v207
  v_sub_f32 v123, v123, v207
  v_sub_f32 v132, v132, v207
  v_sub_f32 v133, v133, v207
  v_sub_f32 v134, v134, v207
  v_sub_f32 v135, v135, v207
  v_sub_f32 v144, v144, v207
  v_sub_f32 v145, v145, v207
  v_sub_f32 v146, v146, v207
  v_sub_f32 v147, v147, v207
  v_sub_f32 v180, v180, v207
  v_sub_f32 v181, v181, v207
  v_sub_f32 v182, v182, v207
  v_sub_f32 v183, v183, v207
  v_mul_f32 v192, v192, v208
  v_mul_f32 v12, v12, v208
  v_mul_f32 v13, v13, v208
  v_mul_f32 v14, v14, v208
  v_mul_f32 v15, v15, v208
  v_mul_f32 v24, v24, v208
  v_mul_f32 v25, v25, v208
  v_mul_f32 v26, v26, v208
  v_mul_f32 v27, v27, v208
  v_mul_f32 v36, v36, v208
  v_mul_f32 v37, v37, v208
  v_mul_f32 v38, v38, v208
  v_mul_f32 v39, v39, v208
  v_mul_f32 v48, v48, v208
  v_mul_f32 v49, v49, v208
  v_mul_f32 v50, v50, v208
  v_mul_f32 v51, v51, v208
  v_mul_f32 v60, v60, v208
  v_mul_f32 v61, v61, v208
  v_mul_f32 v62, v62, v208
  v_mul_f32 v63, v63, v208
  v_mul_f32 v72, v72, v208
  v_mul_f32 v73, v73, v208
  v_mul_f32 v74, v74, v208
  v_mul_f32 v75, v75, v208
  v_mul_f32 v84, v84, v208
  v_mul_f32 v85, v85, v208
  v_mul_f32 v86, v86, v208
  v_mul_f32 v87, v87, v208
  v_mul_f32 v96, v96, v208
  v_mul_f32 v97, v97, v208
  v_mul_f32 v98, v98, v208
  v_mul_f32 v99, v99, v208
  v_exp_f32 v209, v108
  v_exp_f32 v210, v109
  s_nop 0
  v_cvt_pk_bf16_f32 v156, v209, v210
  v_exp_f32 v209, v110
  v_exp_f32 v210, v111
  s_nop 0
  v_cvt_pk_bf16_f32 v157, v209, v210
  v_exp_f32 v209, v120
  v_exp_f32 v210, v121
  s_nop 0
  v_cvt_pk_bf16_f32 v158, v209, v210
  v_exp_f32 v209, v122
  v_exp_f32 v210, v123
  s_nop 0
  v_cvt_pk_bf16_f32 v159, v209, v210
  s_nop 3
  s_setpc_b64 s[52:53]
.section .rodata,"a"
.p2align 6
.amdhsa_kernel standalone__gqa_block_cached__near_ridge_kernel
  .amdhsa_next_free_vgpr 512
  .amdhsa_next_free_sgpr 100
  .amdhsa_accum_offset 256
  .amdhsa_group_segment_fixed_size 0
  .amdhsa_kernarg_size 64
  .amdhsa_user_sgpr_count 2
  .amdhsa_user_sgpr_kernarg_segment_ptr 1
  .amdhsa_system_sgpr_workgroup_id_x 1
  .amdhsa_float_denorm_mode_32 3
.end_amdhsa_kernel
.text
```
